```python
import torch

def _softmax(x, axis=-1):
    return torch.softmax(x, dim=axis)
def _gelu(x):
    return torch.nn.functional.gelu(x, approximate="tanh")
def _silu(x):
    return torch.nn.functional.silu(x)
def _sigmoid(x):
    return torch.sigmoid(x)
def _layernorm(x, axis=-1, eps=1e-5):
    m = x.mean(dim=axis, keepdim=True)
    v = x.var(dim=axis, keepdim=True, unbiased=False)
    return (x - m) / torch.sqrt(v + eps)
def _scatter_add(tgt, idx, src, axis=0):
    return tgt.clone().index_add_(axis, idx, src)
def _segment_sum(src, seg, n):
    out = torch.zeros((n,) + src.shape[1:], dtype=src.dtype)
    return out.index_add_(0, seg, src)
def _pad(x, pw):
    flat = tuple(v for pair in reversed(pw) for v in pair)
    return torch.nn.functional.pad(x, flat)

kernel_name = 'standalone__mha_softmax__near_ridge'

def setup_inputs():

    _w = (lambda a: (lambda t: t.to(torch.bfloat16) if t.is_floating_point() else t)(torch.as_tensor(a)))
    B, H, Sq, Sk, D = 8, 32, 608, 1024, 128
    return {
        "q": _w((lambda *s: torch.randn(*s, dtype=torch.bfloat16) * 0.8)(B, H, Sq, D)),
        "k": _w((lambda *s: torch.randn(*s, dtype=torch.bfloat16) * 0.8)(B, H, Sk, D)),
        "v": _w((lambda *s: torch.randn(*s, dtype=torch.bfloat16) * 0.05)(B, H, Sk, D)),
    }

def reference(q, k, v):
    scale = q.shape[-1] ** -0.5
    scores = torch.einsum("bhqd,bhkd->bhqk", q, k) * scale
    p = _softmax(scores, axis=-1)
    return torch.einsum("bhqk,bhkd->bhqd", p, v)
```

```asm
; @launch grid=(256,1,1) block=(256,1,1) lds=163840
.amdgcn_target "amdgcn-amd-amdhsa--gfx950"
.text
.p2align 12
.fill 832, 4, 0xbf810000
.globl standalone__mha_softmax__near_ridge_kernel
.p2align 8
.type standalone__mha_softmax__near_ridge_kernel,@function
standalone__mha_softmax__near_ridge_kernel:
    s_cmp_ge_u32 s2, 256
    s_cbranch_scc1 L_end
    s_load_dwordx4 s[52:55], s[0:1], 0
    s_load_dwordx4 s[56:59], s[0:1], 16
    v_lshrrev_b32 v1, 6, v0
    v_and_b32 v0, 63, v0
    v_readfirstlane_b32 s20, v1
    v_lshlrev_b32 v244, 4, v0
    s_bfe_u32 s21, s2, 0x10003
    s_cmp_lg_u32 s21, 0
    s_cselect_b32 s48, L_role1-L_role0, 0
    s_getpc_b64 s[44:45]
L_pcs:
    s_lshl_b32 s49, s20, 13
    s_add_u32 s48, s48, s49
    s_add_u32 s48, s48, L_role0-L_pcs
    v_lshl_add_u32 v248, v0, 7, s48
    v_min_u32 v248, L_end-L_pcs, v248
    v_mov_b32 v249, s45
    v_add_co_u32 v248, vcc, s44, v248
    s_nop 1
    v_addc_co_u32 v249, vcc, 0, v249, vcc
    global_load_dword a240, v[248:249], off
    s_lshr_b32 s60, s2, 4
    s_lshl_b32 s60, s60, 3
    s_and_b32 s61, s2, 7
    s_add_u32 s60, s60, s61
    s_lshl_b32 s60, s60, 1
    s_add_u32 s61, s60, 1
    s_and_b32 s29, s20, 1
    s_lshl_b32 s50, s60, 18
    s_lshl_b32 s51, s61, 18
    s_lshl_b32 s62, s20, 12
    s_lshr_b32 s63, s2, 4
    s_mul_i32 s63, s63, 81920
    s_and_b32 s64, s2, 7
    s_mul_i32 s64, s64, 36864
    s_add_u32 s63, s63, s64
    s_add_u32 s63, s63, s62
    s_and_b32 s24, s63, 0x3ffff
    s_mov_b32 s25, s50
    s_add_u32 s66, s25, s24
    s_mul_i32 s26, s20, 4224
    s_mul_i32 s63, s20, 20480
    s_add_u32 s62, s63, 12288
    s_lshr_b32 s64, s20, 1
    s_mul_i32 s64, s64, 36864
    s_mul_i32 s65, s29, 20480
    s_add_u32 s65, s65, s64
    s_add_u32 s65, s65, 81920
    s_add_u32 s64, s64, 98304
    s_cmp_eq_u32 s21, 0
    s_cselect_b32 s32, s62, s64
    s_cselect_b32 s30, s63, s65
    s_cselect_b32 s37, s64, s62
    s_cselect_b32 s35, s65, s63
    s_mul_i32 s60, s60, 155648
    s_mul_i32 s61, s61, 155648
    s_add_u32 s32, s32, s60
    s_add_u32 s30, s30, s60
    s_add_u32 s37, s37, s61
    s_add_u32 s35, s35, s61
    s_add_u32 s31, s30, 4096
    s_waitcnt lgkmcnt(0)
    s_mov_b64 s[8:9], s[54:55]
    s_mov_b64 s[4:5], s[52:53]
    s_add_u32 s62, s4, s30
    s_addc_u32 s63, s5, 0
    s_add_u32 m0, s26, 67584
    s_nop 0
    global_load_lds_dwordx4 v244, s[62:63] offset:0 nt
    s_add_u32 m0, s26, 67616
    s_nop 0
    global_load_lds_dwordx4 v244, s[62:63] offset:1024 nt
    s_add_u32 m0, s26, 67648
    s_nop 0
    global_load_lds_dwordx4 v244, s[62:63] offset:2048 nt
    s_add_u32 m0, s26, 67680
    s_nop 0
    global_load_lds_dwordx4 v244, s[62:63] offset:3072 nt
    s_add_u32 s60, s8, s66
    s_addc_u32 s61, s9, 0
    s_add_u32 m0, s26, 0
    s_nop 0
    global_load_lds_dwordx4 v244, s[60:61] offset:0 nt
    s_add_u32 m0, s26, 32
    s_nop 0
    global_load_lds_dwordx4 v244, s[60:61] offset:1024 nt
    s_add_u32 m0, s26, 64
    s_nop 0
    global_load_lds_dwordx4 v244, s[60:61] offset:2048 nt
    s_add_u32 m0, s26, 96
    s_nop 0
    global_load_lds_dwordx4 v244, s[60:61] offset:3072 nt
    s_add_u32 s64, s4, s31
    s_addc_u32 s65, s5, 0
    s_add_u32 m0, s26, 84480
    s_nop 0
    global_load_lds_dwordx4 v244, s[64:65] offset:0 nt
    s_add_u32 m0, s26, 84512
    s_nop 0
    global_load_lds_dwordx4 v244, s[64:65] offset:1024 nt
    s_add_u32 m0, s26, 84544
    s_nop 0
    global_load_lds_dwordx4 v244, s[64:65] offset:2048 nt
    s_add_u32 m0, s26, 84576
    s_nop 0
    global_load_lds_dwordx4 v244, s[64:65] offset:3072 nt
    s_mov_b64 s[12:13], s[56:57]
    s_mov_b64 s[16:17], s[58:59]
    s_mov_b32 s18, 39845888
    s_mov_b32 s19, 0x20000
    s_add_u32 s48, s26, 67584
    s_mul_i32 s28, s20, 15616
    s_add_u32 s28, s28, 101376
    s_add_u32 s33, s30, 8192
    s_lshl_b32 s62, s21, 12
    s_sub_u32 s63, 16384, s62
    s_add_u32 s34, s30, s63
    s_add_u32 s62, s62, 12288
    s_add_u32 s36, s35, 4096
    s_add_u32 s38, s35, 8192
    s_add_u32 s39, s35, s62
    v_and_b32 v1, 15, v0
    v_lshrrev_b32 v2, 4, v0
    v_and_b32 v4, 7, v1
    v_mul_u32_u24 v4, 1056, v4
    v_lshrrev_b32 v6, 3, v1
    v_lshl_add_u32 v4, v6, 8, v4
    v_lshl_add_u32 v4, v2, 4, v4
    s_mul_i32 s62, s29, 8448
    s_sub_u32 s63, 8448, s62
    v_add_u32 v240, s62, v4
    v_add_u32 v241, s63, v4
    v_bfe_u32 v4, v0, 2, 2
    v_mul_u32_u24 v4, 1040, v4
    v_and_b32 v5, 1, v2
    v_mul_u32_u24 v5, 4224, v5
    v_add_u32 v4, v4, v5
    v_lshrrev_b32 v5, 5, v0
    v_lshl_add_u32 v4, v5, 8, v4
    v_bfe_u32 v7, v0, 1, 1
    v_lshl_add_u32 v4, v7, 6, v4
    v_and_b32 v8, 1, v0
    v_lshl_add_u32 v4, v8, 3, v4
    v_and_b32 v6, 3, v0
    v_add_u32 v4, 16896, v4
    v_add_u32 v242, s62, v4
    v_add_u32 v243, s63, v4
    v_mul_u32_u24 v4, 1056, v6
    v_lshrrev_b32 v5, 2, v1
    v_lshl_add_u32 v4, v5, 8, v4
    v_lshl_add_u32 v4, v2, 4, v4
    s_add_u32 s62, s26, 67584
    v_add_u32 v253, s62, v4
    v_lshl_add_u32 v4, v6, 5, v4
    v_add_u32 v245, s28, v4
    v_add_u32 v4, 1, v2
    v_lshrrev_b32 v4, 1, v4
    v_lshlrev_b32 v4, 5, v4
    v_lshl_add_u32 v4, v2, 8, v4
    v_add_u32 v4, s28, v4
    v_lshl_add_u32 v246, v1, 3, v4
    v_lshl_add_u32 v4, v6, 6, v4
    v_lshl_add_u32 v252, v5, 3, v4
    v_and_b32 v4, 1, v0
    v_mov_b32 v6, 0xaaaaaaaa
    v_mul_lo_u32 v4, v4, v6
    v_add_u32 v247, 0x44444444, v4
    v_mov_b32 v4, 0x3f803f80
    s_mov_b32 s40, 0x3e0293ee
    s_mov_b32 s41, 0x3e0293ee
    s_mov_b32 s42, 0x2b800000
    s_mov_b32 s43, 0x28000000
    s_mov_b64 s[44:45], 0
    s_mov_b64 s[46:47], 0
    s_mov_b32 s58, -67584
    s_mov_b32 s59, 33792
    s_mov_b32 s27, 33792
    s_add_u32 s49, s28, 1088
    s_mul_i32 s3, s29, 31232
    s_sub_u32 s3, 15616, s3
    s_add_u32 s56, s4, s35
    s_addc_u32 s57, s5, 0
    v_mov_b32 v5, 0x3f003f00
    v_and_b32 v6, 2, v0
    v_cmp_eq_u32 s[62:63], 0, v6
    s_nop 1
    v_cndmask_b32 v4, 0, v4, s[62:63]
    v_cndmask_b32 v5, 0, v5, s[62:63]
    v_accvgpr_write_b32 a228, v4
    v_accvgpr_write_b32 a232, v5
    v_accvgpr_write_b32 a229, v4
    v_accvgpr_write_b32 a233, v5
    v_accvgpr_write_b32 a230, v4
    v_accvgpr_write_b32 a234, v5
    v_accvgpr_write_b32 a231, v4
    v_accvgpr_write_b32 a235, v5
    v_accvgpr_write_b32 a208, 0
    v_accvgpr_write_b32 a209, 0
    v_accvgpr_write_b32 a210, 0
    v_accvgpr_write_b32 a211, 0
    v_accvgpr_write_b32 a212, 0
    v_accvgpr_write_b32 a213, 0
    v_accvgpr_write_b32 a214, 0
    v_accvgpr_write_b32 a215, 0
    v_accvgpr_write_b32 a216, 0
    v_accvgpr_write_b32 a217, 0
    v_accvgpr_write_b32 a218, 0
    v_accvgpr_write_b32 a219, 0
    v_accvgpr_write_b32 a220, 0
    v_accvgpr_write_b32 a221, 0
    v_accvgpr_write_b32 a222, 0
    v_accvgpr_write_b32 a223, 0
    v_accvgpr_write_b32 a224, 0
    v_accvgpr_write_b32 a225, 0
    v_accvgpr_write_b32 a226, 0
    v_accvgpr_write_b32 a227, 0
    s_mov_b64 exec, 0
    s_lshl_b32 s67, s21, 2
    s_add_u32 s67, s67, s20
    s_cmp_eq_u32 s67, 0
    s_cbranch_scc1 L_pad0_0
    s_cmp_eq_u32 s67, 1
    s_cbranch_scc1 L_pad0_1
    s_cmp_eq_u32 s67, 2
    s_cbranch_scc1 L_pad0_2
    s_cmp_eq_u32 s67, 3
    s_cbranch_scc1 L_pad0_3
    s_cmp_eq_u32 s67, 4
    s_cbranch_scc1 L_pad1_0
    s_cmp_eq_u32 s67, 5
    s_cbranch_scc1 L_pad1_1
    s_cmp_eq_u32 s67, 6
    s_cbranch_scc1 L_pad1_2
    s_branch L_pad1_3
L_ret0:
    s_mov_b64 exec, -1
    s_mov_b64 exec, 0
    s_lshl_b32 s67, s21, 2
    s_add_u32 s67, s67, s20
    s_cmp_eq_u32 s67, 0
    s_cbranch_scc1 L_pad0_4
    s_cmp_eq_u32 s67, 1
    s_cbranch_scc1 L_pad0_5
    s_cmp_eq_u32 s67, 2
    s_cbranch_scc1 L_pad0_6
    s_cmp_eq_u32 s67, 3
    s_cbranch_scc1 L_pad0_7
    s_cmp_eq_u32 s67, 4
    s_cbranch_scc1 L_pad1_4
    s_cmp_eq_u32 s67, 5
    s_cbranch_scc1 L_pad1_5
    s_cmp_eq_u32 s67, 6
    s_cbranch_scc1 L_pad1_6
    s_branch L_pad1_7
L_ret1:
    s_mov_b64 exec, -1
    s_cmp_lg_u32 s21, 0
    s_cbranch_scc1 L_role1
L_role0:
    s_add_u32 s62, s24, 0
    s_and_b32 s62, s62, 0x3ffff
    s_add_u32 s62, s62, s25
    s_add_u32 s6, s12, s62
    s_addc_u32 s7, s13, 0
    s_add_u32 s10, s4, s32
    s_addc_u32 s11, s5, 0
    s_add_u32 s14, s4, s33
    s_addc_u32 s15, s5, 0
    s_add_u32 s62, s24, 16384
    s_and_b32 s62, s62, 0x3ffff
    s_add_u32 s62, s62, s25
    s_add_u32 s60, s8, s62
    s_addc_u32 s61, s9, 0
    s_add_u32 s62, s24, 65536
    s_and_b32 s62, s62, 0x3ffff
    s_add_u32 s62, s62, s25
    s_add_u32 s52, s8, s62
    s_addc_u32 s53, s9, 0
    s_add_u32 s54, s12, s62
    s_addc_u32 s55, s13, 0
    s_waitcnt vmcnt(8)
    ds_read_b128 v[200:203], v253 offset:0
    ds_read_b128 v[204:207], v253 offset:64
    ds_read_b128 v[208:211], v253 offset:128
    ds_read_b128 v[212:215], v253 offset:192
    s_add_u32 m0, s26, 16896
    s_waitcnt lgkmcnt(0)
    global_load_lds_dwordx4 v244, s[6:7] offset:0 nt
    v_lshlrev_b32 v248, 16, v200
    v_and_b32 v249, 0xffff0000, v200
    v_lshlrev_b32 v250, 16, v201
    v_and_b32 v251, 0xffff0000, v201
    v_pk_mul_f32 v[248:249], v[248:249], s[40:41]
    v_pk_mul_f32 v[250:251], v[250:251], s[40:41]
    v_cvt_pk_bf16_f32 v200, v248, v249
    v_cvt_pk_bf16_f32 v201, v250, v251
    v_accvgpr_write_b32 a0, v200
    v_accvgpr_write_b32 a1, v201
    v_lshlrev_b32 v248, 16, v202
    v_and_b32 v249, 0xffff0000, v202
    v_lshlrev_b32 v250, 16, v203
    v_and_b32 v251, 0xffff0000, v203
    v_pk_mul_f32 v[248:249], v[248:249], s[40:41]
    v_pk_mul_f32 v[250:251], v[250:251], s[40:41]
    v_cvt_pk_bf16_f32 v202, v248, v249
    v_cvt_pk_bf16_f32 v203, v250, v251
    v_accvgpr_write_b32 a2, v202
    v_accvgpr_write_b32 a3, v203
    s_add_u32 m0, s26, 16912
    s_nop 0
    global_load_lds_dwordx4 v244, s[6:7] offset:1024 nt
    v_lshlrev_b32 v248, 16, v204
    v_and_b32 v249, 0xffff0000, v204
    v_lshlrev_b32 v250, 16, v205
    v_and_b32 v251, 0xffff0000, v205
    v_pk_mul_f32 v[248:249], v[248:249], s[40:41]
    v_pk_mul_f32 v[250:251], v[250:251], s[40:41]
    v_cvt_pk_bf16_f32 v204, v248, v249
    v_cvt_pk_bf16_f32 v205, v250, v251
    v_accvgpr_write_b32 a4, v204
    v_accvgpr_write_b32 a5, v205
    v_lshlrev_b32 v248, 16, v206
    v_and_b32 v249, 0xffff0000, v206
    v_lshlrev_b32 v250, 16, v207
    v_and_b32 v251, 0xffff0000, v207
    v_pk_mul_f32 v[248:249], v[248:249], s[40:41]
    v_pk_mul_f32 v[250:251], v[250:251], s[40:41]
    v_cvt_pk_bf16_f32 v206, v248, v249
    v_cvt_pk_bf16_f32 v207, v250, v251
    v_accvgpr_write_b32 a6, v206
    v_accvgpr_write_b32 a7, v207
    s_add_u32 m0, s26, 16928
    s_nop 0
    global_load_lds_dwordx4 v244, s[6:7] offset:2048 nt
    v_lshlrev_b32 v248, 16, v208
    v_and_b32 v249, 0xffff0000, v208
    v_lshlrev_b32 v250, 16, v209
    v_and_b32 v251, 0xffff0000, v209
    v_pk_mul_f32 v[248:249], v[248:249], s[40:41]
    v_pk_mul_f32 v[250:251], v[250:251], s[40:41]
    v_cvt_pk_bf16_f32 v208, v248, v249
    v_cvt_pk_bf16_f32 v209, v250, v251
    v_accvgpr_write_b32 a8, v208
    v_accvgpr_write_b32 a9, v209
    v_lshlrev_b32 v248, 16, v210
    v_and_b32 v249, 0xffff0000, v210
    v_lshlrev_b32 v250, 16, v211
    v_and_b32 v251, 0xffff0000, v211
    v_pk_mul_f32 v[248:249], v[248:249], s[40:41]
    v_pk_mul_f32 v[250:251], v[250:251], s[40:41]
    v_cvt_pk_bf16_f32 v210, v248, v249
    v_cvt_pk_bf16_f32 v211, v250, v251
    v_accvgpr_write_b32 a10, v210
    v_accvgpr_write_b32 a11, v211
    s_add_u32 m0, s26, 16944
    s_nop 0
    global_load_lds_dwordx4 v244, s[6:7] offset:3072 nt
    v_lshlrev_b32 v248, 16, v212
    v_and_b32 v249, 0xffff0000, v212
    v_lshlrev_b32 v250, 16, v213
    v_and_b32 v251, 0xffff0000, v213
    v_pk_mul_f32 v[248:249], v[248:249], s[40:41]
    v_pk_mul_f32 v[250:251], v[250:251], s[40:41]
    v_cvt_pk_bf16_f32 v212, v248, v249
    v_cvt_pk_bf16_f32 v213, v250, v251
    v_accvgpr_write_b32 a12, v212
    v_accvgpr_write_b32 a13, v213
    v_lshlrev_b32 v248, 16, v214
    v_and_b32 v249, 0xffff0000, v214
    v_lshlrev_b32 v250, 16, v215
    v_and_b32 v251, 0xffff0000, v215
    v_pk_mul_f32 v[248:249], v[248:249], s[40:41]
    v_pk_mul_f32 v[250:251], v[250:251], s[40:41]
    v_cvt_pk_bf16_f32 v214, v248, v249
    v_cvt_pk_bf16_f32 v215, v250, v251
    v_accvgpr_write_b32 a14, v214
    v_accvgpr_write_b32 a15, v215
    s_waitcnt vmcnt(8)
    s_barrier
    ds_read_b128 a[80:83], v240 offset:0
    ds_read_b128 a[84:87], v240 offset:64
    ds_read_b128 a[88:91], v240 offset:128
    ds_read_b128 a[92:95], v240 offset:192
    ds_read_b128 a[96:99], v240 offset:704
    ds_read_b128 a[100:103], v240 offset:640
    ds_read_b128 a[104:107], v240 offset:576
    ds_read_b128 a[108:111], v240 offset:512
    ds_read_b128 a[112:115], v241 offset:0
    ds_read_b128 a[116:119], v241 offset:64
    ds_read_b128 a[120:123], v241 offset:128
    ds_read_b128 a[124:127], v241 offset:192
    ds_read_b128 a[128:131], v241 offset:704
    ds_read_b128 a[132:135], v241 offset:640
    ds_read_b128 a[136:139], v241 offset:576
    ds_read_b128 a[140:143], v241 offset:512
    s_waitcnt lgkmcnt(12)
    v_mfma_f32_16x16x32_bf16 v[160:163], a[80:83], a[0:3], -4.0
    s_add_u32 m0, s28, 1088
    v_mfma_f32_16x16x32_bf16 v[160:163], a[84:87], a[4:7], v[160:163]
    global_load_lds_dwordx4 v244, s[10:11] offset:0 nt
    v_mfma_f32_16x16x32_bf16 v[160:163], a[88:91], a[8:11], v[160:163]
    v_mfma_f32_16x16x32_bf16 v[160:163], a[92:95], a[12:15], v[160:163]
    s_waitcnt lgkmcnt(8)
    v_mfma_f32_16x16x32_bf16 v[164:167], a[96:99], a[12:15], -4.0
    s_add_u32 m0, s28, 1152
    v_mfma_f32_16x16x32_bf16 v[164:167], a[100:103], a[8:11], v[164:167]
    global_load_lds_dwordx4 v244, s[10:11] offset:1024 nt
    v_mfma_f32_16x16x32_bf16 v[164:167], a[104:107], a[4:7], v[164:167]
    v_mfma_f32_16x16x32_bf16 v[164:167], a[108:111], a[0:3], v[164:167]
    s_waitcnt lgkmcnt(4)
    v_mfma_f32_16x16x32_bf16 v[168:171], a[112:115], a[0:3], -4.0
    s_add_u32 m0, s28, 1216
    v_mfma_f32_16x16x32_bf16 v[168:171], a[116:119], a[4:7], v[168:171]
    global_load_lds_dwordx4 v244, s[10:11] offset:2048 nt
    v_mfma_f32_16x16x32_bf16 v[168:171], a[120:123], a[8:11], v[168:171]
    v_mfma_f32_16x16x32_bf16 v[168:171], a[124:127], a[12:15], v[168:171]
    s_waitcnt lgkmcnt(0)
    v_mfma_f32_16x16x32_bf16 v[172:175], a[128:131], a[12:15], -4.0
    s_add_u32 m0, s28, 1280
    v_mfma_f32_16x16x32_bf16 v[172:175], a[132:135], a[8:11], v[172:175]
    global_load_lds_dwordx4 v244, s[10:11] offset:3072 nt
    v_mfma_f32_16x16x32_bf16 v[172:175], a[136:139], a[4:7], v[172:175]
    v_mfma_f32_16x16x32_bf16 v[172:175], a[140:143], a[0:3], v[172:175]
    s_nop 3
    v_exp_f32 v160, v160
    v_exp_f32 v161, v161
    v_exp_f32 v162, v162
    v_exp_f32 v163, v163
    s_nop 0
    v_cvt_pk_bf16_f32 v176, v160, v161
    v_cvt_pk_bf16_f32 v177, v162, v163
    v_exp_f32 v164, v164
    v_exp_f32 v165, v165
    v_exp_f32 v166, v166
    v_exp_f32 v167, v167
    s_nop 0
    v_cvt_pk_bf16_f32 v178, v164, v165
    v_cvt_pk_bf16_f32 v179, v166, v167
    v_exp_f32 v168, v168
    v_exp_f32 v169, v169
    v_exp_f32 v170, v170
    v_exp_f32 v171, v171
    v_exp_f32 v172, v172
    v_exp_f32 v173, v173
    v_exp_f32 v174, v174
    v_exp_f32 v175, v175
    s_waitcnt vmcnt(8)
    ds_read_b128 v[200:203], v253 offset:16896
    ds_read_b128 v[204:207], v253 offset:16960
    ds_read_b128 v[208:211], v253 offset:17024
    ds_read_b128 v[212:215], v253 offset:17088
    s_add_u32 m0, s28, 5440
    s_waitcnt lgkmcnt(0)
    global_load_lds_dwordx4 v244, s[14:15] offset:0 nt
    v_lshlrev_b32 v248, 16, v200
    v_and_b32 v249, 0xffff0000, v200
    v_lshlrev_b32 v250, 16, v201
    v_and_b32 v251, 0xffff0000, v201
    v_pk_mul_f32 v[248:249], v[248:249], s[40:41]
    v_pk_mul_f32 v[250:251], v[250:251], s[40:41]
    v_cvt_pk_bf16_f32 v200, v248, v249
    v_cvt_pk_bf16_f32 v201, v250, v251
    v_accvgpr_write_b32 a16, v200
    v_accvgpr_write_b32 a17, v201
    v_lshlrev_b32 v248, 16, v202
    v_and_b32 v249, 0xffff0000, v202
    v_lshlrev_b32 v250, 16, v203
    v_and_b32 v251, 0xffff0000, v203
    v_pk_mul_f32 v[248:249], v[248:249], s[40:41]
    v_pk_mul_f32 v[250:251], v[250:251], s[40:41]
    v_cvt_pk_bf16_f32 v202, v248, v249
    v_cvt_pk_bf16_f32 v203, v250, v251
    v_accvgpr_write_b32 a18, v202
    v_accvgpr_write_b32 a19, v203
    s_add_u32 m0, s28, 5504
    s_nop 0
    global_load_lds_dwordx4 v244, s[14:15] offset:1024 nt
    v_lshlrev_b32 v248, 16, v204
    v_and_b32 v249, 0xffff0000, v204
    v_lshlrev_b32 v250, 16, v205
    v_and_b32 v251, 0xffff0000, v205
    v_pk_mul_f32 v[248:249], v[248:249], s[40:41]
    v_pk_mul_f32 v[250:251], v[250:251], s[40:41]
    v_cvt_pk_bf16_f32 v204, v248, v249
    v_cvt_pk_bf16_f32 v205, v250, v251
    v_accvgpr_write_b32 a20, v204
    v_accvgpr_write_b32 a21, v205
    v_lshlrev_b32 v248, 16, v206
    v_and_b32 v249, 0xffff0000, v206
    v_lshlrev_b32 v250, 16, v207
    v_and_b32 v251, 0xffff0000, v207
    v_pk_mul_f32 v[248:249], v[248:249], s[40:41]
    v_pk_mul_f32 v[250:251], v[250:251], s[40:41]
    v_cvt_pk_bf16_f32 v206, v248, v249
    v_cvt_pk_bf16_f32 v207, v250, v251
    v_accvgpr_write_b32 a22, v206
    v_accvgpr_write_b32 a23, v207
    s_add_u32 m0, s28, 5568
    s_nop 0
    global_load_lds_dwordx4 v244, s[14:15] offset:2048 nt
    v_lshlrev_b32 v248, 16, v208
    v_and_b32 v249, 0xffff0000, v208
    v_lshlrev_b32 v250, 16, v209
    v_and_b32 v251, 0xffff0000, v209
    v_pk_mul_f32 v[248:249], v[248:249], s[40:41]
    v_pk_mul_f32 v[250:251], v[250:251], s[40:41]
    v_cvt_pk_bf16_f32 v208, v248, v249
    v_cvt_pk_bf16_f32 v209, v250, v251
    v_accvgpr_write_b32 a24, v208
    v_accvgpr_write_b32 a25, v209
    v_lshlrev_b32 v248, 16, v210
    v_and_b32 v249, 0xffff0000, v210
    v_lshlrev_b32 v250, 16, v211
    v_and_b32 v251, 0xffff0000, v211
    v_pk_mul_f32 v[248:249], v[248:249], s[40:41]
    v_pk_mul_f32 v[250:251], v[250:251], s[40:41]
    v_cvt_pk_bf16_f32 v210, v248, v249
    v_cvt_pk_bf16_f32 v211, v250, v251
    v_accvgpr_write_b32 a26, v210
    v_accvgpr_write_b32 a27, v211
    s_add_u32 m0, s28, 5632
    s_nop 0
    global_load_lds_dwordx4 v244, s[14:15] offset:3072 nt
    v_lshlrev_b32 v248, 16, v212
    v_and_b32 v249, 0xffff0000, v212
    v_lshlrev_b32 v250, 16, v213
    v_and_b32 v251, 0xffff0000, v213
    v_pk_mul_f32 v[248:249], v[248:249], s[40:41]
    v_pk_mul_f32 v[250:251], v[250:251], s[40:41]
    v_cvt_pk_bf16_f32 v212, v248, v249
    v_cvt_pk_bf16_f32 v213, v250, v251
    v_accvgpr_write_b32 a28, v212
    v_accvgpr_write_b32 a29, v213
    v_lshlrev_b32 v248, 16, v214
    v_and_b32 v249, 0xffff0000, v214
    v_lshlrev_b32 v250, 16, v215
    v_and_b32 v251, 0xffff0000, v215
    v_pk_mul_f32 v[248:249], v[248:249], s[40:41]
    v_pk_mul_f32 v[250:251], v[250:251], s[40:41]
    v_cvt_pk_bf16_f32 v214, v248, v249
    v_cvt_pk_bf16_f32 v215, v250, v251
    v_accvgpr_write_b32 a30, v214
    v_accvgpr_write_b32 a31, v215
    s_add_u32 s6, s4, s34
    s_addc_u32 s7, s5, 0
    s_add_u32 s62, s24, 16384
    s_and_b32 s62, s62, 0x3ffff
    s_add_u32 s62, s62, s25
    s_add_u32 s10, s12, s62
    s_addc_u32 s11, s13, 0
    s_add_u32 s62, s24, 32768
    s_and_b32 s62, s62, 0x3ffff
    s_add_u32 s62, s62, s25
    s_add_u32 s14, s8, s62
    s_addc_u32 s15, s9, 0
    s_waitcnt vmcnt(8)
    s_barrier
    ds_read_b64_tr_b16 a[144:145], v242 offset:0
    ds_read_b64_tr_b16 a[146:147], v242 offset:512
    ds_read_b64_tr_b16 a[176:177], v243 offset:0
    ds_read_b64_tr_b16 a[178:179], v243 offset:512
    ds_read_b64_tr_b16 a[148:149], v242 offset:16
    ds_read_b64_tr_b16 a[150:151], v242 offset:528
    ds_read_b64_tr_b16 a[180:181], v243 offset:16
    ds_read_b64_tr_b16 a[182:183], v243 offset:528
    ds_read_b64_tr_b16 a[152:153], v242 offset:32
    ds_read_b64_tr_b16 a[154:155], v242 offset:544
    ds_read_b64_tr_b16 a[184:185], v243 offset:32
    ds_read_b64_tr_b16 a[186:187], v243 offset:544
    ds_read_b64_tr_b16 a[156:157], v242 offset:48
    ds_read_b64_tr_b16 a[158:159], v242 offset:560
    ds_read_b64_tr_b16 a[188:189], v243 offset:48
    ds_read_b64_tr_b16 a[190:191], v243 offset:560
    v_mfma_f32_16x16x32_bf16 v[160:163], a[80:83], a[16:19], -4.0
    s_add_u32 m0, s26, 33792
    ds_read_b64_tr_b16 a[160:161], v242 offset:128
    ds_read_b64_tr_b16 a[162:163], v242 offset:640
    v_mfma_f32_16x16x32_bf16 v[160:163], a[84:87], a[20:23], v[160:163]
    global_load_lds_dwordx4 v244, s[60:61] offset:0 nt
    v_cvt_pk_bf16_f32 v180, v168, v169
    v_cvt_pk_bf16_f32 v181, v170, v171
    v_mfma_f32_16x16x32_bf16 v[160:163], a[88:91], a[24:27], v[160:163]
    ds_read_b64_tr_b16 a[192:193], v243 offset:128
    ds_read_b64_tr_b16 a[194:195], v243 offset:640
    v_mfma_f32_16x16x32_bf16 v[160:163], a[92:95], a[28:31], v[160:163]
    s_add_u32 m0, s26, 33824
    v_cvt_pk_bf16_f32 v182, v172, v173
    v_cvt_pk_bf16_f32 v183, v174, v175
    v_mfma_f32_16x16x32_bf16 v[164:167], a[96:99], a[28:31], -4.0
    ds_read_b64_tr_b16 a[164:165], v242 offset:144
    ds_read_b64_tr_b16 a[166:167], v242 offset:656
    v_mfma_f32_16x16x32_bf16 v[164:167], a[100:103], a[24:27], v[164:167]
    global_load_lds_dwordx4 v244, s[60:61] offset:1024 nt
    v_mfma_f32_16x16x32_bf16 v[164:167], a[104:107], a[20:23], v[164:167]
    ds_read_b64_tr_b16 a[196:197], v243 offset:144
    ds_read_b64_tr_b16 a[198:199], v243 offset:656
    v_mfma_f32_16x16x32_bf16 v[164:167], a[108:111], a[16:19], v[164:167]
    s_add_u32 m0, s26, 33856
    v_exp_f32 v160, v160
    v_mfma_f32_16x16x32_bf16 v[168:171], a[112:115], a[16:19], -4.0
    ds_read_b64_tr_b16 a[168:169], v242 offset:160
    ds_read_b64_tr_b16 a[170:171], v242 offset:672
    global_load_lds_dwordx4 v244, s[60:61] offset:2048 nt
    v_mfma_f32_16x16x32_bf16 v[168:171], a[116:119], a[20:23], v[168:171]
    v_exp_f32 v161, v161
    v_mfma_f32_16x16x32_bf16 v[168:171], a[120:123], a[24:27], v[168:171]
    s_add_u32 m0, s26, 33888
    ds_read_b64_tr_b16 a[200:201], v243 offset:160
    ds_read_b64_tr_b16 a[202:203], v243 offset:672
    v_mfma_f32_16x16x32_bf16 v[168:171], a[124:127], a[28:31], v[168:171]
    global_load_lds_dwordx4 v244, s[60:61] offset:3072 nt
    v_exp_f32 v162, v162
    v_mfma_f32_16x16x32_bf16 v[172:175], a[128:131], a[28:31], -4.0
    ds_read_b64_tr_b16 a[172:173], v242 offset:176
    ds_read_b64_tr_b16 a[174:175], v242 offset:688
    v_mfma_f32_16x16x32_bf16 v[172:175], a[132:135], a[24:27], v[172:175]
    v_exp_f32 v163, v163
    v_mfma_f32_16x16x32_bf16 v[172:175], a[136:139], a[20:23], v[172:175]
    ds_read_b64_tr_b16 a[204:205], v243 offset:176
    ds_read_b64_tr_b16 a[206:207], v243 offset:688
    v_mfma_f32_16x16x32_bf16 v[172:175], a[140:143], a[16:19], v[172:175]
    s_waitcnt lgkmcnt(8)
    v_cvt_pk_bf16_f32 v184, v160, v161
    v_cvt_pk_bf16_f32 v185, v162, v163
    v_mfma_f32_16x16x32_bf16 v[0:3], v[176:179], a[144:147], 0
    v_exp_f32 v164, v164
    v_mfma_f32_16x16x32_bf16 v[0:3], v[180:183], a[176:179], v[0:3]
    v_exp_f32 v165, v165
    v_mfma_f32_16x16x32_bf16 v[4:7], v[176:179], a[148:151], 0
    v_exp_f32 v166, v166
    v_mfma_f32_16x16x32_bf16 v[4:7], v[180:183], a[180:183], v[4:7]
    v_exp_f32 v167, v167
    v_mfma_f32_16x16x32_bf16 v[8:11], v[176:179], a[152:155], 0
L_pad0_0:
    s_cbranch_execz L_ret0
    v_cvt_pk_bf16_f32 v186, v164, v165
    v_cvt_pk_bf16_f32 v187, v166, v167
    v_mfma_f32_16x16x32_bf16 v[8:11], v[180:183], a[184:187], v[8:11]
    v_exp_f32 v168, v168
    v_mfma_f32_16x16x32_bf16 v[12:15], v[176:179], a[156:159], 0
    v_exp_f32 v169, v169
    v_mfma_f32_16x16x32_bf16 v[12:15], v[180:183], a[188:191], v[12:15]
    v_exp_f32 v170, v170
    v_mfma_f32_16x16x32_bf16 v[16:19], v[176:179], a[160:163], 0
    v_exp_f32 v171, v171
    v_mfma_f32_16x16x32_bf16 v[16:19], v[180:183], a[192:195], v[16:19]
    v_cvt_pk_bf16_f32 v188, v168, v169
    v_cvt_pk_bf16_f32 v189, v170, v171
    v_mfma_f32_16x16x32_bf16 v[20:23], v[176:179], a[164:167], 0
    v_exp_f32 v172, v172
    v_mfma_f32_16x16x32_bf16 v[20:23], v[180:183], a[196:199], v[20:23]
    s_waitcnt lgkmcnt(0)
    v_exp_f32 v173, v173
    v_mfma_f32_16x16x32_bf16 v[24:27], v[176:179], a[168:171], 0
    v_exp_f32 v174, v174
    v_mfma_f32_16x16x32_bf16 v[24:27], v[180:183], a[200:203], v[24:27]
    v_exp_f32 v175, v175
    v_mfma_f32_16x16x32_bf16 v[28:31], v[176:179], a[172:175], 0
    v_cvt_pk_bf16_f32 v190, v172, v173
    v_cvt_pk_bf16_f32 v191, v174, v175
    v_mfma_f32_16x16x32_bf16 v[28:31], v[180:183], a[204:207], v[28:31]
    v_smfmac_f32_16x16x64_bf16 a[208:211], a[228:231], v[176:183], v247
    s_add_u32 s62, s24, 32768
    s_and_b32 s62, s62, 0x3ffff
    s_add_u32 s62, s62, s25
    s_add_u32 s60, s12, s62
    s_addc_u32 s61, s13, 0
    s_waitcnt vmcnt(8)
    ds_read_b128 v[200:203], v245 offset:1088
    ds_read_b128 v[204:207], v245 offset:1152
    ds_read_b128 v[208:211], v245 offset:1216
    ds_read_b128 v[212:215], v245 offset:1280
    s_add_u32 m0, s28, 9792
    s_waitcnt lgkmcnt(0)
    global_load_lds_dwordx4 v244, s[6:7] offset:0 nt
    v_lshlrev_b32 v248, 16, v200
    v_and_b32 v249, 0xffff0000, v200
    v_lshlrev_b32 v250, 16, v201
    v_and_b32 v251, 0xffff0000, v201
    v_pk_mul_f32 v[248:249], v[248:249], s[40:41]
    v_pk_mul_f32 v[250:251], v[250:251], s[40:41]
    v_cvt_pk_bf16_f32 v200, v248, v249
    v_cvt_pk_bf16_f32 v201, v250, v251
    v_accvgpr_write_b32 a32, v200
    v_accvgpr_write_b32 a33, v201
    v_lshlrev_b32 v248, 16, v202
    v_and_b32 v249, 0xffff0000, v202
    v_lshlrev_b32 v250, 16, v203
    v_and_b32 v251, 0xffff0000, v203
    v_pk_mul_f32 v[248:249], v[248:249], s[40:41]
    v_pk_mul_f32 v[250:251], v[250:251], s[40:41]
    v_cvt_pk_bf16_f32 v202, v248, v249
    v_cvt_pk_bf16_f32 v203, v250, v251
    v_accvgpr_write_b32 a34, v202
    v_accvgpr_write_b32 a35, v203
    s_add_u32 m0, s28, 9856
    s_nop 0
    global_load_lds_dwordx4 v244, s[6:7] offset:1024 nt
    v_lshlrev_b32 v248, 16, v204
    v_and_b32 v249, 0xffff0000, v204
    v_lshlrev_b32 v250, 16, v205
    v_and_b32 v251, 0xffff0000, v205
    v_pk_mul_f32 v[248:249], v[248:249], s[40:41]
    v_pk_mul_f32 v[250:251], v[250:251], s[40:41]
    v_cvt_pk_bf16_f32 v204, v248, v249
    v_cvt_pk_bf16_f32 v205, v250, v251
    v_accvgpr_write_b32 a36, v204
    v_accvgpr_write_b32 a37, v205
    v_lshlrev_b32 v248, 16, v206
    v_and_b32 v249, 0xffff0000, v206
    v_lshlrev_b32 v250, 16, v207
    v_and_b32 v251, 0xffff0000, v207
    v_pk_mul_f32 v[248:249], v[248:249], s[40:41]
    v_pk_mul_f32 v[250:251], v[250:251], s[40:41]
    v_cvt_pk_bf16_f32 v206, v248, v249
    v_cvt_pk_bf16_f32 v207, v250, v251
    v_accvgpr_write_b32 a38, v206
    v_accvgpr_write_b32 a39, v207
    s_add_u32 m0, s28, 9920
    s_nop 0
    global_load_lds_dwordx4 v244, s[6:7] offset:2048 nt
    v_lshlrev_b32 v248, 16, v208
    v_and_b32 v249, 0xffff0000, v208
    v_lshlrev_b32 v250, 16, v209
    v_and_b32 v251, 0xffff0000, v209
    v_pk_mul_f32 v[248:249], v[248:249], s[40:41]
    v_pk_mul_f32 v[250:251], v[250:251], s[40:41]
    v_cvt_pk_bf16_f32 v208, v248, v249
    v_cvt_pk_bf16_f32 v209, v250, v251
    v_accvgpr_write_b32 a40, v208
    v_accvgpr_write_b32 a41, v209
    v_lshlrev_b32 v248, 16, v210
    v_and_b32 v249, 0xffff0000, v210
    v_lshlrev_b32 v250, 16, v211
    v_and_b32 v251, 0xffff0000, v211
    v_pk_mul_f32 v[248:249], v[248:249], s[40:41]
    v_pk_mul_f32 v[250:251], v[250:251], s[40:41]
    v_cvt_pk_bf16_f32 v210, v248, v249
    v_cvt_pk_bf16_f32 v211, v250, v251
    v_accvgpr_write_b32 a42, v210
    v_accvgpr_write_b32 a43, v211
    s_add_u32 m0, s28, 9984
    s_nop 0
    global_load_lds_dwordx4 v244, s[6:7] offset:3072 nt
    v_lshlrev_b32 v248, 16, v212
    v_and_b32 v249, 0xffff0000, v212
    v_lshlrev_b32 v250, 16, v213
    v_and_b32 v251, 0xffff0000, v213
    v_pk_mul_f32 v[248:249], v[248:249], s[40:41]
    v_pk_mul_f32 v[250:251], v[250:251], s[40:41]
    v_cvt_pk_bf16_f32 v212, v248, v249
    v_cvt_pk_bf16_f32 v213, v250, v251
    v_accvgpr_write_b32 a44, v212
    v_accvgpr_write_b32 a45, v213
    v_lshlrev_b32 v248, 16, v214
    v_and_b32 v249, 0xffff0000, v214
    v_lshlrev_b32 v250, 16, v215
    v_and_b32 v251, 0xffff0000, v215
    v_pk_mul_f32 v[248:249], v[248:249], s[40:41]
    v_pk_mul_f32 v[250:251], v[250:251], s[40:41]
    v_cvt_pk_bf16_f32 v214, v248, v249
    v_cvt_pk_bf16_f32 v215, v250, v251
    v_accvgpr_write_b32 a46, v214
    v_accvgpr_write_b32 a47, v215
    s_nop 0
    v_mfma_f32_16x16x32_bf16 v[160:163], a[80:83], a[32:35], -4.0
    v_add_u32 v240, s27, v240
    v_mfma_f32_16x16x32_bf16 v[160:163], a[84:87], a[36:39], v[160:163]
    v_mfma_f32_16x16x32_bf16 v[160:163], a[88:91], a[40:43], v[160:163]
    v_add_u32 v241, s27, v241
    v_mfma_f32_16x16x32_bf16 v[160:163], a[92:95], a[44:47], v[160:163]
    v_mfma_f32_16x16x32_bf16 v[164:167], a[96:99], a[44:47], -4.0
    v_add_u32 v242, s27, v242
    v_mfma_f32_16x16x32_bf16 v[164:167], a[100:103], a[40:43], v[164:167]
    v_mfma_f32_16x16x32_bf16 v[164:167], a[104:107], a[36:39], v[164:167]
    v_exp_f32 v160, v160
    v_mfma_f32_16x16x32_bf16 v[164:167], a[108:111], a[32:35], v[164:167]
    v_exp_f32 v161, v161
    v_mfma_f32_16x16x32_bf16 v[168:171], a[112:115], a[32:35], -4.0
    v_exp_f32 v162, v162
    v_mfma_f32_16x16x32_bf16 v[168:171], a[116:119], a[36:39], v[168:171]
    v_exp_f32 v163, v163
    v_mfma_f32_16x16x32_bf16 v[168:171], a[120:123], a[40:43], v[168:171]
    v_cvt_pk_bf16_f32 v176, v160, v161
    v_cvt_pk_bf16_f32 v177, v162, v163
    v_mfma_f32_16x16x32_bf16 v[168:171], a[124:127], a[44:47], v[168:171]
    v_exp_f32 v164, v164
    v_mfma_f32_16x16x32_bf16 v[172:175], a[128:131], a[44:47], -4.0
    v_exp_f32 v165, v165
    v_mfma_f32_16x16x32_bf16 v[172:175], a[132:135], a[40:43], v[172:175]
    v_exp_f32 v166, v166
    v_mfma_f32_16x16x32_bf16 v[172:175], a[136:139], a[36:39], v[172:175]
    v_exp_f32 v167, v167
    v_mfma_f32_16x16x32_bf16 v[172:175], a[140:143], a[32:35], v[172:175]
    v_cvt_pk_bf16_f32 v178, v164, v165
    v_cvt_pk_bf16_f32 v179, v166, v167
    v_mfma_f32_16x16x32_bf16 v[32:35], v[184:187], a[144:147], 0
    v_exp_f32 v168, v168
    v_mfma_f32_16x16x32_bf16 v[32:35], v[188:191], a[176:179], v[32:35]
    v_exp_f32 v169, v169
    v_mfma_f32_16x16x32_bf16 v[36:39], v[184:187], a[148:151], 0
    v_exp_f32 v170, v170
    v_mfma_f32_16x16x32_bf16 v[36:39], v[188:191], a[180:183], v[36:39]
    v_exp_f32 v171, v171
    v_mfma_f32_16x16x32_bf16 v[40:43], v[184:187], a[152:155], 0
    v_cvt_pk_bf16_f32 v180, v168, v169
    v_cvt_pk_bf16_f32 v181, v170, v171
    v_mfma_f32_16x16x32_bf16 v[40:43], v[188:191], a[184:187], v[40:43]
    v_exp_f32 v172, v172
    v_mfma_f32_16x16x32_bf16 v[44:47], v[184:187], a[156:159], 0
    v_exp_f32 v173, v173
    v_mfma_f32_16x16x32_bf16 v[44:47], v[188:191], a[188:191], v[44:47]
    v_exp_f32 v174, v174
    v_mfma_f32_16x16x32_bf16 v[48:51], v[184:187], a[160:163], 0
    v_exp_f32 v175, v175
    v_mfma_f32_16x16x32_bf16 v[48:51], v[188:191], a[192:195], v[48:51]
    v_cvt_pk_bf16_f32 v182, v172, v173
    v_cvt_pk_bf16_f32 v183, v174, v175
    v_mfma_f32_16x16x32_bf16 v[52:55], v[184:187], a[164:167], 0
    v_add_u32 v243, s27, v243
    v_mfma_f32_16x16x32_bf16 v[52:55], v[188:191], a[196:199], v[52:55]
    v_mfma_f32_16x16x32_bf16 v[56:59], v[184:187], a[168:171], 0
    v_mfma_f32_16x16x32_bf16 v[56:59], v[188:191], a[200:203], v[56:59]
    v_lshrrev_b32 v254, 2, v244
    v_add_u32 v254, s28, v254
    v_mfma_f32_16x16x32_bf16 v[60:63], v[184:187], a[172:175], 0
    v_mfma_f32_16x16x32_bf16 v[60:63], v[188:191], a[204:207], v[60:63]
    v_smfmac_f32_16x16x64_bf16 a[212:215], a[228:231], v[184:191], v247
    s_add_u32 s62, s24, 49152
    s_and_b32 s62, s62, 0x3ffff
    s_add_u32 s62, s62, s25
    s_add_u32 s6, s8, s62
    s_addc_u32 s7, s9, 0
    s_waitcnt vmcnt(8)
    ds_read_b128 v[200:203], v245 offset:5440
    ds_read_b128 v[204:207], v245 offset:5504
    ds_read_b128 v[208:211], v245 offset:5568
    ds_read_b128 v[212:215], v245 offset:5632
    s_add_u32 m0, s26, 50688
    s_waitcnt lgkmcnt(0)
    global_load_lds_dwordx4 v244, s[10:11] offset:0 nt
    v_lshlrev_b32 v248, 16, v200
    v_and_b32 v249, 0xffff0000, v200
    v_lshlrev_b32 v250, 16, v201
    v_and_b32 v251, 0xffff0000, v201
    v_pk_mul_f32 v[248:249], v[248:249], s[40:41]
    v_pk_mul_f32 v[250:251], v[250:251], s[40:41]
    v_cvt_pk_bf16_f32 v200, v248, v249
    v_cvt_pk_bf16_f32 v201, v250, v251
    v_accvgpr_write_b32 a48, v200
    v_accvgpr_write_b32 a49, v201
    v_lshlrev_b32 v248, 16, v202
    v_and_b32 v249, 0xffff0000, v202
    v_lshlrev_b32 v250, 16, v203
    v_and_b32 v251, 0xffff0000, v203
    v_pk_mul_f32 v[248:249], v[248:249], s[40:41]
    v_pk_mul_f32 v[250:251], v[250:251], s[40:41]
    v_cvt_pk_bf16_f32 v202, v248, v249
    v_cvt_pk_bf16_f32 v203, v250, v251
    v_accvgpr_write_b32 a50, v202
    v_accvgpr_write_b32 a51, v203
    s_add_u32 m0, s26, 50704
    s_nop 0
    global_load_lds_dwordx4 v244, s[10:11] offset:1024 nt
    v_lshlrev_b32 v248, 16, v204
    v_and_b32 v249, 0xffff0000, v204
    v_lshlrev_b32 v250, 16, v205
    v_and_b32 v251, 0xffff0000, v205
    v_pk_mul_f32 v[248:249], v[248:249], s[40:41]
    v_pk_mul_f32 v[250:251], v[250:251], s[40:41]
    v_cvt_pk_bf16_f32 v204, v248, v249
    v_cvt_pk_bf16_f32 v205, v250, v251
    v_accvgpr_write_b32 a52, v204
    v_accvgpr_write_b32 a53, v205
    v_lshlrev_b32 v248, 16, v206
    v_and_b32 v249, 0xffff0000, v206
    v_lshlrev_b32 v250, 16, v207
    v_and_b32 v251, 0xffff0000, v207
    v_pk_mul_f32 v[248:249], v[248:249], s[40:41]
    v_pk_mul_f32 v[250:251], v[250:251], s[40:41]
    v_cvt_pk_bf16_f32 v206, v248, v249
    v_cvt_pk_bf16_f32 v207, v250, v251
    v_accvgpr_write_b32 a54, v206
    v_accvgpr_write_b32 a55, v207
    s_add_u32 m0, s26, 50720
    s_nop 0
    global_load_lds_dwordx4 v244, s[10:11] offset:2048 nt
    v_lshlrev_b32 v248, 16, v208
    v_and_b32 v249, 0xffff0000, v208
    v_lshlrev_b32 v250, 16, v209
    v_and_b32 v251, 0xffff0000, v209
    v_pk_mul_f32 v[248:249], v[248:249], s[40:41]
    v_pk_mul_f32 v[250:251], v[250:251], s[40:41]
    v_cvt_pk_bf16_f32 v208, v248, v249
    v_cvt_pk_bf16_f32 v209, v250, v251
    v_accvgpr_write_b32 a56, v208
    v_accvgpr_write_b32 a57, v209
    v_lshlrev_b32 v248, 16, v210
    v_and_b32 v249, 0xffff0000, v210
    v_lshlrev_b32 v250, 16, v211
    v_and_b32 v251, 0xffff0000, v211
    v_pk_mul_f32 v[248:249], v[248:249], s[40:41]
    v_pk_mul_f32 v[250:251], v[250:251], s[40:41]
    v_cvt_pk_bf16_f32 v210, v248, v249
    v_cvt_pk_bf16_f32 v211, v250, v251
    v_accvgpr_write_b32 a58, v210
    v_accvgpr_write_b32 a59, v211
    s_add_u32 m0, s26, 50736
    s_nop 0
    global_load_lds_dwordx4 v244, s[10:11] offset:3072 nt
    v_lshlrev_b32 v248, 16, v212
    v_and_b32 v249, 0xffff0000, v212
    v_lshlrev_b32 v250, 16, v213
    v_and_b32 v251, 0xffff0000, v213
    v_pk_mul_f32 v[248:249], v[248:249], s[40:41]
    v_pk_mul_f32 v[250:251], v[250:251], s[40:41]
    v_cvt_pk_bf16_f32 v212, v248, v249
    v_cvt_pk_bf16_f32 v213, v250, v251
    v_accvgpr_write_b32 a60, v212
    v_accvgpr_write_b32 a61, v213
    v_lshlrev_b32 v248, 16, v214
    v_and_b32 v249, 0xffff0000, v214
    v_lshlrev_b32 v250, 16, v215
    v_and_b32 v251, 0xffff0000, v215
    v_pk_mul_f32 v[248:249], v[248:249], s[40:41]
    v_pk_mul_f32 v[250:251], v[250:251], s[40:41]
    v_cvt_pk_bf16_f32 v214, v248, v249
    v_cvt_pk_bf16_f32 v215, v250, v251
    v_accvgpr_write_b32 a62, v214
    v_accvgpr_write_b32 a63, v215
    s_nop 0
    v_mfma_f32_16x16x32_bf16 v[160:163], a[80:83], a[48:51], -4.0
    v_mfma_f32_16x16x32_bf16 v[160:163], a[84:87], a[52:55], v[160:163]
    v_mfma_f32_16x16x32_bf16 v[160:163], a[88:91], a[56:59], v[160:163]
    v_mfma_f32_16x16x32_bf16 v[160:163], a[92:95], a[60:63], v[160:163]
    v_mfma_f32_16x16x32_bf16 v[164:167], a[96:99], a[60:63], -4.0
    v_mfma_f32_16x16x32_bf16 v[164:167], a[100:103], a[56:59], v[164:167]
    v_mfma_f32_16x16x32_bf16 v[164:167], a[104:107], a[52:55], v[164:167]
    v_exp_f32 v160, v160
    v_mfma_f32_16x16x32_bf16 v[164:167], a[108:111], a[48:51], v[164:167]
    v_exp_f32 v161, v161
    v_mfma_f32_16x16x32_bf16 v[168:171], a[112:115], a[48:51], -4.0
    v_exp_f32 v162, v162
    v_mfma_f32_16x16x32_bf16 v[168:171], a[116:119], a[52:55], v[168:171]
    v_exp_f32 v163, v163
    v_mfma_f32_16x16x32_bf16 v[168:171], a[120:123], a[56:59], v[168:171]
    v_cvt_pk_bf16_f32 v184, v160, v161
    v_cvt_pk_bf16_f32 v185, v162, v163
    v_mfma_f32_16x16x32_bf16 v[168:171], a[124:127], a[60:63], v[168:171]
    v_exp_f32 v164, v164
    v_mfma_f32_16x16x32_bf16 v[172:175], a[128:131], a[60:63], -4.0
    v_exp_f32 v165, v165
    v_mfma_f32_16x16x32_bf16 v[172:175], a[132:135], a[56:59], v[172:175]
    v_exp_f32 v166, v166
    v_mfma_f32_16x16x32_bf16 v[172:175], a[136:139], a[52:55], v[172:175]
    v_exp_f32 v167, v167
    v_mfma_f32_16x16x32_bf16 v[172:175], a[140:143], a[48:51], v[172:175]
    v_cvt_pk_bf16_f32 v186, v164, v165
    v_cvt_pk_bf16_f32 v187, v166, v167
    v_mfma_f32_16x16x32_bf16 v[64:67], v[176:179], a[144:147], 0
    s_add_u32 m0, s26, 67584
    v_exp_f32 v168, v168
    v_mfma_f32_16x16x32_bf16 v[64:67], v[180:183], a[176:179], v[64:67]
    global_load_lds_dwordx4 v244, s[14:15] offset:0 nt
    v_exp_f32 v169, v169
    v_mfma_f32_16x16x32_bf16 v[68:71], v[176:179], a[148:151], 0
    v_exp_f32 v170, v170
    v_mfma_f32_16x16x32_bf16 v[68:71], v[180:183], a[180:183], v[68:71]
    s_add_u32 m0, s26, 67616
    v_exp_f32 v171, v171
    v_mfma_f32_16x16x32_bf16 v[72:75], v[176:179], a[152:155], 0
    v_cvt_pk_bf16_f32 v188, v168, v169
    v_cvt_pk_bf16_f32 v189, v170, v171
    v_mfma_f32_16x16x32_bf16 v[72:75], v[180:183], a[184:187], v[72:75]
    v_exp_f32 v172, v172
    v_mfma_f32_16x16x32_bf16 v[76:79], v[176:179], a[156:159], 0
    v_exp_f32 v173, v173
    v_mfma_f32_16x16x32_bf16 v[76:79], v[180:183], a[188:191], v[76:79]
    v_exp_f32 v174, v174
    v_mfma_f32_16x16x32_bf16 v[80:83], v[176:179], a[160:163], 0
    v_exp_f32 v175, v175
    v_mfma_f32_16x16x32_bf16 v[80:83], v[180:183], a[192:195], v[80:83]
    v_cvt_pk_bf16_f32 v190, v172, v173
    v_cvt_pk_bf16_f32 v191, v174, v175
    v_mfma_f32_16x16x32_bf16 v[84:87], v[176:179], a[164:167], 0
    global_load_lds_dwordx4 v244, s[14:15] offset:1024 nt
    v_mfma_f32_16x16x32_bf16 v[84:87], v[180:183], a[196:199], v[84:87]
    v_mfma_f32_16x16x32_bf16 v[88:91], v[176:179], a[168:171], 0
    s_add_u32 m0, s26, 67648
    v_mfma_f32_16x16x32_bf16 v[88:91], v[180:183], a[200:203], v[88:91]
    global_load_lds_dwordx4 v244, s[14:15] offset:2048 nt
    v_mfma_f32_16x16x32_bf16 v[92:95], v[176:179], a[172:175], 0
    v_mfma_f32_16x16x32_bf16 v[92:95], v[180:183], a[204:207], v[92:95]
    s_add_u32 m0, s26, 67680
    v_smfmac_f32_16x16x64_bf16 a[216:219], a[228:231], v[176:183], v247
    global_load_lds_dwordx4 v244, s[14:15] offset:3072 nt
    s_add_u32 s62, s24, 49152
    s_and_b32 s62, s62, 0x3ffff
    s_add_u32 s62, s62, s25
    s_add_u32 s10, s12, s62
    s_addc_u32 s11, s13, 0
    s_add_u32 s24, s24, 65536
    s_and_b32 s24, s24, 0x3ffff
    s_mov_b32 s23, 15
    s_mov_b32 s67, 4
    s_mov_b64 vcc, -1
    s_mov_b32 s21, 0
    s_waitcnt vmcnt(8)
    ds_read_b128 v[200:203], v245 offset:9792
    ds_read_b128 v[204:207], v245 offset:9856
    ds_read_b128 v[208:211], v245 offset:9920
    ds_read_b128 v[212:215], v245 offset:9984
    s_waitcnt lgkmcnt(0)
    v_lshlrev_b32 v248, 16, v200
    v_and_b32 v249, 0xffff0000, v200
    v_lshlrev_b32 v250, 16, v201
    v_and_b32 v251, 0xffff0000, v201
    v_pk_mul_f32 v[248:249], v[248:249], s[40:41]
    v_pk_mul_f32 v[250:251], v[250:251], s[40:41]
    v_cvt_pk_bf16_f32 v200, v248, v249
    v_cvt_pk_bf16_f32 v201, v250, v251
    v_accvgpr_write_b32 a64, v200
    v_accvgpr_write_b32 a65, v201
    v_lshlrev_b32 v248, 16, v202
    v_and_b32 v249, 0xffff0000, v202
    v_lshlrev_b32 v250, 16, v203
    v_and_b32 v251, 0xffff0000, v203
    v_pk_mul_f32 v[248:249], v[248:249], s[40:41]
    v_pk_mul_f32 v[250:251], v[250:251], s[40:41]
    v_cvt_pk_bf16_f32 v202, v248, v249
    v_cvt_pk_bf16_f32 v203, v250, v251
    v_accvgpr_write_b32 a66, v202
    v_accvgpr_write_b32 a67, v203
    v_lshlrev_b32 v248, 16, v204
    v_and_b32 v249, 0xffff0000, v204
    v_lshlrev_b32 v250, 16, v205
    v_and_b32 v251, 0xffff0000, v205
    v_pk_mul_f32 v[248:249], v[248:249], s[40:41]
    v_pk_mul_f32 v[250:251], v[250:251], s[40:41]
    v_cvt_pk_bf16_f32 v204, v248, v249
    v_cvt_pk_bf16_f32 v205, v250, v251
    v_accvgpr_write_b32 a68, v204
    v_accvgpr_write_b32 a69, v205
    v_lshlrev_b32 v248, 16, v206
    v_and_b32 v249, 0xffff0000, v206
    v_lshlrev_b32 v250, 16, v207
    v_and_b32 v251, 0xffff0000, v207
    v_pk_mul_f32 v[248:249], v[248:249], s[40:41]
    v_pk_mul_f32 v[250:251], v[250:251], s[40:41]
    v_cvt_pk_bf16_f32 v206, v248, v249
    v_cvt_pk_bf16_f32 v207, v250, v251
    v_accvgpr_write_b32 a70, v206
    v_accvgpr_write_b32 a71, v207
    v_lshlrev_b32 v248, 16, v208
    v_and_b32 v249, 0xffff0000, v208
    v_lshlrev_b32 v250, 16, v209
    v_and_b32 v251, 0xffff0000, v209
    v_pk_mul_f32 v[248:249], v[248:249], s[40:41]
    v_pk_mul_f32 v[250:251], v[250:251], s[40:41]
    v_cvt_pk_bf16_f32 v208, v248, v249
    v_cvt_pk_bf16_f32 v209, v250, v251
    v_accvgpr_write_b32 a72, v208
    v_accvgpr_write_b32 a73, v209
    v_lshlrev_b32 v248, 16, v210
    v_and_b32 v249, 0xffff0000, v210
    v_lshlrev_b32 v250, 16, v211
    v_and_b32 v251, 0xffff0000, v211
    v_pk_mul_f32 v[248:249], v[248:249], s[40:41]
    v_pk_mul_f32 v[250:251], v[250:251], s[40:41]
    v_cvt_pk_bf16_f32 v210, v248, v249
    v_cvt_pk_bf16_f32 v211, v250, v251
    v_accvgpr_write_b32 a74, v210
    v_accvgpr_write_b32 a75, v211
    v_lshlrev_b32 v248, 16, v212
    v_and_b32 v249, 0xffff0000, v212
    v_lshlrev_b32 v250, 16, v213
    v_and_b32 v251, 0xffff0000, v213
    v_pk_mul_f32 v[248:249], v[248:249], s[40:41]
    v_pk_mul_f32 v[250:251], v[250:251], s[40:41]
    v_cvt_pk_bf16_f32 v212, v248, v249
    v_cvt_pk_bf16_f32 v213, v250, v251
    v_accvgpr_write_b32 a76, v212
    v_accvgpr_write_b32 a77, v213
    v_lshlrev_b32 v248, 16, v214
    v_and_b32 v249, 0xffff0000, v214
    v_lshlrev_b32 v250, 16, v215
    v_and_b32 v251, 0xffff0000, v215
    v_pk_mul_f32 v[248:249], v[248:249], s[40:41]
    v_pk_mul_f32 v[250:251], v[250:251], s[40:41]
    v_cvt_pk_bf16_f32 v214, v248, v249
    v_cvt_pk_bf16_f32 v215, v250, v251
    v_accvgpr_write_b32 a78, v214
    v_accvgpr_write_b32 a79, v215
    s_waitcnt vmcnt(12)
    s_barrier
    v_mfma_f32_16x16x32_bf16 v[160:163], a[80:83], a[64:67], -4.0
    s_add_u32 m0, s26, 84480
    ds_read_b128 a[80:83], v240 offset:0
    v_mfma_f32_16x16x32_bf16 v[160:163], a[84:87], a[68:71], v[160:163]
    ds_read_b128 a[84:87], v240 offset:64
    global_load_lds_dwordx4 v244, s[60:61] offset:0 nt
    v_mfma_f32_16x16x32_bf16 v[160:163], a[88:91], a[72:75], v[160:163]
    ds_read_b128 a[88:91], v240 offset:128
    v_mfma_f32_16x16x32_bf16 v[160:163], a[92:95], a[76:79], v[160:163]
    ds_read_b128 a[92:95], v240 offset:192
    v_mfma_f32_16x16x32_bf16 v[164:167], a[96:99], a[76:79], -4.0
    ds_read_b128 a[96:99], v240 offset:704
    v_mfma_f32_16x16x32_bf16 v[164:167], a[100:103], a[72:75], v[164:167]
    s_add_u32 m0, s26, 84496
    ds_read_b128 a[100:103], v240 offset:640
    v_mfma_f32_16x16x32_bf16 v[164:167], a[104:107], a[68:71], v[164:167]
    global_load_lds_dwordx4 v244, s[60:61] offset:1024 nt
    v_exp_f32 v160, v160
    v_mfma_f32_16x16x32_bf16 v[164:167], a[108:111], a[64:67], v[164:167]
    v_exp_f32 v161, v161
    v_mfma_f32_16x16x32_bf16 v[168:171], a[112:115], a[64:67], -4.0
    ds_read_b128 a[104:107], v240 offset:576
    v_cvt_pk_bf16_f32 v192, v160, v161
    v_mfma_f32_16x16x32_bf16 v[168:171], a[116:119], a[68:71], v[168:171]
    v_exp_f32 v162, v162
    v_mfma_f32_16x16x32_bf16 v[168:171], a[120:123], a[72:75], v[168:171]
    s_add_u32 m0, s26, 84512
    v_exp_f32 v163, v163
    v_mfma_f32_16x16x32_bf16 v[168:171], a[124:127], a[76:79], v[168:171]
    ds_read_b128 a[108:111], v240 offset:512
    global_load_lds_dwordx4 v244, s[60:61] offset:2048 nt
    v_cvt_pk_bf16_f32 v193, v162, v163
    v_mfma_f32_16x16x32_bf16 v[172:175], a[128:131], a[76:79], -4.0
    v_exp_f32 v164, v164
    v_mfma_f32_16x16x32_bf16 v[172:175], a[132:135], a[72:75], v[172:175]
    v_exp_f32 v165, v165
    v_mfma_f32_16x16x32_bf16 v[172:175], a[136:139], a[68:71], v[172:175]
    ds_read_b128 a[112:115], v241 offset:0
    v_cvt_pk_bf16_f32 v194, v164, v165
    v_mfma_f32_16x16x32_bf16 v[172:175], a[140:143], a[64:67], v[172:175]
    s_add_u32 m0, s26, 84528
    v_exp_f32 v166, v166
    v_mfma_f32_16x16x32_bf16 v[96:99], v[184:187], a[144:147], 0
    global_load_lds_dwordx4 v244, s[60:61] offset:3072 nt
    v_exp_f32 v167, v167
    v_mfma_f32_16x16x32_bf16 v[96:99], v[188:191], a[176:179], v[96:99]
    ds_read_b128 a[116:119], v241 offset:64
    v_cvt_pk_bf16_f32 v195, v166, v167
    v_mfma_f32_16x16x32_bf16 v[100:103], v[184:187], a[148:151], 0
    v_exp_f32 v168, v168
    v_mfma_f32_16x16x32_bf16 v[100:103], v[188:191], a[180:183], v[100:103]
    v_exp_f32 v169, v169
    v_mfma_f32_16x16x32_bf16 v[104:107], v[184:187], a[152:155], 0
    s_mov_b32 m0, s49
    ds_read_b128 a[120:123], v241 offset:128
    v_cvt_pk_bf16_f32 v196, v168, v169
    v_mfma_f32_16x16x32_bf16 v[104:107], v[188:191], a[184:187], v[104:107]
    global_load_lds_dwordx4 v244, s[56:57] nt
    v_exp_f32 v170, v170
    v_mfma_f32_16x16x32_bf16 v[108:111], v[184:187], a[156:159], 0
    s_add_u32 s49, s49, 1088
    v_exp_f32 v171, v171
    v_mfma_f32_16x16x32_bf16 v[108:111], v[188:191], a[188:191], v[108:111]
    s_add_u32 s56, s56, 1024
    s_addc_u32 s57, s57, 0
    ds_read_b128 a[124:127], v241 offset:192
    v_cvt_pk_bf16_f32 v197, v170, v171
    v_mfma_f32_16x16x32_bf16 v[112:115], v[184:187], a[160:163], 0
    v_exp_f32 v172, v172
    v_mfma_f32_16x16x32_bf16 v[112:115], v[188:191], a[192:195], v[112:115]
    s_add_u32 m0, s26, 0
    v_exp_f32 v173, v173
    v_mfma_f32_16x16x32_bf16 v[116:119], v[184:187], a[164:167], 0
    ds_read_b128 a[128:131], v241 offset:704
    global_load_lds_dwordx4 v244, s[6:7] offset:0 nt
    v_cvt_pk_bf16_f32 v198, v172, v173
    v_mfma_f32_16x16x32_bf16 v[116:119], v[188:191], a[196:199], v[116:119]
    v_exp_f32 v174, v174
    v_mfma_f32_16x16x32_bf16 v[120:123], v[184:187], a[168:171], 0
    v_exp_f32 v175, v175
    v_mfma_f32_16x16x32_bf16 v[120:123], v[188:191], a[200:203], v[120:123]
    ds_read_b128 a[132:135], v241 offset:640
    v_cvt_pk_bf16_f32 v199, v174, v175
    v_mfma_f32_16x16x32_bf16 v[124:127], v[184:187], a[172:175], 0
    s_add_u32 m0, s26, 32
    ds_read_b128 a[136:139], v241 offset:576
    v_mfma_f32_16x16x32_bf16 v[124:127], v[188:191], a[204:207], v[124:127]
    ds_read_b128 a[140:143], v241 offset:512
    v_smfmac_f32_16x16x64_bf16 a[220:223], a[228:231], v[184:191], v247
    s_waitcnt lgkmcnt(4)
    global_load_lds_dwordx4 v244, s[6:7] offset:1024 nt
    v_mfma_f32_16x16x32_bf16 v[160:163], a[80:83], a[0:3], -4.0
    v_mfma_f32_16x16x32_bf16 v[160:163], a[84:87], a[4:7], v[160:163]
    v_mfma_f32_16x16x32_bf16 v[160:163], a[88:91], a[8:11], v[160:163]
    v_mfma_f32_16x16x32_bf16 v[160:163], a[92:95], a[12:15], v[160:163]
    s_add_u32 m0, s26, 64
    v_mfma_f32_16x16x32_bf16 v[164:167], a[96:99], a[12:15], -4.0
    s_waitcnt vmcnt(11)
    global_load_lds_dwordx4 v244, s[6:7] offset:2048 nt
    v_mfma_f32_16x16x32_bf16 v[164:167], a[100:103], a[8:11], v[164:167]
    s_barrier
    v_mfma_f32_16x16x32_bf16 v[164:167], a[104:107], a[4:7], v[164:167]
    v_exp_f32 v160, v160
    v_mfma_f32_16x16x32_bf16 v[164:167], a[108:111], a[0:3], v[164:167]
    v_exp_f32 v161, v161
    v_mfma_f32_16x16x32_bf16 v[168:171], a[112:115], a[0:3], -4.0
    s_add_u32 m0, s26, 96
    v_exp_f32 v162, v162
    v_mfma_f32_16x16x32_bf16 v[168:171], a[116:119], a[4:7], v[168:171]
    global_load_lds_dwordx4 v244, s[6:7] offset:3072 nt
    v_exp_f32 v163, v163
    v_mfma_f32_16x16x32_bf16 v[168:171], a[120:123], a[8:11], v[168:171]
    v_cvt_pk_bf16_f32 v176, v160, v161
    v_cvt_pk_bf16_f32 v177, v162, v163
    v_mfma_f32_16x16x32_bf16 v[168:171], a[124:127], a[12:15], v[168:171]
    s_waitcnt lgkmcnt(0)
    v_exp_f32 v164, v164
    v_mfma_f32_16x16x32_bf16 v[172:175], a[128:131], a[12:15], -4.0
    v_exp_f32 v165, v165
    v_mfma_f32_16x16x32_bf16 v[172:175], a[132:135], a[8:11], v[172:175]
    s_add_u32 m0, s26, 16896
    v_exp_f32 v166, v166
    v_mfma_f32_16x16x32_bf16 v[172:175], a[136:139], a[4:7], v[172:175]
    global_load_lds_dwordx4 v244, s[10:11] offset:0 nt
    v_exp_f32 v167, v167
    v_mfma_f32_16x16x32_bf16 v[172:175], a[140:143], a[0:3], v[172:175]
    v_cvt_pk_bf16_f32 v178, v164, v165
    v_cvt_pk_bf16_f32 v179, v166, v167
    v_mfma_f32_16x16x32_bf16 v[128:131], v[192:195], a[144:147], 0
    ds_read_b64_tr_b16 a[144:145], v242 offset:0
    ds_read_b64_tr_b16 a[146:147], v242 offset:512
    v_mfma_f32_16x16x32_bf16 v[128:131], v[196:199], a[176:179], v[128:131]
L_pad0_1:
    s_cbranch_execz L_ret0
    v_exp_f32 v168, v168
    v_mfma_f32_16x16x32_bf16 v[132:135], v[192:195], a[148:151], 0
    s_add_u32 m0, s26, 16912
    ds_read_b64_tr_b16 a[176:177], v243 offset:0
    ds_read_b64_tr_b16 a[178:179], v243 offset:512
    v_mfma_f32_16x16x32_bf16 v[132:135], v[196:199], a[180:183], v[132:135]
    global_load_lds_dwordx4 v244, s[10:11] offset:1024 nt
    v_exp_f32 v169, v169
    v_mfma_f32_16x16x32_bf16 v[136:139], v[192:195], a[152:155], 0
    ds_read_b64_tr_b16 a[148:149], v242 offset:16
    ds_read_b64_tr_b16 a[150:151], v242 offset:528
    v_mfma_f32_16x16x32_bf16 v[136:139], v[196:199], a[184:187], v[136:139]
    v_exp_f32 v170, v170
    v_mfma_f32_16x16x32_bf16 v[140:143], v[192:195], a[156:159], 0
    ds_read_b64_tr_b16 a[180:181], v243 offset:16
    ds_read_b64_tr_b16 a[182:183], v243 offset:528
    v_mfma_f32_16x16x32_bf16 v[140:143], v[196:199], a[188:191], v[140:143]
    s_add_u32 m0, s26, 16928
    v_exp_f32 v171, v171
    v_mfma_f32_16x16x32_bf16 v[144:147], v[192:195], a[160:163], 0
    ds_read_b64_tr_b16 a[152:153], v242 offset:32
    ds_read_b64_tr_b16 a[154:155], v242 offset:544
    global_load_lds_dwordx4 v244, s[10:11] offset:2048 nt
    v_mfma_f32_16x16x32_bf16 v[144:147], v[196:199], a[192:195], v[144:147]
    v_exp_f32 v172, v172
    v_mfma_f32_16x16x32_bf16 v[148:151], v[192:195], a[164:167], 0
    ds_read_b64_tr_b16 a[184:185], v243 offset:32
    ds_read_b64_tr_b16 a[186:187], v243 offset:544
    v_mfma_f32_16x16x32_bf16 v[148:151], v[196:199], a[196:199], v[148:151]
    v_exp_f32 v173, v173
    v_mfma_f32_16x16x32_bf16 v[152:155], v[192:195], a[168:171], 0
    s_add_u32 m0, s26, 16944
    s_add_u32 s26, s26, 33792
    ds_read_b64_tr_b16 a[156:157], v242 offset:48
    ds_read_b64_tr_b16 a[158:159], v242 offset:560
    v_mfma_f32_16x16x32_bf16 v[152:155], v[196:199], a[200:203], v[152:155]
    global_load_lds_dwordx4 v244, s[10:11] offset:3072 nt
    v_exp_f32 v174, v174
    v_mfma_f32_16x16x32_bf16 v[156:159], v[192:195], a[172:175], 0
    ds_read_b64_tr_b16 a[188:189], v243 offset:48
    ds_read_b64_tr_b16 a[190:191], v243 offset:560
    v_mfma_f32_16x16x32_bf16 v[156:159], v[196:199], a[204:207], v[156:159]
    v_exp_f32 v175, v175
    v_smfmac_f32_16x16x64_bf16 a[224:227], a[228:231], v[192:199], v247
    s_branch L_loop0r0
.fill 16+11, 4, 0xbf810000
L_pad0_3:
    s_branch L_ret0
L_pad0_4:
    s_branch L_ret1
L_midr0:
    v_mfma_f32_16x16x32_bf16 v[160:163], a[80:83], a[16:19], -4.0
    ds_read_b64_tr_b16 a[160:161], v242 offset:128
    ds_read_b64_tr_b16 a[162:163], v242 offset:640
    v_mfma_f32_16x16x32_bf16 v[160:163], a[84:87], a[20:23], v[160:163]
    ds_read_b128 v[216:219], v245 offset:5440
    v_cvt_pk_bf16_f32 v180, v168, v169
    v_cvt_pk_bf16_f32 v181, v170, v171
    v_mfma_f32_16x16x32_bf16 v[160:163], a[88:91], a[24:27], v[160:163]
    s_add_u32 s60, s4, s37
    s_addc_u32 s61, s5, 0
    ds_read_b64_tr_b16 a[192:193], v243 offset:128
    ds_read_b64_tr_b16 a[194:195], v243 offset:640
    v_mfma_f32_16x16x32_bf16 v[160:163], a[92:95], a[28:31], v[160:163]
    s_add_u32 s49, s28, 1088
    ds_read_b128 v[220:223], v245 offset:5504
    v_cvt_pk_bf16_f32 v182, v172, v173
    v_cvt_pk_bf16_f32 v183, v174, v175
    v_mfma_f32_16x16x32_bf16 v[164:167], a[96:99], a[28:31], -4.0
    s_mov_b32 s67, 1
    ds_read_b64_tr_b16 a[164:165], v242 offset:144
    ds_read_b64_tr_b16 a[166:167], v242 offset:656
    v_mfma_f32_16x16x32_bf16 v[164:167], a[100:103], a[24:27], v[164:167]
    s_mov_b64 vcc, 0
    ds_read_b128 v[224:227], v245 offset:5568
    v_mfma_f32_16x16x32_bf16 v[164:167], a[104:107], a[20:23], v[164:167]
    ds_read_b64_tr_b16 a[196:197], v243 offset:144
    ds_read_b64_tr_b16 a[198:199], v243 offset:656
    v_mfma_f32_16x16x32_bf16 v[164:167], a[108:111], a[16:19], v[164:167]
    ds_read_b128 v[228:231], v245 offset:5632
    v_exp_f32 v160, v160
    v_mfma_f32_16x16x32_bf16 v[168:171], a[112:115], a[16:19], -4.0
    ds_read_b64_tr_b16 a[168:169], v242 offset:160
    ds_read_b64_tr_b16 a[170:171], v242 offset:672
    v_mfma_f32_16x16x32_bf16 v[168:171], a[116:119], a[20:23], v[168:171]
    ds_read_b128 v[200:203], v245 offset:1088
    v_exp_f32 v161, v161
    v_mfma_f32_16x16x32_bf16 v[168:171], a[120:123], a[24:27], v[168:171]
    ds_read_b64_tr_b16 a[200:201], v243 offset:160
    ds_read_b64_tr_b16 a[202:203], v243 offset:672
    v_mfma_f32_16x16x32_bf16 v[168:171], a[124:127], a[28:31], v[168:171]
    ds_read_b128 v[204:207], v245 offset:1152
    v_exp_f32 v162, v162
    v_mfma_f32_16x16x32_bf16 v[172:175], a[128:131], a[28:31], -4.0
    ds_read_b64_tr_b16 a[172:173], v242 offset:176
    ds_read_b64_tr_b16 a[174:175], v242 offset:688
    v_mfma_f32_16x16x32_bf16 v[172:175], a[132:135], a[24:27], v[172:175]
    ds_read_b128 v[208:211], v245 offset:1216
    v_exp_f32 v163, v163
    v_mfma_f32_16x16x32_bf16 v[172:175], a[136:139], a[20:23], v[172:175]
    ds_read_b64_tr_b16 a[204:205], v243 offset:176
    ds_read_b64_tr_b16 a[206:207], v243 offset:688
    v_mfma_f32_16x16x32_bf16 v[172:175], a[140:143], a[16:19], v[172:175]
    s_waitcnt lgkmcnt(12)
    ds_read_b128 v[212:215], v245 offset:1280
    v_cvt_pk_bf16_f32 v184, v160, v161
    v_cvt_pk_bf16_f32 v185, v162, v163
    v_mfma_f32_16x16x32_bf16 v[0:3], v[176:179], a[144:147], v[0:3]
    s_waitcnt lgkmcnt(12)
    v_exp_f32 v164, v164
    v_mfma_f32_16x16x32_bf16 v[0:3], v[180:183], a[176:179], v[0:3]
    s_add_u32 m0, s28, 5440
    v_exp_f32 v165, v165
    v_mfma_f32_16x16x32_bf16 v[4:7], v[176:179], a[148:151], v[4:7]
    global_load_lds_dwordx4 v244, s[60:61] offset:0 nt
    v_exp_f32 v166, v166
    v_mfma_f32_16x16x32_bf16 v[4:7], v[180:183], a[180:183], v[4:7]
    v_exp_f32 v167, v167
    v_mfma_f32_16x16x32_bf16 v[8:11], v[176:179], a[152:155], v[8:11]
    s_add_u32 m0, s28, 5504
    v_cvt_pk_bf16_f32 v186, v164, v165
    v_cvt_pk_bf16_f32 v187, v166, v167
    v_mfma_f32_16x16x32_bf16 v[8:11], v[180:183], a[184:187], v[8:11]
    global_load_lds_dwordx4 v244, s[60:61] offset:1024 nt
    v_exp_f32 v168, v168
    v_mfma_f32_16x16x32_bf16 v[12:15], v[176:179], a[156:159], v[12:15]
    v_exp_f32 v169, v169
    v_mfma_f32_16x16x32_bf16 v[12:15], v[180:183], a[188:191], v[12:15]
    s_add_u32 m0, s28, 5568
    v_exp_f32 v170, v170
    v_mfma_f32_16x16x32_bf16 v[16:19], v[176:179], a[160:163], v[16:19]
    global_load_lds_dwordx4 v244, s[60:61] offset:2048 nt
    v_exp_f32 v171, v171
    v_mfma_f32_16x16x32_bf16 v[16:19], v[180:183], a[192:195], v[16:19]
    v_cvt_pk_bf16_f32 v188, v168, v169
    v_cvt_pk_bf16_f32 v189, v170, v171
    v_mfma_f32_16x16x32_bf16 v[20:23], v[176:179], a[164:167], v[20:23]
    s_add_u32 m0, s28, 5632
    v_exp_f32 v172, v172
    v_mfma_f32_16x16x32_bf16 v[20:23], v[180:183], a[196:199], v[20:23]
    s_waitcnt lgkmcnt(0)
    global_load_lds_dwordx4 v244, s[60:61] offset:3072 nt
    v_exp_f32 v173, v173
    v_mfma_f32_16x16x32_bf16 v[24:27], v[176:179], a[168:171], v[24:27]
    s_waitcnt lgkmcnt(0)
    v_exp_f32 v174, v174
    v_mfma_f32_16x16x32_bf16 v[24:27], v[180:183], a[200:203], v[24:27]
    v_exp_f32 v175, v175
    v_mfma_f32_16x16x32_bf16 v[28:31], v[176:179], a[172:175], v[28:31]
    s_branch L_inr0
L_loop0r0:
    v_mfma_f32_16x16x32_bf16 v[160:163], a[80:83], a[16:19], -4.0
    ds_read_b64_tr_b16 a[160:161], v242 offset:128
    ds_read_b64_tr_b16 a[162:163], v242 offset:640
    v_mfma_f32_16x16x32_bf16 v[160:163], a[84:87], a[20:23], v[160:163]
    v_cvt_pk_bf16_f32 v180, v168, v169
    v_cvt_pk_bf16_f32 v181, v170, v171
    v_mfma_f32_16x16x32_bf16 v[160:163], a[88:91], a[24:27], v[160:163]
    ds_read_b64_tr_b16 a[192:193], v243 offset:128
    ds_read_b64_tr_b16 a[194:195], v243 offset:640
    v_mfma_f32_16x16x32_bf16 v[160:163], a[92:95], a[28:31], v[160:163]
    v_cvt_pk_bf16_f32 v182, v172, v173
    v_cvt_pk_bf16_f32 v183, v174, v175
    v_mfma_f32_16x16x32_bf16 v[164:167], a[96:99], a[28:31], -4.0
    ds_read_b64_tr_b16 a[164:165], v242 offset:144
    ds_read_b64_tr_b16 a[166:167], v242 offset:656
    v_mfma_f32_16x16x32_bf16 v[164:167], a[100:103], a[24:27], v[164:167]
    v_mfma_f32_16x16x32_bf16 v[164:167], a[104:107], a[20:23], v[164:167]
    ds_read_b64_tr_b16 a[196:197], v243 offset:144
    ds_read_b64_tr_b16 a[198:199], v243 offset:656
    v_mfma_f32_16x16x32_bf16 v[164:167], a[108:111], a[16:19], v[164:167]
    v_exp_f32 v160, v160
    v_mfma_f32_16x16x32_bf16 v[168:171], a[112:115], a[16:19], -4.0
    ds_read_b64_tr_b16 a[168:169], v242 offset:160
    ds_read_b64_tr_b16 a[170:171], v242 offset:672
    v_mfma_f32_16x16x32_bf16 v[168:171], a[116:119], a[20:23], v[168:171]
    v_exp_f32 v161, v161
    v_mfma_f32_16x16x32_bf16 v[168:171], a[120:123], a[24:27], v[168:171]
    ds_read_b64_tr_b16 a[200:201], v243 offset:160
    ds_read_b64_tr_b16 a[202:203], v243 offset:672
    v_mfma_f32_16x16x32_bf16 v[168:171], a[124:127], a[28:31], v[168:171]
    v_exp_f32 v162, v162
    v_mfma_f32_16x16x32_bf16 v[172:175], a[128:131], a[28:31], -4.0
    ds_read_b64_tr_b16 a[172:173], v242 offset:176
    ds_read_b64_tr_b16 a[174:175], v242 offset:688
    v_mfma_f32_16x16x32_bf16 v[172:175], a[132:135], a[24:27], v[172:175]
    v_exp_f32 v163, v163
    v_mfma_f32_16x16x32_bf16 v[172:175], a[136:139], a[20:23], v[172:175]
    ds_read_b64_tr_b16 a[204:205], v243 offset:176
    ds_read_b64_tr_b16 a[206:207], v243 offset:688
    v_mfma_f32_16x16x32_bf16 v[172:175], a[140:143], a[16:19], v[172:175]
    s_waitcnt lgkmcnt(8)
    v_cvt_pk_bf16_f32 v184, v160, v161
    v_cvt_pk_bf16_f32 v185, v162, v163
    v_mfma_f32_16x16x32_bf16 v[0:3], v[176:179], a[144:147], v[0:3]
    v_exp_f32 v164, v164
    v_mfma_f32_16x16x32_bf16 v[0:3], v[180:183], a[176:179], v[0:3]
    v_exp_f32 v165, v165
    v_mfma_f32_16x16x32_bf16 v[4:7], v[176:179], a[148:151], v[4:7]
    v_exp_f32 v166, v166
    v_mfma_f32_16x16x32_bf16 v[4:7], v[180:183], a[180:183], v[4:7]
    v_exp_f32 v167, v167
    v_mfma_f32_16x16x32_bf16 v[8:11], v[176:179], a[152:155], v[8:11]
    v_cvt_pk_bf16_f32 v186, v164, v165
    v_cvt_pk_bf16_f32 v187, v166, v167
    v_mfma_f32_16x16x32_bf16 v[8:11], v[180:183], a[184:187], v[8:11]
    v_exp_f32 v168, v168
    v_mfma_f32_16x16x32_bf16 v[12:15], v[176:179], a[156:159], v[12:15]
    v_exp_f32 v169, v169
    v_mfma_f32_16x16x32_bf16 v[12:15], v[180:183], a[188:191], v[12:15]
    v_exp_f32 v170, v170
    v_mfma_f32_16x16x32_bf16 v[16:19], v[176:179], a[160:163], v[16:19]
    v_exp_f32 v171, v171
    v_mfma_f32_16x16x32_bf16 v[16:19], v[180:183], a[192:195], v[16:19]
    v_cvt_pk_bf16_f32 v188, v168, v169
    v_cvt_pk_bf16_f32 v189, v170, v171
    v_mfma_f32_16x16x32_bf16 v[20:23], v[176:179], a[164:167], v[20:23]
    v_exp_f32 v172, v172
    v_mfma_f32_16x16x32_bf16 v[20:23], v[180:183], a[196:199], v[20:23]
    s_waitcnt lgkmcnt(0)
    v_exp_f32 v173, v173
    v_mfma_f32_16x16x32_bf16 v[24:27], v[176:179], a[168:171], v[24:27]
    v_exp_f32 v174, v174
    v_mfma_f32_16x16x32_bf16 v[24:27], v[180:183], a[200:203], v[24:27]
    v_exp_f32 v175, v175
    v_mfma_f32_16x16x32_bf16 v[28:31], v[176:179], a[172:175], v[28:31]
L_inr0:
    v_cvt_pk_bf16_f32 v190, v172, v173
    v_cvt_pk_bf16_f32 v191, v174, v175
    v_mfma_f32_16x16x32_bf16 v[28:31], v[180:183], a[204:207], v[28:31]
    s_waitcnt vmcnt(9)
    v_smfmac_f32_16x16x64_bf16 a[208:211], a[228:231], v[176:183], v247
    s_barrier
    v_mfma_f32_16x16x32_bf16 v[160:163], a[80:83], a[32:35], -4.0
    s_mov_b32 m0, s49
    v_add_u32 v240, s27, v240
    v_mfma_f32_16x16x32_bf16 v[160:163], a[84:87], a[36:39], v[160:163]
    global_load_lds_dwordx4 v244, s[56:57] nt
    v_mfma_f32_16x16x32_bf16 v[160:163], a[88:91], a[40:43], v[160:163]
    s_add_u32 m0, s26, 0
    v_add_u32 v241, s27, v241
    v_mfma_f32_16x16x32_bf16 v[160:163], a[92:95], a[44:47], v[160:163]
    global_load_lds_dwordx4 v244, s[52:53] offset:0
    v_mfma_f32_16x16x32_bf16 v[164:167], a[96:99], a[44:47], -4.0
    s_add_u32 m0, s26, 32
    v_add_u32 v242, s27, v242
    v_mfma_f32_16x16x32_bf16 v[164:167], a[100:103], a[40:43], v[164:167]
    global_load_lds_dwordx4 v244, s[52:53] offset:1024
    v_mfma_f32_16x16x32_bf16 v[164:167], a[104:107], a[36:39], v[164:167]
    v_exp_f32 v160, v160
    v_mfma_f32_16x16x32_bf16 v[164:167], a[108:111], a[32:35], v[164:167]
    v_exp_f32 v161, v161
    v_mfma_f32_16x16x32_bf16 v[168:171], a[112:115], a[32:35], -4.0
    v_exp_f32 v162, v162
    v_mfma_f32_16x16x32_bf16 v[168:171], a[116:119], a[36:39], v[168:171]
    v_exp_f32 v163, v163
    v_mfma_f32_16x16x32_bf16 v[168:171], a[120:123], a[40:43], v[168:171]
    v_cvt_pk_bf16_f32 v176, v160, v161
    v_cvt_pk_bf16_f32 v177, v162, v163
    v_mfma_f32_16x16x32_bf16 v[168:171], a[124:127], a[44:47], v[168:171]
    v_exp_f32 v164, v164
    v_mfma_f32_16x16x32_bf16 v[172:175], a[128:131], a[44:47], -4.0
    v_exp_f32 v165, v165
    v_mfma_f32_16x16x32_bf16 v[172:175], a[132:135], a[40:43], v[172:175]
    v_exp_f32 v166, v166
    v_mfma_f32_16x16x32_bf16 v[172:175], a[136:139], a[36:39], v[172:175]
    v_exp_f32 v167, v167
    v_mfma_f32_16x16x32_bf16 v[172:175], a[140:143], a[32:35], v[172:175]
    v_cvt_pk_bf16_f32 v178, v164, v165
    v_cvt_pk_bf16_f32 v179, v166, v167
    v_mfma_f32_16x16x32_bf16 v[32:35], v[184:187], a[144:147], v[32:35]
    v_exp_f32 v168, v168
    v_mfma_f32_16x16x32_bf16 v[32:35], v[188:191], a[176:179], v[32:35]
    v_exp_f32 v169, v169
    v_mfma_f32_16x16x32_bf16 v[36:39], v[184:187], a[148:151], v[36:39]
    v_exp_f32 v170, v170
    v_mfma_f32_16x16x32_bf16 v[36:39], v[188:191], a[180:183], v[36:39]
    v_exp_f32 v171, v171
    v_mfma_f32_16x16x32_bf16 v[40:43], v[184:187], a[152:155], v[40:43]
    v_cvt_pk_bf16_f32 v180, v168, v169
    v_cvt_pk_bf16_f32 v181, v170, v171
    v_mfma_f32_16x16x32_bf16 v[40:43], v[188:191], a[184:187], v[40:43]
    v_exp_f32 v172, v172
    v_mfma_f32_16x16x32_bf16 v[44:47], v[184:187], a[156:159], v[44:47]
    v_exp_f32 v173, v173
    v_mfma_f32_16x16x32_bf16 v[44:47], v[188:191], a[188:191], v[44:47]
    v_exp_f32 v174, v174
    v_mfma_f32_16x16x32_bf16 v[48:51], v[184:187], a[160:163], v[48:51]
    v_exp_f32 v175, v175
    v_mfma_f32_16x16x32_bf16 v[48:51], v[188:191], a[192:195], v[48:51]
    v_cvt_pk_bf16_f32 v182, v172, v173
    v_cvt_pk_bf16_f32 v183, v174, v175
    v_mfma_f32_16x16x32_bf16 v[52:55], v[184:187], a[164:167], v[52:55]
    v_add_u32 v243, s27, v243
    v_mfma_f32_16x16x32_bf16 v[52:55], v[188:191], a[196:199], v[52:55]
    ds_write_b32 v254, v232 offset:0
    v_mfma_f32_16x16x32_bf16 v[56:59], v[184:187], a[168:171], v[56:59]
    ds_write_b32 v254, v233 offset:256
    v_mfma_f32_16x16x32_bf16 v[56:59], v[188:191], a[200:203], v[56:59]
    ds_write_b32 v254, v234 offset:512
    v_mfma_f32_16x16x32_bf16 v[60:63], v[184:187], a[172:175], v[60:63]
    ds_write_b32 v254, v235 offset:768
    v_mfma_f32_16x16x32_bf16 v[60:63], v[188:191], a[204:207], v[60:63]
    s_add_u32 m0, s26, 64
    v_add_u32 v254, s21, v254
    v_smfmac_f32_16x16x64_bf16 a[212:215], a[228:231], v[184:191], v247
    global_load_lds_dwordx4 v244, s[52:53] offset:2048
    v_mfma_f32_16x16x32_bf16 v[160:163], a[80:83], a[48:51], -4.0
    s_add_u32 m0, s26, 96
    ds_read2st64_b32 v[232:233], v254 offset0:0 offset1:1
    v_mfma_f32_16x16x32_bf16 v[160:163], a[84:87], a[52:55], v[160:163]
    global_load_lds_dwordx4 v244, s[52:53] offset:3072
    v_mfma_f32_16x16x32_bf16 v[160:163], a[88:91], a[56:59], v[160:163]
    s_add_u32 m0, s26, 16896
    ds_read2st64_b32 v[234:235], v254 offset0:2 offset1:3
    v_mfma_f32_16x16x32_bf16 v[160:163], a[92:95], a[60:63], v[160:163]
    global_load_lds_dwordx4 v244, s[54:55] offset:0
    v_mfma_f32_16x16x32_bf16 v[164:167], a[96:99], a[60:63], -4.0
    s_add_u32 m0, s26, 16912
    v_mfma_f32_16x16x32_bf16 v[164:167], a[100:103], a[56:59], v[164:167]
    global_load_lds_dwordx4 v244, s[54:55] offset:1024
    v_mfma_f32_16x16x32_bf16 v[164:167], a[104:107], a[52:55], v[164:167]
    v_exp_f32 v160, v160
    v_mfma_f32_16x16x32_bf16 v[164:167], a[108:111], a[48:51], v[164:167]
    v_exp_f32 v161, v161
    v_mfma_f32_16x16x32_bf16 v[168:171], a[112:115], a[48:51], -4.0
    v_exp_f32 v162, v162
    v_mfma_f32_16x16x32_bf16 v[168:171], a[116:119], a[52:55], v[168:171]
    v_exp_f32 v163, v163
    v_mfma_f32_16x16x32_bf16 v[168:171], a[120:123], a[56:59], v[168:171]
    v_cvt_pk_bf16_f32 v184, v160, v161
    v_cvt_pk_bf16_f32 v185, v162, v163
    v_mfma_f32_16x16x32_bf16 v[168:171], a[124:127], a[60:63], v[168:171]
    v_exp_f32 v164, v164
    v_mfma_f32_16x16x32_bf16 v[172:175], a[128:131], a[60:63], -4.0
    v_exp_f32 v165, v165
    v_mfma_f32_16x16x32_bf16 v[172:175], a[132:135], a[56:59], v[172:175]
    v_exp_f32 v166, v166
    v_mfma_f32_16x16x32_bf16 v[172:175], a[136:139], a[52:55], v[172:175]
    v_exp_f32 v167, v167
    v_mfma_f32_16x16x32_bf16 v[172:175], a[140:143], a[48:51], v[172:175]
    v_cvt_pk_bf16_f32 v186, v164, v165
    v_cvt_pk_bf16_f32 v187, v166, v167
    v_mfma_f32_16x16x32_bf16 v[64:67], v[176:179], a[144:147], v[64:67]
    v_exp_f32 v168, v168
    v_mfma_f32_16x16x32_bf16 v[64:67], v[180:183], a[176:179], v[64:67]
    v_exp_f32 v169, v169
    v_mfma_f32_16x16x32_bf16 v[68:71], v[176:179], a[148:151], v[68:71]
    v_exp_f32 v170, v170
    v_mfma_f32_16x16x32_bf16 v[68:71], v[180:183], a[180:183], v[68:71]
    v_exp_f32 v171, v171
    v_mfma_f32_16x16x32_bf16 v[72:75], v[176:179], a[152:155], v[72:75]
    v_cvt_pk_bf16_f32 v188, v168, v169
    v_cvt_pk_bf16_f32 v189, v170, v171
    v_mfma_f32_16x16x32_bf16 v[72:75], v[180:183], a[184:187], v[72:75]
    v_exp_f32 v172, v172
    v_mfma_f32_16x16x32_bf16 v[76:79], v[176:179], a[156:159], v[76:79]
    v_exp_f32 v173, v173
    v_mfma_f32_16x16x32_bf16 v[76:79], v[180:183], a[188:191], v[76:79]
    v_exp_f32 v174, v174
    v_mfma_f32_16x16x32_bf16 v[80:83], v[176:179], a[160:163], v[80:83]
    v_exp_f32 v175, v175
    v_mfma_f32_16x16x32_bf16 v[80:83], v[180:183], a[192:195], v[80:83]
    v_cvt_pk_bf16_f32 v190, v172, v173
    v_cvt_pk_bf16_f32 v191, v174, v175
    v_mfma_f32_16x16x32_bf16 v[84:87], v[176:179], a[164:167], v[84:87]
    s_waitcnt lgkmcnt(0)
    v_lshlrev_b32 v236, 16, v232
    v_and_b32 v237, 0xffff0000, v232
    v_mfma_f32_16x16x32_bf16 v[84:87], v[180:183], a[196:199], v[84:87]
    s_add_u32 m0, s26, 16928
    v_mul_f32 v236, s40, v236
    v_mfma_f32_16x16x32_bf16 v[88:91], v[176:179], a[168:171], v[88:91]
    global_load_lds_dwordx4 v244, s[54:55] offset:2048
    v_mfma_f32_16x16x32_bf16 v[88:91], v[180:183], a[200:203], v[88:91]
    v_mul_f32 v237, s40, v237
    v_cvt_pk_bf16_f32 v232, v236, v237
    v_mfma_f32_16x16x32_bf16 v[92:95], v[176:179], a[172:175], v[92:95]
    v_lshlrev_b32 v238, 16, v233
    v_and_b32 v239, 0xffff0000, v233
    v_mfma_f32_16x16x32_bf16 v[92:95], v[180:183], a[204:207], v[92:95]
    s_add_u32 m0, s26, 16944
    v_mul_f32 v238, s40, v238
    v_smfmac_f32_16x16x64_bf16 a[216:219], a[228:231], v[176:183], v247
    global_load_lds_dwordx4 v244, s[54:55] offset:3072
    v_mfma_f32_16x16x32_bf16 v[160:163], a[80:83], a[64:67], -4.0
    s_add_u32 s49, s49, 1088
    ds_read_b128 a[80:83], v240 offset:0
    v_mul_f32 v239, s40, v239
    v_mfma_f32_16x16x32_bf16 v[160:163], a[84:87], a[68:71], v[160:163]
    s_add_u32 s56, s56, 1024
    ds_read_b128 a[84:87], v240 offset:64
    v_cvt_pk_bf16_f32 v233, v238, v239
    v_mfma_f32_16x16x32_bf16 v[160:163], a[88:91], a[72:75], v[160:163]
    s_addc_u32 s57, s57, 0
    ds_read_b128 a[88:91], v240 offset:128
    v_lshlrev_b32 v248, 16, v234
    v_mfma_f32_16x16x32_bf16 v[160:163], a[92:95], a[76:79], v[160:163]
    s_mov_b32 s21, 1088
    ds_read_b128 a[92:95], v240 offset:192
    v_and_b32 v249, 0xffff0000, v234
    v_mfma_f32_16x16x32_bf16 v[164:167], a[96:99], a[76:79], -4.0
    s_add_u32 s24, s24, 16384
    ds_read_b128 a[96:99], v240 offset:704
    v_mul_f32 v248, s40, v248
    v_mfma_f32_16x16x32_bf16 v[164:167], a[100:103], a[72:75], v[164:167]
    s_and_b32 s24, s24, 0x3ffff
    ds_read_b128 a[100:103], v240 offset:640
    v_mul_f32 v249, s40, v249
    v_mfma_f32_16x16x32_bf16 v[164:167], a[104:107], a[68:71], v[164:167]
    s_cmp_eq_u32 s23, 4
    v_exp_f32 v160, v160
    v_mfma_f32_16x16x32_bf16 v[164:167], a[108:111], a[64:67], v[164:167]
    s_cselect_b32 s25, s51, s25
    v_exp_f32 v161, v161
    v_mfma_f32_16x16x32_bf16 v[168:171], a[112:115], a[64:67], -4.0
    s_add_u32 s65, s25, s24
    ds_read_b128 a[104:107], v240 offset:576
    v_cvt_pk_bf16_f32 v192, v160, v161
    v_mfma_f32_16x16x32_bf16 v[168:171], a[116:119], a[68:71], v[168:171]
    s_add_u32 s52, s8, s65
    v_exp_f32 v162, v162
    v_mfma_f32_16x16x32_bf16 v[168:171], a[120:123], a[72:75], v[168:171]
    s_addc_u32 s53, s9, 0
    v_exp_f32 v163, v163
    v_mfma_f32_16x16x32_bf16 v[168:171], a[124:127], a[76:79], v[168:171]
    s_add_u32 s54, s12, s65
    ds_read_b128 a[108:111], v240 offset:512
    v_cvt_pk_bf16_f32 v193, v162, v163
    v_mfma_f32_16x16x32_bf16 v[172:175], a[128:131], a[76:79], -4.0
    s_addc_u32 s55, s13, 0
    v_exp_f32 v164, v164
    v_mfma_f32_16x16x32_bf16 v[172:175], a[132:135], a[72:75], v[172:175]
    s_add_u32 s26, s26, s27
    v_exp_f32 v165, v165
    v_mfma_f32_16x16x32_bf16 v[172:175], a[136:139], a[68:71], v[172:175]
    s_cmp_eq_u32 s26, s48
    ds_read_b128 a[112:115], v241 offset:0
    v_cvt_pk_bf16_f32 v194, v164, v165
    v_mfma_f32_16x16x32_bf16 v[172:175], a[140:143], a[64:67], v[172:175]
    s_cselect_b32 s27, s58, s59
    v_exp_f32 v166, v166
    v_mfma_f32_16x16x32_bf16 v[96:99], v[184:187], a[144:147], v[96:99]
    s_sub_u32 s23, s23, 1
    v_exp_f32 v167, v167
    v_mfma_f32_16x16x32_bf16 v[96:99], v[188:191], a[176:179], v[96:99]
    s_cmp_lg_u32 s23, s67
    ds_read_b128 a[116:119], v241 offset:64
    v_cvt_pk_bf16_f32 v195, v166, v167
    v_mfma_f32_16x16x32_bf16 v[100:103], v[184:187], a[148:151], v[100:103]
    v_exp_f32 v168, v168
    v_mfma_f32_16x16x32_bf16 v[100:103], v[188:191], a[180:183], v[100:103]
    v_exp_f32 v169, v169
    v_mfma_f32_16x16x32_bf16 v[104:107], v[184:187], a[152:155], v[104:107]
    ds_read_b128 a[120:123], v241 offset:128
    v_cvt_pk_bf16_f32 v196, v168, v169
    v_mfma_f32_16x16x32_bf16 v[104:107], v[188:191], a[184:187], v[104:107]
    v_exp_f32 v170, v170
    v_mfma_f32_16x16x32_bf16 v[108:111], v[184:187], a[156:159], v[108:111]
    v_exp_f32 v171, v171
    v_mfma_f32_16x16x32_bf16 v[108:111], v[188:191], a[188:191], v[108:111]
    ds_read_b128 a[124:127], v241 offset:192
    v_cvt_pk_bf16_f32 v197, v170, v171
    v_mfma_f32_16x16x32_bf16 v[112:115], v[184:187], a[160:163], v[112:115]
    v_exp_f32 v172, v172
    v_mfma_f32_16x16x32_bf16 v[112:115], v[188:191], a[192:195], v[112:115]
    v_exp_f32 v173, v173
    v_mfma_f32_16x16x32_bf16 v[116:119], v[184:187], a[164:167], v[116:119]
    ds_read_b128 a[128:131], v241 offset:704
    v_cvt_pk_bf16_f32 v198, v172, v173
    v_mfma_f32_16x16x32_bf16 v[116:119], v[188:191], a[196:199], v[116:119]
    v_exp_f32 v174, v174
    v_mfma_f32_16x16x32_bf16 v[120:123], v[184:187], a[168:171], v[120:123]
    v_exp_f32 v175, v175
    v_mfma_f32_16x16x32_bf16 v[120:123], v[188:191], a[200:203], v[120:123]
    ds_read_b128 a[132:135], v241 offset:640
    v_cvt_pk_bf16_f32 v199, v174, v175
    v_mfma_f32_16x16x32_bf16 v[124:127], v[184:187], a[172:175], v[124:127]
    ds_read_b128 a[136:139], v241 offset:576
    v_cvt_pk_bf16_f32 v234, v248, v249
    v_mfma_f32_16x16x32_bf16 v[124:127], v[188:191], a[204:207], v[124:127]
    ds_read_b128 a[140:143], v241 offset:512
    v_lshlrev_b32 v250, 16, v235
    v_smfmac_f32_16x16x64_bf16 a[220:223], a[228:231], v[184:191], v247
    s_waitcnt lgkmcnt(4)
    v_mfma_f32_16x16x32_bf16 v[160:163], a[80:83], a[0:3], -4.0
    v_and_b32 v251, 0xffff0000, v235
    v_mul_f32 v250, s40, v250
    v_mfma_f32_16x16x32_bf16 v[160:163], a[84:87], a[4:7], v[160:163]
    v_mul_f32 v251, s40, v251
    v_cvt_pk_bf16_f32 v235, v250, v251
    v_mfma_f32_16x16x32_bf16 v[160:163], a[88:91], a[8:11], v[160:163]
    v_mfma_f32_16x16x32_bf16 v[160:163], a[92:95], a[12:15], v[160:163]
    v_mfma_f32_16x16x32_bf16 v[164:167], a[96:99], a[12:15], -4.0
    v_mfma_f32_16x16x32_bf16 v[164:167], a[100:103], a[8:11], v[164:167]
    v_mfma_f32_16x16x32_bf16 v[164:167], a[104:107], a[4:7], v[164:167]
    v_exp_f32 v160, v160
    v_mfma_f32_16x16x32_bf16 v[164:167], a[108:111], a[0:3], v[164:167]
    v_exp_f32 v161, v161
    v_mfma_f32_16x16x32_bf16 v[168:171], a[112:115], a[0:3], -4.0
    v_exp_f32 v162, v162
    v_mfma_f32_16x16x32_bf16 v[168:171], a[116:119], a[4:7], v[168:171]
    v_exp_f32 v163, v163
    v_mfma_f32_16x16x32_bf16 v[168:171], a[120:123], a[8:11], v[168:171]
    v_cvt_pk_bf16_f32 v176, v160, v161
    v_cvt_pk_bf16_f32 v177, v162, v163
    v_mfma_f32_16x16x32_bf16 v[168:171], a[124:127], a[12:15], v[168:171]
    s_waitcnt lgkmcnt(0)
    v_exp_f32 v164, v164
    v_mfma_f32_16x16x32_bf16 v[172:175], a[128:131], a[12:15], -4.0
    v_exp_f32 v165, v165
    v_mfma_f32_16x16x32_bf16 v[172:175], a[132:135], a[8:11], v[172:175]
    v_exp_f32 v166, v166
    v_mfma_f32_16x16x32_bf16 v[172:175], a[136:139], a[4:7], v[172:175]
    v_exp_f32 v167, v167
    v_mfma_f32_16x16x32_bf16 v[172:175], a[140:143], a[0:3], v[172:175]
    v_cvt_pk_bf16_f32 v178, v164, v165
    v_cvt_pk_bf16_f32 v179, v166, v167
    v_mfma_f32_16x16x32_bf16 v[128:131], v[192:195], a[144:147], v[128:131]
    ds_read_b64_tr_b16 a[144:145], v242 offset:0
    ds_read_b64_tr_b16 a[146:147], v242 offset:512
    v_mfma_f32_16x16x32_bf16 v[128:131], v[196:199], a[176:179], v[128:131]
    v_exp_f32 v168, v168
    v_mfma_f32_16x16x32_bf16 v[132:135], v[192:195], a[148:151], v[132:135]
    ds_read_b64_tr_b16 a[176:177], v243 offset:0
    ds_read_b64_tr_b16 a[178:179], v243 offset:512
    v_mfma_f32_16x16x32_bf16 v[132:135], v[196:199], a[180:183], v[132:135]
    v_exp_f32 v169, v169
    v_mfma_f32_16x16x32_bf16 v[136:139], v[192:195], a[152:155], v[136:139]
    ds_read_b64_tr_b16 a[148:149], v242 offset:16
    ds_read_b64_tr_b16 a[150:151], v242 offset:528
    v_mfma_f32_16x16x32_bf16 v[136:139], v[196:199], a[184:187], v[136:139]
    v_exp_f32 v170, v170
    v_mfma_f32_16x16x32_bf16 v[140:143], v[192:195], a[156:159], v[140:143]
    ds_read_b64_tr_b16 a[180:181], v243 offset:16
    ds_read_b64_tr_b16 a[182:183], v243 offset:528
    v_mfma_f32_16x16x32_bf16 v[140:143], v[196:199], a[188:191], v[140:143]
    v_exp_f32 v171, v171
    v_mfma_f32_16x16x32_bf16 v[144:147], v[192:195], a[160:163], v[144:147]
    ds_read_b64_tr_b16 a[152:153], v242 offset:32
    ds_read_b64_tr_b16 a[154:155], v242 offset:544
    v_mfma_f32_16x16x32_bf16 v[144:147], v[196:199], a[192:195], v[144:147]
    v_exp_f32 v172, v172
    v_mfma_f32_16x16x32_bf16 v[148:151], v[192:195], a[164:167], v[148:151]
    ds_read_b64_tr_b16 a[184:185], v243 offset:32
    ds_read_b64_tr_b16 a[186:187], v243 offset:544
    v_mfma_f32_16x16x32_bf16 v[148:151], v[196:199], a[196:199], v[148:151]
    v_exp_f32 v173, v173
    v_mfma_f32_16x16x32_bf16 v[152:155], v[192:195], a[168:171], v[152:155]
    ds_read_b64_tr_b16 a[156:157], v242 offset:48
    ds_read_b64_tr_b16 a[158:159], v242 offset:560
    v_mfma_f32_16x16x32_bf16 v[152:155], v[196:199], a[200:203], v[152:155]
    v_exp_f32 v174, v174
    v_mfma_f32_16x16x32_bf16 v[156:159], v[192:195], a[172:175], v[156:159]
    ds_read_b64_tr_b16 a[188:189], v243 offset:48
    ds_read_b64_tr_b16 a[190:191], v243 offset:560
    v_mfma_f32_16x16x32_bf16 v[156:159], v[196:199], a[204:207], v[156:159]
    v_exp_f32 v175, v175
    v_smfmac_f32_16x16x64_bf16 a[224:227], a[228:231], v[192:199], v247
    s_cbranch_scc1 L_loop0r0
    s_cbranch_vccnz L_midr0
L_transr0:
    v_mfma_f32_16x16x32_bf16 v[160:163], a[80:83], a[16:19], -4.0
    ds_read_b64_tr_b16 a[160:161], v242 offset:128
    ds_read_b64_tr_b16 a[162:163], v242 offset:640
    v_mfma_f32_16x16x32_bf16 v[160:163], a[84:87], a[20:23], v[160:163]
    v_cvt_pk_bf16_f32 v180, v168, v169
    v_cvt_pk_bf16_f32 v181, v170, v171
    v_mfma_f32_16x16x32_bf16 v[160:163], a[88:91], a[24:27], v[160:163]
    ds_read_b64_tr_b16 a[192:193], v243 offset:128
    ds_read_b64_tr_b16 a[194:195], v243 offset:640
    v_mfma_f32_16x16x32_bf16 v[160:163], a[92:95], a[28:31], v[160:163]
    v_cvt_pk_bf16_f32 v182, v172, v173
    v_cvt_pk_bf16_f32 v183, v174, v175
    v_mfma_f32_16x16x32_bf16 v[164:167], a[96:99], a[28:31], -4.0
    s_mov_b32 m0, s49
    ds_read_b64_tr_b16 a[164:165], v242 offset:144
    ds_read_b64_tr_b16 a[166:167], v242 offset:656
    v_mfma_f32_16x16x32_bf16 v[164:167], a[100:103], a[24:27], v[164:167]
    global_load_lds_dwordx4 v244, s[56:57] nt
    v_mfma_f32_16x16x32_bf16 v[164:167], a[104:107], a[20:23], v[164:167]
    ds_read_b64_tr_b16 a[196:197], v243 offset:144
    ds_read_b64_tr_b16 a[198:199], v243 offset:656
    v_mfma_f32_16x16x32_bf16 v[164:167], a[108:111], a[16:19], v[164:167]
    s_mov_b32 s64, 960
    v_exp_f32 v160, v160
    v_mfma_f32_16x16x32_bf16 v[168:171], a[112:115], a[16:19], -4.0
L_pad0_2:
    s_cbranch_execz L_ret0
    ds_read_b64_tr_b16 a[168:169], v242 offset:160
    ds_read_b64_tr_b16 a[170:171], v242 offset:672
    v_mfma_f32_16x16x32_bf16 v[168:171], a[116:119], a[20:23], v[168:171]
    v_exp_f32 v161, v161
    v_mfma_f32_16x16x32_bf16 v[168:171], a[120:123], a[24:27], v[168:171]
    ds_read_b64_tr_b16 a[200:201], v243 offset:160
    ds_read_b64_tr_b16 a[202:203], v243 offset:672
    v_mfma_f32_16x16x32_bf16 v[168:171], a[124:127], a[28:31], v[168:171]
    v_exp_f32 v162, v162
    v_mfma_f32_16x16x32_bf16 v[172:175], a[128:131], a[28:31], -4.0
    ds_read_b64_tr_b16 a[172:173], v242 offset:176
    ds_read_b64_tr_b16 a[174:175], v242 offset:688
    v_mfma_f32_16x16x32_bf16 v[172:175], a[132:135], a[24:27], v[172:175]
    v_exp_f32 v163, v163
    v_mfma_f32_16x16x32_bf16 v[172:175], a[136:139], a[20:23], v[172:175]
    ds_read_b64_tr_b16 a[204:205], v243 offset:176
    ds_read_b64_tr_b16 a[206:207], v243 offset:688
    v_mfma_f32_16x16x32_bf16 v[172:175], a[140:143], a[16:19], v[172:175]
    s_waitcnt lgkmcnt(8)
    v_cvt_pk_bf16_f32 v184, v160, v161
    v_cvt_pk_bf16_f32 v185, v162, v163
    v_mfma_f32_16x16x32_bf16 v[0:3], v[176:179], a[144:147], v[0:3]
    v_exp_f32 v164, v164
    v_mfma_f32_16x16x32_bf16 v[0:3], v[180:183], a[176:179], v[0:3]
    v_exp_f32 v165, v165
    v_mfma_f32_16x16x32_bf16 v[4:7], v[176:179], a[148:151], v[4:7]
    v_exp_f32 v166, v166
    v_mfma_f32_16x16x32_bf16 v[4:7], v[180:183], a[180:183], v[4:7]
    v_exp_f32 v167, v167
    v_mfma_f32_16x16x32_bf16 v[8:11], v[176:179], a[152:155], v[8:11]
    v_cvt_pk_bf16_f32 v186, v164, v165
    v_cvt_pk_bf16_f32 v187, v166, v167
    v_mfma_f32_16x16x32_bf16 v[8:11], v[180:183], a[184:187], v[8:11]
    v_exp_f32 v168, v168
    v_mfma_f32_16x16x32_bf16 v[12:15], v[176:179], a[156:159], v[12:15]
    v_exp_f32 v169, v169
    v_mfma_f32_16x16x32_bf16 v[12:15], v[180:183], a[188:191], v[12:15]
    v_exp_f32 v170, v170
    v_mfma_f32_16x16x32_bf16 v[16:19], v[176:179], a[160:163], v[16:19]
    v_exp_f32 v171, v171
    v_mfma_f32_16x16x32_bf16 v[16:19], v[180:183], a[192:195], v[16:19]
    v_cvt_pk_bf16_f32 v188, v168, v169
    v_cvt_pk_bf16_f32 v189, v170, v171
    v_mfma_f32_16x16x32_bf16 v[20:23], v[176:179], a[164:167], v[20:23]
    v_exp_f32 v172, v172
    v_mfma_f32_16x16x32_bf16 v[20:23], v[180:183], a[196:199], v[20:23]
    s_waitcnt lgkmcnt(0)
    v_exp_f32 v173, v173
    v_mfma_f32_16x16x32_bf16 v[24:27], v[176:179], a[168:171], v[24:27]
    v_exp_f32 v174, v174
    v_mfma_f32_16x16x32_bf16 v[24:27], v[180:183], a[200:203], v[24:27]
    v_exp_f32 v175, v175
    v_mfma_f32_16x16x32_bf16 v[28:31], v[176:179], a[172:175], v[28:31]
    v_cvt_pk_bf16_f32 v190, v172, v173
    v_cvt_pk_bf16_f32 v191, v174, v175
    v_mfma_f32_16x16x32_bf16 v[28:31], v[180:183], a[204:207], v[28:31]
    s_waitcnt vmcnt(10)
    v_smfmac_f32_16x16x64_bf16 a[208:211], a[228:231], v[176:183], v247
    s_barrier
    v_mfma_f32_16x16x32_bf16 v[160:163], a[80:83], a[32:35], -4.0
    s_add_u32 m0, s26, 0
    v_add_u32 v240, s27, v240
    v_mfma_f32_16x16x32_bf16 v[160:163], a[84:87], a[36:39], v[160:163]
    global_load_lds_dwordx4 v244, s[52:53] offset:0
    v_mfma_f32_16x16x32_bf16 v[160:163], a[88:91], a[40:43], v[160:163]
    s_add_u32 m0, s26, 32
    v_add_u32 v241, s27, v241
    v_mfma_f32_16x16x32_bf16 v[160:163], a[92:95], a[44:47], v[160:163]
    global_load_lds_dwordx4 v244, s[52:53] offset:1024
    v_mfma_f32_16x16x32_bf16 v[164:167], a[96:99], a[44:47], -4.0
    s_add_u32 m0, s26, 64
    v_add_u32 v242, s27, v242
    v_mfma_f32_16x16x32_bf16 v[164:167], a[100:103], a[40:43], v[164:167]
    global_load_lds_dwordx4 v244, s[52:53] offset:2048
    v_mfma_f32_16x16x32_bf16 v[164:167], a[104:107], a[36:39], v[164:167]
    ds_read_b128 v[232:235], v245 offset:5440
    ds_read_b128 v[236:239], v245 offset:5504
    v_exp_f32 v160, v160
    v_accvgpr_read_b32 v248, a208
    v_accvgpr_read_b32 v249, a209
    v_add_f32 v248, v248, v249
    v_subrev_u32 v249, s42, v248
    v_rcp_f32 v248, v248
    v_cmp_le_u32 vcc, s43, v249
    v_mov_b32 v251, v248
    v_mov_b32_dpp v251, v248 row_ror:12 row_mask:0x2 bank_mask:0xf
    v_mov_b32_dpp v251, v248 row_ror:8 row_mask:0x4 bank_mask:0xf
    v_mov_b32_dpp v251, v248 row_ror:4 row_mask:0x8 bank_mask:0xf
    v_accvgpr_write_b32 a208, 0
    v_accvgpr_write_b32 a209, 0
    v_mov_b32_dpp v248, v251 row_newbcast:0 row_mask:0xf bank_mask:0xf
    v_mov_b32_dpp v249, v251 row_newbcast:1 row_mask:0xf bank_mask:0xf
    v_mov_b32_dpp v250, v251 row_newbcast:2 row_mask:0xf bank_mask:0xf
    v_mov_b32_dpp v251, v251 row_newbcast:3 row_mask:0xf bank_mask:0xf
    v_pk_mul_f32 v[0:1], v[0:1], v[248:249]
    v_pk_mul_f32 v[2:3], v[2:3], v[250:251]
    v_pk_mul_f32 v[4:5], v[4:5], v[248:249]
    v_pk_mul_f32 v[6:7], v[6:7], v[250:251]
    v_pk_mul_f32 v[8:9], v[8:9], v[248:249]
    v_pk_mul_f32 v[10:11], v[10:11], v[250:251]
    v_pk_mul_f32 v[12:13], v[12:13], v[248:249]
    v_pk_mul_f32 v[14:15], v[14:15], v[250:251]
    v_pk_mul_f32 v[16:17], v[16:17], v[248:249]
    v_pk_mul_f32 v[18:19], v[18:19], v[250:251]
    v_pk_mul_f32 v[20:21], v[20:21], v[248:249]
    v_pk_mul_f32 v[22:23], v[22:23], v[250:251]
    v_pk_mul_f32 v[24:25], v[24:25], v[248:249]
    v_pk_mul_f32 v[26:27], v[26:27], v[250:251]
    v_pk_mul_f32 v[28:29], v[28:29], v[248:249]
    v_pk_mul_f32 v[30:31], v[30:31], v[250:251]
    v_mfma_f32_16x16x32_bf16 v[164:167], a[108:111], a[32:35], v[164:167]
    s_add_u32 m0, s26, 96
    v_exp_f32 v161, v161
    v_mfma_f32_16x16x32_bf16 v[168:171], a[112:115], a[32:35], -4.0
    s_or_b64 s[44:45], s[44:45], vcc
    global_load_lds_dwordx4 v244, s[52:53] offset:3072
    v_exp_f32 v162, v162
    v_mfma_f32_16x16x32_bf16 v[168:171], a[116:119], a[36:39], v[168:171]
    v_exp_f32 v163, v163
    v_mfma_f32_16x16x32_bf16 v[168:171], a[120:123], a[40:43], v[168:171]
    s_add_u32 m0, s26, 16896
    v_cvt_pk_bf16_f32 v176, v160, v161
    v_cvt_pk_bf16_f32 v177, v162, v163
    v_mfma_f32_16x16x32_bf16 v[168:171], a[124:127], a[44:47], v[168:171]
    global_load_lds_dwordx4 v244, s[54:55] offset:0
    v_exp_f32 v164, v164
    v_mfma_f32_16x16x32_bf16 v[172:175], a[128:131], a[44:47], -4.0
    v_exp_f32 v165, v165
    v_mfma_f32_16x16x32_bf16 v[172:175], a[132:135], a[40:43], v[172:175]
    s_add_u32 m0, s26, 16912
    v_exp_f32 v166, v166
    v_mfma_f32_16x16x32_bf16 v[172:175], a[136:139], a[36:39], v[172:175]
    global_load_lds_dwordx4 v244, s[54:55] offset:1024
    v_exp_f32 v167, v167
    v_mfma_f32_16x16x32_bf16 v[172:175], a[140:143], a[32:35], v[172:175]
    v_cvt_pk_bf16_f32 v178, v164, v165
    v_cvt_pk_bf16_f32 v179, v166, v167
    v_mfma_f32_16x16x32_bf16 v[32:35], v[184:187], a[144:147], v[32:35]
    s_add_u32 m0, s26, 16928
    v_exp_f32 v168, v168
    v_mfma_f32_16x16x32_bf16 v[32:35], v[188:191], a[176:179], v[32:35]
    s_waitcnt lgkmcnt(0)
    global_load_lds_dwordx4 v244, s[54:55] offset:2048
    v_exp_f32 v169, v169
    v_lshlrev_b32 v248, 16, v232
    v_and_b32 v249, 0xffff0000, v232
    v_lshlrev_b32 v250, 16, v233
    v_and_b32 v251, 0xffff0000, v233
    v_pk_mul_f32 v[248:249], v[248:249], s[40:41]
    v_pk_mul_f32 v[250:251], v[250:251], s[40:41]
    v_cvt_pk_bf16_f32 v232, v248, v249
    v_cvt_pk_bf16_f32 v233, v250, v251
    v_accvgpr_write_b32 a32, v232
    v_accvgpr_write_b32 a33, v233
    v_lshlrev_b32 v248, 16, v234
    v_and_b32 v249, 0xffff0000, v234
    v_lshlrev_b32 v250, 16, v235
    v_and_b32 v251, 0xffff0000, v235
    v_pk_mul_f32 v[248:249], v[248:249], s[40:41]
    v_pk_mul_f32 v[250:251], v[250:251], s[40:41]
    v_cvt_pk_bf16_f32 v234, v248, v249
    v_cvt_pk_bf16_f32 v235, v250, v251
    v_accvgpr_write_b32 a34, v234
    v_accvgpr_write_b32 a35, v235
    v_mfma_f32_16x16x32_bf16 v[36:39], v[184:187], a[148:151], v[36:39]
    ds_read_b128 v[232:235], v245 offset:5568
    v_exp_f32 v170, v170
    v_lshlrev_b32 v248, 16, v236
    v_and_b32 v249, 0xffff0000, v236
    v_lshlrev_b32 v250, 16, v237
    v_and_b32 v251, 0xffff0000, v237
    v_pk_mul_f32 v[248:249], v[248:249], s[40:41]
    v_pk_mul_f32 v[250:251], v[250:251], s[40:41]
    v_cvt_pk_bf16_f32 v236, v248, v249
    v_cvt_pk_bf16_f32 v237, v250, v251
    v_accvgpr_write_b32 a36, v236
    v_accvgpr_write_b32 a37, v237
    v_lshlrev_b32 v248, 16, v238
    v_and_b32 v249, 0xffff0000, v238
    v_lshlrev_b32 v250, 16, v239
    v_and_b32 v251, 0xffff0000, v239
    v_pk_mul_f32 v[248:249], v[248:249], s[40:41]
    v_pk_mul_f32 v[250:251], v[250:251], s[40:41]
    v_cvt_pk_bf16_f32 v238, v248, v249
    v_cvt_pk_bf16_f32 v239, v250, v251
    v_accvgpr_write_b32 a38, v238
    v_accvgpr_write_b32 a39, v239
    v_mfma_f32_16x16x32_bf16 v[36:39], v[188:191], a[180:183], v[36:39]
    s_add_u32 m0, s26, 16944
    ds_read_b128 v[236:239], v245 offset:5632
    v_exp_f32 v171, v171
    v_mfma_f32_16x16x32_bf16 v[40:43], v[184:187], a[152:155], v[40:43]
    global_load_lds_dwordx4 v244, s[54:55] offset:3072
    v_cvt_pk_bf16_f32 v180, v168, v169
    v_cvt_pk_bf16_f32 v181, v170, v171
    v_mfma_f32_16x16x32_bf16 v[40:43], v[188:191], a[184:187], v[40:43]
    s_waitcnt lgkmcnt(1)
    v_exp_f32 v172, v172
    v_lshlrev_b32 v248, 16, v232
    v_and_b32 v249, 0xffff0000, v232
    v_lshlrev_b32 v250, 16, v233
    v_and_b32 v251, 0xffff0000, v233
    v_pk_mul_f32 v[248:249], v[248:249], s[40:41]
    v_pk_mul_f32 v[250:251], v[250:251], s[40:41]
    v_cvt_pk_bf16_f32 v232, v248, v249
    v_cvt_pk_bf16_f32 v233, v250, v251
    v_accvgpr_write_b32 a40, v232
    v_accvgpr_write_b32 a41, v233
    v_lshlrev_b32 v248, 16, v234
    v_and_b32 v249, 0xffff0000, v234
    v_lshlrev_b32 v250, 16, v235
    v_and_b32 v251, 0xffff0000, v235
    v_pk_mul_f32 v[248:249], v[248:249], s[40:41]
    v_pk_mul_f32 v[250:251], v[250:251], s[40:41]
    v_cvt_pk_bf16_f32 v234, v248, v249
    v_cvt_pk_bf16_f32 v235, v250, v251
    v_accvgpr_write_b32 a42, v234
    v_accvgpr_write_b32 a43, v235
    v_mfma_f32_16x16x32_bf16 v[44:47], v[184:187], a[156:159], v[44:47]
    s_waitcnt lgkmcnt(0)
    v_exp_f32 v173, v173
    v_lshlrev_b32 v248, 16, v236
    v_and_b32 v249, 0xffff0000, v236
    v_lshlrev_b32 v250, 16, v237
    v_and_b32 v251, 0xffff0000, v237
    v_pk_mul_f32 v[248:249], v[248:249], s[40:41]
    v_pk_mul_f32 v[250:251], v[250:251], s[40:41]
    v_cvt_pk_bf16_f32 v236, v248, v249
    v_cvt_pk_bf16_f32 v237, v250, v251
    v_accvgpr_write_b32 a44, v236
    v_accvgpr_write_b32 a45, v237
    v_lshlrev_b32 v248, 16, v238
    v_and_b32 v249, 0xffff0000, v238
    v_lshlrev_b32 v250, 16, v239
    v_and_b32 v251, 0xffff0000, v239
    v_pk_mul_f32 v[248:249], v[248:249], s[40:41]
    v_pk_mul_f32 v[250:251], v[250:251], s[40:41]
    v_cvt_pk_bf16_f32 v238, v248, v249
    v_cvt_pk_bf16_f32 v239, v250, v251
    v_accvgpr_write_b32 a46, v238
    v_accvgpr_write_b32 a47, v239
    v_mfma_f32_16x16x32_bf16 v[44:47], v[188:191], a[188:191], v[44:47]
    v_exp_f32 v174, v174
    v_mfma_f32_16x16x32_bf16 v[48:51], v[184:187], a[160:163], v[48:51]
    v_exp_f32 v175, v175
    v_mfma_f32_16x16x32_bf16 v[48:51], v[188:191], a[192:195], v[48:51]
    v_cvt_pk_bf16_f32 v182, v172, v173
    v_cvt_pk_bf16_f32 v183, v174, v175
    v_mfma_f32_16x16x32_bf16 v[52:55], v[184:187], a[164:167], v[52:55]
    v_add_u32 v243, s27, v243
    v_mfma_f32_16x16x32_bf16 v[52:55], v[188:191], a[196:199], v[52:55]
    s_add_u32 s24, s24, 16384
    v_cvt_pk_bf16_f32 v0, v0, v4
    v_cvt_pk_bf16_f32 v4, v1, v5
    v_mfma_f32_16x16x32_bf16 v[56:59], v[184:187], a[168:171], v[56:59]
    s_and_b32 s24, s24, 0x3ffff
    v_cvt_pk_bf16_f32 v1, v8, v12
    v_cvt_pk_bf16_f32 v5, v9, v13
    v_mfma_f32_16x16x32_bf16 v[56:59], v[188:191], a[200:203], v[56:59]
    s_add_u32 s65, s25, s24
    v_mfma_f32_16x16x32_bf16 v[60:63], v[184:187], a[172:175], v[60:63]
    s_add_u32 s52, s8, s65
    s_addc_u32 s53, s9, 0
    v_mfma_f32_16x16x32_bf16 v[60:63], v[188:191], a[204:207], v[60:63]
    s_add_u32 s54, s12, s65
    s_addc_u32 s55, s13, 0
    v_smfmac_f32_16x16x64_bf16 a[212:215], a[228:231], v[184:191], v247
    s_add_u32 s26, s26, s27
    v_mfma_f32_16x16x32_bf16 v[160:163], a[80:83], a[48:51], -4.0
    s_cmp_eq_u32 s26, s48
    s_cselect_b32 s27, s58, s59
    v_mfma_f32_16x16x32_bf16 v[160:163], a[84:87], a[52:55], v[160:163]
    v_mfma_f32_16x16x32_bf16 v[160:163], a[88:91], a[56:59], v[160:163]
    v_accvgpr_read_b32 v248, a212
    v_accvgpr_read_b32 v249, a213
    v_add_f32 v248, v248, v249
    v_subrev_u32 v249, s42, v248
    v_rcp_f32 v248, v248
    v_cmp_le_u32 vcc, s43, v249
    v_mov_b32 v251, v248
    v_mov_b32_dpp v251, v248 row_ror:12 row_mask:0x2 bank_mask:0xf
    v_mov_b32_dpp v251, v248 row_ror:8 row_mask:0x4 bank_mask:0xf
    v_mov_b32_dpp v251, v248 row_ror:4 row_mask:0x8 bank_mask:0xf
    v_accvgpr_write_b32 a212, 0
    v_accvgpr_write_b32 a213, 0
    v_mov_b32_dpp v248, v251 row_newbcast:0 row_mask:0xf bank_mask:0xf
    v_mov_b32_dpp v249, v251 row_newbcast:1 row_mask:0xf bank_mask:0xf
    v_mov_b32_dpp v250, v251 row_newbcast:2 row_mask:0xf bank_mask:0xf
    v_mov_b32_dpp v251, v251 row_newbcast:3 row_mask:0xf bank_mask:0xf
    v_pk_mul_f32 v[32:33], v[32:33], v[248:249]
    v_pk_mul_f32 v[34:35], v[34:35], v[250:251]
    v_pk_mul_f32 v[36:37], v[36:37], v[248:249]
    v_pk_mul_f32 v[38:39], v[38:39], v[250:251]
    v_pk_mul_f32 v[40:41], v[40:41], v[248:249]
    v_pk_mul_f32 v[42:43], v[42:43], v[250:251]
    v_pk_mul_f32 v[44:45], v[44:45], v[248:249]
    v_pk_mul_f32 v[46:47], v[46:47], v[250:251]
    v_pk_mul_f32 v[48:49], v[48:49], v[248:249]
    v_pk_mul_f32 v[50:51], v[50:51], v[250:251]
    v_pk_mul_f32 v[52:53], v[52:53], v[248:249]
    v_pk_mul_f32 v[54:55], v[54:55], v[250:251]
    v_pk_mul_f32 v[56:57], v[56:57], v[248:249]
    v_pk_mul_f32 v[58:59], v[58:59], v[250:251]
    v_pk_mul_f32 v[60:61], v[60:61], v[248:249]
    v_pk_mul_f32 v[62:63], v[62:63], v[250:251]
    v_cvt_pk_bf16_f32 v32, v32, v36
    v_cvt_pk_bf16_f32 v36, v33, v37
    v_cvt_pk_bf16_f32 v33, v40, v44
    v_cvt_pk_bf16_f32 v37, v41, v45
    v_mfma_f32_16x16x32_bf16 v[160:163], a[92:95], a[60:63], v[160:163]
    s_or_b64 s[44:45], s[44:45], vcc
    ds_write_b64 v246, v[0:1] offset:5440
    v_cvt_pk_bf16_f32 v2, v2, v6
    v_cvt_pk_bf16_f32 v6, v3, v7
    v_mfma_f32_16x16x32_bf16 v[164:167], a[96:99], a[60:63], -4.0
    ds_write_b64 v246, v[4:5] offset:6528
    v_cvt_pk_bf16_f32 v3, v10, v14
    v_cvt_pk_bf16_f32 v7, v11, v15
    v_mfma_f32_16x16x32_bf16 v[164:167], a[100:103], a[56:59], v[164:167]
    ds_write_b64 v246, v[2:3] offset:7616
    v_cvt_pk_bf16_f32 v16, v16, v20
    v_cvt_pk_bf16_f32 v20, v17, v21
    v_mfma_f32_16x16x32_bf16 v[164:167], a[104:107], a[52:55], v[164:167]
    ds_write_b64 v246, v[6:7] offset:8704
    v_exp_f32 v160, v160
    v_cvt_pk_bf16_f32 v17, v24, v28
    v_cvt_pk_bf16_f32 v21, v25, v29
    v_mfma_f32_16x16x32_bf16 v[164:167], a[108:111], a[48:51], v[164:167]
    ds_write_b64 v246, v[16:17] offset:5568
    v_exp_f32 v161, v161
    v_cvt_pk_bf16_f32 v18, v18, v22
    v_cvt_pk_bf16_f32 v22, v19, v23
    v_mfma_f32_16x16x32_bf16 v[168:171], a[112:115], a[48:51], -4.0
    ds_write_b64 v246, v[20:21] offset:6656
    v_exp_f32 v162, v162
    v_cvt_pk_bf16_f32 v19, v26, v30
    v_cvt_pk_bf16_f32 v23, v27, v31
    v_mfma_f32_16x16x32_bf16 v[168:171], a[116:119], a[52:55], v[168:171]
    ds_write_b64 v246, v[18:19] offset:7744
    v_exp_f32 v163, v163
    v_mfma_f32_16x16x32_bf16 v[168:171], a[120:123], a[56:59], v[168:171]
    ds_write_b64 v246, v[22:23] offset:8832
    v_cvt_pk_bf16_f32 v184, v160, v161
    v_cvt_pk_bf16_f32 v185, v162, v163
    v_mfma_f32_16x16x32_bf16 v[168:171], a[124:127], a[60:63], v[168:171]
    v_exp_f32 v164, v164
    v_mfma_f32_16x16x32_bf16 v[172:175], a[128:131], a[60:63], -4.0
    ds_read_b64_tr_b16 v[0:1], v252 offset:5440
    ds_read_b64_tr_b16 v[2:3], v252 offset:5472
    v_exp_f32 v165, v165
    v_mfma_f32_16x16x32_bf16 v[172:175], a[132:135], a[56:59], v[172:175]
    ds_read_b64_tr_b16 v[4:5], v252 offset:6528
    ds_read_b64_tr_b16 v[6:7], v252 offset:6560
    v_exp_f32 v166, v166
    v_mfma_f32_16x16x32_bf16 v[172:175], a[136:139], a[52:55], v[172:175]
    ds_read_b64_tr_b16 v[8:9], v252 offset:7616
    ds_read_b64_tr_b16 v[10:11], v252 offset:7648
    v_exp_f32 v167, v167
    v_mfma_f32_16x16x32_bf16 v[172:175], a[140:143], a[48:51], v[172:175]
    ds_read_b64_tr_b16 v[12:13], v252 offset:8704
    ds_read_b64_tr_b16 v[14:15], v252 offset:8736
    v_cvt_pk_bf16_f32 v186, v164, v165
    v_cvt_pk_bf16_f32 v187, v166, v167
    v_mfma_f32_16x16x32_bf16 v[64:67], v[176:179], a[144:147], v[64:67]
    ds_read_b128 a[48:51], v245 offset:9792
    ds_write_b64 v246, v[32:33] offset:5440
    v_exp_f32 v168, v168
    v_cvt_pk_bf16_f32 v34, v34, v38
    v_cvt_pk_bf16_f32 v38, v35, v39
    v_mfma_f32_16x16x32_bf16 v[64:67], v[180:183], a[176:179], v[64:67]
    ds_read_b128 a[52:55], v245 offset:9856
    ds_write_b64 v246, v[36:37] offset:6528
    v_exp_f32 v169, v169
    v_cvt_pk_bf16_f32 v35, v42, v46
    v_cvt_pk_bf16_f32 v39, v43, v47
    v_mfma_f32_16x16x32_bf16 v[68:71], v[176:179], a[148:151], v[68:71]
    ds_read_b128 a[56:59], v245 offset:9920
    ds_write_b64 v246, v[34:35] offset:7616
    v_exp_f32 v170, v170
    v_cvt_pk_bf16_f32 v48, v48, v52
    v_cvt_pk_bf16_f32 v52, v49, v53
    v_mfma_f32_16x16x32_bf16 v[68:71], v[180:183], a[180:183], v[68:71]
    ds_read_b128 a[60:63], v245 offset:9984
    ds_write_b64 v246, v[38:39] offset:8704
    v_exp_f32 v171, v171
    v_cvt_pk_bf16_f32 v49, v56, v60
    v_cvt_pk_bf16_f32 v53, v57, v61
    v_mfma_f32_16x16x32_bf16 v[72:75], v[176:179], a[152:155], v[72:75]
    ds_write_b64 v246, v[48:49] offset:5568
    v_cvt_pk_bf16_f32 v188, v168, v169
    v_cvt_pk_bf16_f32 v189, v170, v171
    v_cvt_pk_bf16_f32 v50, v50, v54
    v_cvt_pk_bf16_f32 v54, v51, v55
    v_mfma_f32_16x16x32_bf16 v[72:75], v[180:183], a[184:187], v[72:75]
    s_waitcnt lgkmcnt(15)
    buffer_store_dwordx4 v[0:3], v244, s[16:19], s30 offen offset:0
    ds_write_b64 v246, v[52:53] offset:6656
    v_exp_f32 v172, v172
    v_cvt_pk_bf16_f32 v51, v58, v62
    v_cvt_pk_bf16_f32 v55, v59, v63
    v_mfma_f32_16x16x32_bf16 v[76:79], v[176:179], a[156:159], v[76:79]
    ds_write_b64 v246, v[50:51] offset:7744
    v_exp_f32 v173, v173
    v_mfma_f32_16x16x32_bf16 v[76:79], v[180:183], a[188:191], v[76:79]
    ds_write_b64 v246, v[54:55] offset:8832
    v_exp_f32 v174, v174
    v_mfma_f32_16x16x32_bf16 v[80:83], v[176:179], a[160:163], v[80:83]
    v_exp_f32 v175, v175
    v_mfma_f32_16x16x32_bf16 v[80:83], v[180:183], a[192:195], v[80:83]
    ds_read_b64_tr_b16 v[32:33], v252 offset:5440
    ds_read_b64_tr_b16 v[34:35], v252 offset:5472
    v_cvt_pk_bf16_f32 v190, v172, v173
    v_cvt_pk_bf16_f32 v191, v174, v175
    v_mfma_f32_16x16x32_bf16 v[84:87], v[176:179], a[164:167], v[84:87]
    s_waitcnt lgkmcnt(10)
    buffer_store_dwordx4 v[4:7], v244, s[16:19], s30 offen offset:1024
    v_mfma_f32_16x16x32_bf16 v[84:87], v[180:183], a[196:199], v[84:87]
    ds_read_b64_tr_b16 v[36:37], v252 offset:6528
    ds_read_b64_tr_b16 v[38:39], v252 offset:6560
    v_mfma_f32_16x16x32_bf16 v[88:91], v[176:179], a[168:171], v[88:91]
    ds_read_b64_tr_b16 v[40:41], v252 offset:7616
    ds_read_b64_tr_b16 v[42:43], v252 offset:7648
    v_mfma_f32_16x16x32_bf16 v[88:91], v[180:183], a[200:203], v[88:91]
    ds_read_b64_tr_b16 v[44:45], v252 offset:8704
    ds_read_b64_tr_b16 v[46:47], v252 offset:8736
    v_mfma_f32_16x16x32_bf16 v[92:95], v[176:179], a[172:175], v[92:95]
    buffer_store_dwordx4 v[8:11], v244, s[16:19], s30 offen offset:2048
    v_mfma_f32_16x16x32_bf16 v[92:95], v[180:183], a[204:207], v[92:95]
    v_smfmac_f32_16x16x64_bf16 a[216:219], a[228:231], v[176:183], v247
    v_mfma_f32_16x16x32_bf16 v[160:163], a[80:83], a[64:67], -4.0
    ds_read_b128 a[80:83], v240 offset:0
    v_mfma_f32_16x16x32_bf16 v[160:163], a[84:87], a[68:71], v[160:163]
    ds_read_b128 a[84:87], v240 offset:64
    buffer_store_dwordx4 v[12:15], v244, s[16:19], s30 offen offset:3072
    v_mfma_f32_16x16x32_bf16 v[160:163], a[88:91], a[72:75], v[160:163]
    ds_read_b128 a[88:91], v240 offset:128
    v_accvgpr_read_b32 v248, a216
    v_accvgpr_read_b32 v249, a217
    v_add_f32 v248, v248, v249
    v_subrev_u32 v249, s42, v248
    v_rcp_f32 v248, v248
    v_cmp_le_u32 vcc, s43, v249
    v_mov_b32 v251, v248
    v_mov_b32_dpp v251, v248 row_ror:12 row_mask:0x2 bank_mask:0xf
    v_mov_b32_dpp v251, v248 row_ror:8 row_mask:0x4 bank_mask:0xf
    v_mov_b32_dpp v251, v248 row_ror:4 row_mask:0x8 bank_mask:0xf
    v_accvgpr_write_b32 a216, 0
    v_accvgpr_write_b32 a217, 0
    v_mov_b32_dpp v248, v251 row_newbcast:0 row_mask:0xf bank_mask:0xf
    v_mov_b32_dpp v249, v251 row_newbcast:1 row_mask:0xf bank_mask:0xf
    v_mov_b32_dpp v250, v251 row_newbcast:2 row_mask:0xf bank_mask:0xf
    v_mov_b32_dpp v251, v251 row_newbcast:3 row_mask:0xf bank_mask:0xf
    v_pk_mul_f32 v[64:65], v[64:65], v[248:249]
    v_pk_mul_f32 v[66:67], v[66:67], v[250:251]
    v_pk_mul_f32 v[68:69], v[68:69], v[248:249]
    v_pk_mul_f32 v[70:71], v[70:71], v[250:251]
    v_pk_mul_f32 v[72:73], v[72:73], v[248:249]
    v_pk_mul_f32 v[74:75], v[74:75], v[250:251]
    v_pk_mul_f32 v[76:77], v[76:77], v[248:249]
    v_pk_mul_f32 v[78:79], v[78:79], v[250:251]
    v_pk_mul_f32 v[80:81], v[80:81], v[248:249]
    v_pk_mul_f32 v[82:83], v[82:83], v[250:251]
    v_pk_mul_f32 v[84:85], v[84:85], v[248:249]
    v_pk_mul_f32 v[86:87], v[86:87], v[250:251]
    v_pk_mul_f32 v[88:89], v[88:89], v[248:249]
    v_pk_mul_f32 v[90:91], v[90:91], v[250:251]
    v_pk_mul_f32 v[92:93], v[92:93], v[248:249]
    v_pk_mul_f32 v[94:95], v[94:95], v[250:251]
    v_cvt_pk_bf16_f32 v64, v64, v68
    v_cvt_pk_bf16_f32 v68, v65, v69
    v_cvt_pk_bf16_f32 v65, v72, v76
    v_cvt_pk_bf16_f32 v69, v73, v77
    v_mfma_f32_16x16x32_bf16 v[160:163], a[92:95], a[76:79], v[160:163]
    s_or_b64 s[44:45], s[44:45], vcc
    ds_read_b128 a[92:95], v240 offset:192
    ds_write_b64 v246, v[64:65] offset:5440
    v_cvt_pk_bf16_f32 v66, v66, v70
    v_cvt_pk_bf16_f32 v70, v67, v71
    v_mfma_f32_16x16x32_bf16 v[164:167], a[96:99], a[76:79], -4.0
    ds_read_b128 a[96:99], v240 offset:704
    ds_write_b64 v246, v[68:69] offset:6528
    v_cvt_pk_bf16_f32 v67, v74, v78
    v_cvt_pk_bf16_f32 v71, v75, v79
    v_mfma_f32_16x16x32_bf16 v[164:167], a[100:103], a[72:75], v[164:167]
    s_waitcnt lgkmcnt(7)
    ds_read_b128 a[100:103], v240 offset:640
    buffer_store_dwordx4 v[32:35], v244, s[16:19], s31 offen offset:0
    ds_write_b64 v246, v[66:67] offset:7616
    v_cvt_pk_bf16_f32 v80, v80, v84
    v_cvt_pk_bf16_f32 v84, v81, v85
    v_mfma_f32_16x16x32_bf16 v[164:167], a[104:107], a[68:71], v[164:167]
    ds_write_b64 v246, v[70:71] offset:8704
    v_exp_f32 v160, v160
    v_cvt_pk_bf16_f32 v81, v88, v92
    v_cvt_pk_bf16_f32 v85, v89, v93
    v_mfma_f32_16x16x32_bf16 v[164:167], a[108:111], a[64:67], v[164:167]
    ds_write_b64 v246, v[80:81] offset:5568
    v_exp_f32 v161, v161
    v_cvt_pk_bf16_f32 v82, v82, v86
    v_cvt_pk_bf16_f32 v86, v83, v87
    v_mfma_f32_16x16x32_bf16 v[168:171], a[112:115], a[64:67], -4.0
    ds_read_b128 a[104:107], v240 offset:576
    ds_write_b64 v246, v[84:85] offset:6656
    v_cvt_pk_bf16_f32 v192, v160, v161
    v_cvt_pk_bf16_f32 v83, v90, v94
    v_cvt_pk_bf16_f32 v87, v91, v95
    v_mfma_f32_16x16x32_bf16 v[168:171], a[116:119], a[68:71], v[168:171]
    buffer_store_dwordx4 v[36:39], v244, s[16:19], s31 offen offset:1024
    ds_write_b64 v246, v[82:83] offset:7744
    v_exp_f32 v162, v162
    v_mfma_f32_16x16x32_bf16 v[168:171], a[120:123], a[72:75], v[168:171]
    ds_write_b64 v246, v[86:87] offset:8832
    v_exp_f32 v163, v163
    v_mfma_f32_16x16x32_bf16 v[168:171], a[124:127], a[76:79], v[168:171]
    ds_read_b128 a[108:111], v240 offset:512
    v_cvt_pk_bf16_f32 v193, v162, v163
    v_mfma_f32_16x16x32_bf16 v[172:175], a[128:131], a[76:79], -4.0
    ds_read_b64_tr_b16 v[64:65], v252 offset:5440
    ds_read_b64_tr_b16 v[66:67], v252 offset:5472
    v_exp_f32 v164, v164
    v_mfma_f32_16x16x32_bf16 v[172:175], a[132:135], a[72:75], v[172:175]
    buffer_store_dwordx4 v[40:43], v244, s[16:19], s31 offen offset:2048
    v_exp_f32 v165, v165
    v_mfma_f32_16x16x32_bf16 v[172:175], a[136:139], a[68:71], v[172:175]
    ds_read_b128 a[112:115], v241 offset:0
    ds_read_b64_tr_b16 v[68:69], v252 offset:6528
    ds_read_b64_tr_b16 v[70:71], v252 offset:6560
    v_cvt_pk_bf16_f32 v194, v164, v165
    v_mfma_f32_16x16x32_bf16 v[172:175], a[140:143], a[64:67], v[172:175]
    ds_read_b64_tr_b16 v[72:73], v252 offset:7616
    ds_read_b64_tr_b16 v[74:75], v252 offset:7648
    v_exp_f32 v166, v166
    v_mfma_f32_16x16x32_bf16 v[96:99], v[184:187], a[144:147], v[96:99]
    ds_read_b64_tr_b16 v[76:77], v252 offset:8704
    ds_read_b64_tr_b16 v[78:79], v252 offset:8736
    v_exp_f32 v167, v167
    v_mfma_f32_16x16x32_bf16 v[96:99], v[188:191], a[176:179], v[96:99]
    ds_read_b128 a[116:119], v241 offset:64
    buffer_store_dwordx4 v[44:47], v244, s[16:19], s31 offen offset:3072
    v_cvt_pk_bf16_f32 v195, v166, v167
    v_mfma_f32_16x16x32_bf16 v[100:103], v[184:187], a[148:151], v[100:103]
    v_exp_f32 v168, v168
    v_mfma_f32_16x16x32_bf16 v[100:103], v[188:191], a[180:183], v[100:103]
    v_exp_f32 v169, v169
    v_mfma_f32_16x16x32_bf16 v[104:107], v[184:187], a[152:155], v[104:107]
    ds_read_b128 a[120:123], v241 offset:128
    v_cvt_pk_bf16_f32 v196, v168, v169
    v_mfma_f32_16x16x32_bf16 v[104:107], v[188:191], a[184:187], v[104:107]
    v_exp_f32 v170, v170
    v_mfma_f32_16x16x32_bf16 v[108:111], v[184:187], a[156:159], v[108:111]
    s_waitcnt lgkmcnt(9)
    buffer_store_dwordx4 v[64:67], v244, s[16:19], s32 offen offset:0
    v_exp_f32 v171, v171
    v_mfma_f32_16x16x32_bf16 v[108:111], v[188:191], a[188:191], v[108:111]
    ds_read_b128 a[124:127], v241 offset:192
    v_cvt_pk_bf16_f32 v197, v170, v171
    v_mfma_f32_16x16x32_bf16 v[112:115], v[184:187], a[160:163], v[112:115]
    v_exp_f32 v172, v172
    v_mfma_f32_16x16x32_bf16 v[112:115], v[188:191], a[192:195], v[112:115]
    v_exp_f32 v173, v173
    v_mfma_f32_16x16x32_bf16 v[116:119], v[184:187], a[164:167], v[116:119]
    s_waitcnt lgkmcnt(2)
    ds_read_b128 a[128:131], v241 offset:704
    buffer_store_dwordx4 v[68:71], v244, s[16:19], s32 offen offset:1024
    v_cvt_pk_bf16_f32 v198, v172, v173
    v_mfma_f32_16x16x32_bf16 v[116:119], v[188:191], a[196:199], v[116:119]
    v_exp_f32 v174, v174
    v_mfma_f32_16x16x32_bf16 v[120:123], v[184:187], a[168:171], v[120:123]
    v_exp_f32 v175, v175
    v_mfma_f32_16x16x32_bf16 v[120:123], v[188:191], a[200:203], v[120:123]
    ds_read_b128 a[132:135], v241 offset:640
    v_cvt_pk_bf16_f32 v199, v174, v175
    v_mfma_f32_16x16x32_bf16 v[124:127], v[184:187], a[172:175], v[124:127]
L_pad0_5:
    s_cbranch_execz L_ret1
    ds_read_b128 a[136:139], v241 offset:576
    v_mfma_f32_16x16x32_bf16 v[124:127], v[188:191], a[204:207], v[124:127]
    ds_read_b128 a[140:143], v241 offset:512
    v_smfmac_f32_16x16x64_bf16 a[220:223], a[228:231], v[184:191], v247
    buffer_store_dwordx4 v[72:75], v244, s[16:19], s32 offen offset:2048
    v_mfma_f32_16x16x32_bf16 v[160:163], a[80:83], v[200:203], -4.0
    v_mfma_f32_16x16x32_bf16 v[160:163], a[84:87], v[204:207], v[160:163]
    v_mfma_f32_16x16x32_bf16 v[160:163], a[88:91], v[208:211], v[160:163]
    v_accvgpr_read_b32 v248, a220
    v_accvgpr_read_b32 v249, a221
    v_add_f32 v248, v248, v249
    v_subrev_u32 v249, s42, v248
    v_rcp_f32 v248, v248
    v_cmp_le_u32 vcc, s43, v249
    v_mov_b32 v251, v248
    v_mov_b32_dpp v251, v248 row_ror:12 row_mask:0x2 bank_mask:0xf
    v_mov_b32_dpp v251, v248 row_ror:8 row_mask:0x4 bank_mask:0xf
    v_mov_b32_dpp v251, v248 row_ror:4 row_mask:0x8 bank_mask:0xf
    v_accvgpr_write_b32 a220, 0
    v_accvgpr_write_b32 a221, 0
    v_mov_b32_dpp v248, v251 row_newbcast:0 row_mask:0xf bank_mask:0xf
    v_mov_b32_dpp v249, v251 row_newbcast:1 row_mask:0xf bank_mask:0xf
    v_mov_b32_dpp v250, v251 row_newbcast:2 row_mask:0xf bank_mask:0xf
    v_mov_b32_dpp v251, v251 row_newbcast:3 row_mask:0xf bank_mask:0xf
    v_pk_mul_f32 v[96:97], v[96:97], v[248:249]
    v_pk_mul_f32 v[98:99], v[98:99], v[250:251]
    v_pk_mul_f32 v[100:101], v[100:101], v[248:249]
    v_pk_mul_f32 v[102:103], v[102:103], v[250:251]
    v_pk_mul_f32 v[104:105], v[104:105], v[248:249]
    v_pk_mul_f32 v[106:107], v[106:107], v[250:251]
    v_pk_mul_f32 v[108:109], v[108:109], v[248:249]
    v_pk_mul_f32 v[110:111], v[110:111], v[250:251]
    v_pk_mul_f32 v[112:113], v[112:113], v[248:249]
    v_pk_mul_f32 v[114:115], v[114:115], v[250:251]
    v_pk_mul_f32 v[116:117], v[116:117], v[248:249]
    v_pk_mul_f32 v[118:119], v[118:119], v[250:251]
    v_pk_mul_f32 v[120:121], v[120:121], v[248:249]
    v_pk_mul_f32 v[122:123], v[122:123], v[250:251]
    v_pk_mul_f32 v[124:125], v[124:125], v[248:249]
    v_pk_mul_f32 v[126:127], v[126:127], v[250:251]
    v_cvt_pk_bf16_f32 v96, v96, v100
    v_cvt_pk_bf16_f32 v100, v97, v101
    v_cvt_pk_bf16_f32 v97, v104, v108
    v_cvt_pk_bf16_f32 v101, v105, v109
    v_mfma_f32_16x16x32_bf16 v[160:163], a[92:95], v[212:215], v[160:163]
    s_or_b64 s[44:45], s[44:45], vcc
    buffer_store_dwordx4 v[76:79], v244, s[16:19], s32 offen offset:3072
    v_mfma_f32_16x16x32_bf16 v[164:167], a[96:99], v[212:215], -4.0
    ds_write_b64 v246, v[96:97] offset:5440
    v_cvt_pk_bf16_f32 v98, v98, v102
    v_cvt_pk_bf16_f32 v102, v99, v103
    v_mfma_f32_16x16x32_bf16 v[164:167], a[100:103], v[208:211], v[164:167]
    ds_write_b64 v246, v[100:101] offset:6528
    v_cvt_pk_bf16_f32 v99, v106, v110
    v_cvt_pk_bf16_f32 v103, v107, v111
    v_mfma_f32_16x16x32_bf16 v[164:167], a[104:107], v[204:207], v[164:167]
    ds_write_b64 v246, v[98:99] offset:7616
    v_exp_f32 v160, v160
    v_cvt_pk_bf16_f32 v112, v112, v116
    v_cvt_pk_bf16_f32 v116, v113, v117
    v_mfma_f32_16x16x32_bf16 v[164:167], a[108:111], v[200:203], v[164:167]
    ds_write_b64 v246, v[102:103] offset:8704
    v_exp_f32 v161, v161
    v_cvt_pk_bf16_f32 v113, v120, v124
    v_cvt_pk_bf16_f32 v117, v121, v125
    v_mfma_f32_16x16x32_bf16 v[168:171], a[112:115], v[200:203], -4.0
    ds_write_b64 v246, v[112:113] offset:5568
    v_exp_f32 v162, v162
    v_cvt_pk_bf16_f32 v114, v114, v118
    v_cvt_pk_bf16_f32 v118, v115, v119
    v_mfma_f32_16x16x32_bf16 v[168:171], a[116:119], v[204:207], v[168:171]
    s_waitcnt lgkmcnt(5)
    ds_write_b64 v246, v[116:117] offset:6656
    v_exp_f32 v163, v163
    v_cvt_pk_bf16_f32 v115, v122, v126
    v_cvt_pk_bf16_f32 v119, v123, v127
    v_mfma_f32_16x16x32_bf16 v[168:171], a[120:123], v[208:211], v[168:171]
    ds_write_b64 v246, v[114:115] offset:7744
    v_cvt_pk_bf16_f32 v176, v160, v161
    v_cvt_pk_bf16_f32 v177, v162, v163
    v_mfma_f32_16x16x32_bf16 v[168:171], a[124:127], v[212:215], v[168:171]
    ds_write_b64 v246, v[118:119] offset:8832
    v_exp_f32 v164, v164
    v_mfma_f32_16x16x32_bf16 v[172:175], a[128:131], v[212:215], -4.0
    v_exp_f32 v165, v165
    v_mfma_f32_16x16x32_bf16 v[172:175], a[132:135], v[208:211], v[172:175]
    ds_read_b64_tr_b16 v[96:97], v252 offset:5440
    ds_read_b64_tr_b16 v[98:99], v252 offset:5472
    v_exp_f32 v166, v166
    v_mfma_f32_16x16x32_bf16 v[172:175], a[136:139], v[204:207], v[172:175]
    ds_read_b64_tr_b16 v[100:101], v252 offset:6528
    ds_read_b64_tr_b16 v[102:103], v252 offset:6560
    v_exp_f32 v167, v167
    v_mfma_f32_16x16x32_bf16 v[172:175], a[140:143], v[200:203], v[172:175]
    ds_read_b64_tr_b16 v[104:105], v252 offset:7616
    ds_read_b64_tr_b16 v[106:107], v252 offset:7648
    v_cvt_pk_bf16_f32 v178, v164, v165
    v_cvt_pk_bf16_f32 v179, v166, v167
    v_mfma_f32_16x16x32_bf16 v[128:131], v[192:195], a[144:147], v[128:131]
    ds_read_b64_tr_b16 a[144:145], v242 offset:0
    ds_read_b64_tr_b16 a[146:147], v242 offset:512
    ds_read_b64_tr_b16 v[108:109], v252 offset:8704
    ds_read_b64_tr_b16 v[110:111], v252 offset:8736
    v_mfma_f32_16x16x32_bf16 v[128:131], v[196:199], a[176:179], v[128:131]
    v_exp_f32 v168, v168
    v_mfma_f32_16x16x32_bf16 v[132:135], v[192:195], a[148:151], v[132:135]
    ds_read_b64_tr_b16 a[176:177], v243 offset:0
    ds_read_b64_tr_b16 a[178:179], v243 offset:512
    v_mfma_f32_16x16x32_bf16 v[132:135], v[196:199], a[180:183], v[132:135]
    v_exp_f32 v169, v169
    v_mfma_f32_16x16x32_bf16 v[136:139], v[192:195], a[152:155], v[136:139]
    ds_read_b64_tr_b16 a[148:149], v242 offset:16
    ds_read_b64_tr_b16 a[150:151], v242 offset:528
    v_mfma_f32_16x16x32_bf16 v[136:139], v[196:199], a[184:187], v[136:139]
    v_exp_f32 v170, v170
    v_mfma_f32_16x16x32_bf16 v[140:143], v[192:195], a[156:159], v[140:143]
    s_waitcnt lgkmcnt(12)
    ds_read_b64_tr_b16 a[180:181], v243 offset:16
    ds_read_b64_tr_b16 a[182:183], v243 offset:528
    buffer_store_dwordx4 v[96:99], v244, s[16:19], s33 offen offset:0
    v_mfma_f32_16x16x32_bf16 v[140:143], v[196:199], a[188:191], v[140:143]
    v_exp_f32 v171, v171
    v_mfma_f32_16x16x32_bf16 v[144:147], v[192:195], a[160:163], v[144:147]
    ds_read_b64_tr_b16 a[152:153], v242 offset:32
    ds_read_b64_tr_b16 a[154:155], v242 offset:544
    v_mfma_f32_16x16x32_bf16 v[144:147], v[196:199], a[192:195], v[144:147]
    v_exp_f32 v172, v172
    v_mfma_f32_16x16x32_bf16 v[148:151], v[192:195], a[164:167], v[148:151]
    s_waitcnt lgkmcnt(8)
    ds_read_b64_tr_b16 a[184:185], v243 offset:32
    ds_read_b64_tr_b16 a[186:187], v243 offset:544
    buffer_store_dwordx4 v[100:103], v244, s[16:19], s33 offen offset:1024
    v_mfma_f32_16x16x32_bf16 v[148:151], v[196:199], a[196:199], v[148:151]
    v_exp_f32 v173, v173
    v_mfma_f32_16x16x32_bf16 v[152:155], v[192:195], a[168:171], v[152:155]
    ds_read_b64_tr_b16 a[156:157], v242 offset:48
    ds_read_b64_tr_b16 a[158:159], v242 offset:560
    v_mfma_f32_16x16x32_bf16 v[152:155], v[196:199], a[200:203], v[152:155]
    v_exp_f32 v174, v174
    v_mfma_f32_16x16x32_bf16 v[156:159], v[192:195], a[172:175], v[156:159]
    ds_read_b64_tr_b16 a[188:189], v243 offset:48
    ds_read_b64_tr_b16 a[190:191], v243 offset:560
    v_mfma_f32_16x16x32_bf16 v[156:159], v[196:199], a[204:207], v[156:159]
    v_exp_f32 v175, v175
    v_smfmac_f32_16x16x64_bf16 a[224:227], a[228:231], v[192:199], v247
    buffer_store_dwordx4 v[104:107], v244, s[16:19], s33 offen offset:2048
    v_mfma_f32_16x16x32_bf16 v[160:163], a[80:83], v[216:219], -4.0
    ds_read_b64_tr_b16 a[160:161], v242 offset:128
    ds_read_b64_tr_b16 a[162:163], v242 offset:640
    v_mfma_f32_16x16x32_bf16 v[160:163], a[84:87], v[220:223], v[160:163]
    v_cvt_pk_bf16_f32 v180, v168, v169
    v_cvt_pk_bf16_f32 v181, v170, v171
    v_mfma_f32_16x16x32_bf16 v[160:163], a[88:91], v[224:227], v[160:163]
    ds_read_b64_tr_b16 a[192:193], v243 offset:128
    ds_read_b64_tr_b16 a[194:195], v243 offset:640
    v_accvgpr_read_b32 v248, a224
    v_accvgpr_read_b32 v249, a225
    v_add_f32 v248, v248, v249
    v_subrev_u32 v249, s42, v248
    v_rcp_f32 v248, v248
    v_cmp_le_u32 vcc, s43, v249
    v_mov_b32 v251, v248
    v_mov_b32_dpp v251, v248 row_ror:12 row_mask:0x2 bank_mask:0xf
    v_mov_b32_dpp v251, v248 row_ror:8 row_mask:0x4 bank_mask:0xf
    v_mov_b32_dpp v251, v248 row_ror:4 row_mask:0x8 bank_mask:0xf
    v_accvgpr_write_b32 a224, 0
    v_accvgpr_write_b32 a225, 0
    v_mov_b32_dpp v248, v251 row_newbcast:0 row_mask:0xf bank_mask:0xf
    v_mov_b32_dpp v249, v251 row_newbcast:1 row_mask:0xf bank_mask:0xf
    v_mov_b32_dpp v250, v251 row_newbcast:2 row_mask:0xf bank_mask:0xf
    v_mov_b32_dpp v251, v251 row_newbcast:3 row_mask:0xf bank_mask:0xf
    v_pk_mul_f32 v[128:129], v[128:129], v[248:249]
    v_pk_mul_f32 v[130:131], v[130:131], v[250:251]
    v_pk_mul_f32 v[132:133], v[132:133], v[248:249]
    v_pk_mul_f32 v[134:135], v[134:135], v[250:251]
    v_pk_mul_f32 v[136:137], v[136:137], v[248:249]
    v_pk_mul_f32 v[138:139], v[138:139], v[250:251]
    v_pk_mul_f32 v[140:141], v[140:141], v[248:249]
    v_pk_mul_f32 v[142:143], v[142:143], v[250:251]
    v_pk_mul_f32 v[144:145], v[144:145], v[248:249]
    v_pk_mul_f32 v[146:147], v[146:147], v[250:251]
    v_pk_mul_f32 v[148:149], v[148:149], v[248:249]
    v_pk_mul_f32 v[150:151], v[150:151], v[250:251]
    v_pk_mul_f32 v[152:153], v[152:153], v[248:249]
    v_pk_mul_f32 v[154:155], v[154:155], v[250:251]
    v_pk_mul_f32 v[156:157], v[156:157], v[248:249]
    v_pk_mul_f32 v[158:159], v[158:159], v[250:251]
    v_cvt_pk_bf16_f32 v128, v128, v132
    v_cvt_pk_bf16_f32 v132, v129, v133
    v_cvt_pk_bf16_f32 v129, v136, v140
    v_cvt_pk_bf16_f32 v133, v137, v141
    v_mfma_f32_16x16x32_bf16 v[160:163], a[92:95], v[228:231], v[160:163]
    s_or_b64 s[44:45], s[44:45], vcc
    buffer_store_dwordx4 v[108:111], v244, s[16:19], s33 offen offset:3072
    v_cvt_pk_bf16_f32 v182, v172, v173
    v_cvt_pk_bf16_f32 v183, v174, v175
    v_mfma_f32_16x16x32_bf16 v[164:167], a[96:99], v[228:231], -4.0
    ds_read_b64_tr_b16 a[164:165], v242 offset:144
    ds_read_b64_tr_b16 a[166:167], v242 offset:656
    ds_write_b64 v246, v[128:129] offset:5440
    v_cvt_pk_bf16_f32 v130, v130, v134
    v_cvt_pk_bf16_f32 v134, v131, v135
    v_mfma_f32_16x16x32_bf16 v[164:167], a[100:103], v[224:227], v[164:167]
    ds_write_b64 v246, v[132:133] offset:6528
    v_cvt_pk_bf16_f32 v131, v138, v142
    v_cvt_pk_bf16_f32 v135, v139, v143
    v_mfma_f32_16x16x32_bf16 v[164:167], a[104:107], v[220:223], v[164:167]
    ds_read_b64_tr_b16 a[196:197], v243 offset:144
    ds_read_b64_tr_b16 a[198:199], v243 offset:656
    ds_write_b64 v246, v[130:131] offset:7616
    v_cvt_pk_bf16_f32 v144, v144, v148
    v_cvt_pk_bf16_f32 v148, v145, v149
    v_mfma_f32_16x16x32_bf16 v[164:167], a[108:111], v[216:219], v[164:167]
    ds_write_b64 v246, v[134:135] offset:8704
    v_exp_f32 v160, v160
    v_cvt_pk_bf16_f32 v145, v152, v156
    v_cvt_pk_bf16_f32 v149, v153, v157
    v_mfma_f32_16x16x32_bf16 v[168:171], a[112:115], v[216:219], -4.0
    ds_read_b64_tr_b16 a[168:169], v242 offset:160
    ds_read_b64_tr_b16 a[170:171], v242 offset:672
    ds_write_b64 v246, v[144:145] offset:5568
    v_cvt_pk_bf16_f32 v146, v146, v150
    v_cvt_pk_bf16_f32 v150, v147, v151
    v_mfma_f32_16x16x32_bf16 v[168:171], a[116:119], v[220:223], v[168:171]
    ds_write_b64 v246, v[148:149] offset:6656
    v_exp_f32 v161, v161
    v_cvt_pk_bf16_f32 v147, v154, v158
    v_cvt_pk_bf16_f32 v151, v155, v159
    v_mfma_f32_16x16x32_bf16 v[168:171], a[120:123], v[224:227], v[168:171]
    ds_read_b64_tr_b16 a[200:201], v243 offset:160
    ds_read_b64_tr_b16 a[202:203], v243 offset:672
    ds_write_b64 v246, v[146:147] offset:7744
    v_mfma_f32_16x16x32_bf16 v[168:171], a[124:127], v[228:231], v[168:171]
    ds_write_b64 v246, v[150:151] offset:8832
    v_exp_f32 v162, v162
    v_mfma_f32_16x16x32_bf16 v[172:175], a[128:131], v[228:231], -4.0
    ds_read_b64_tr_b16 a[172:173], v242 offset:176
    ds_read_b64_tr_b16 a[174:175], v242 offset:688
    v_mfma_f32_16x16x32_bf16 v[172:175], a[132:135], v[224:227], v[172:175]
    ds_read_b64_tr_b16 v[128:129], v252 offset:5440
    ds_read_b64_tr_b16 v[130:131], v252 offset:5472
    v_exp_f32 v163, v163
    v_mfma_f32_16x16x32_bf16 v[172:175], a[136:139], v[220:223], v[172:175]
    ds_read_b64_tr_b16 a[204:205], v243 offset:176
    ds_read_b64_tr_b16 a[206:207], v243 offset:688
    ds_read_b64_tr_b16 v[132:133], v252 offset:6528
    ds_read_b64_tr_b16 v[134:135], v252 offset:6560
    v_mfma_f32_16x16x32_bf16 v[172:175], a[140:143], v[216:219], v[172:175]
    ds_read_b64_tr_b16 v[136:137], v252 offset:7616
    ds_read_b64_tr_b16 v[138:139], v252 offset:7648
    v_cvt_pk_bf16_f32 v184, v160, v161
    v_cvt_pk_bf16_f32 v185, v162, v163
    v_mfma_f32_16x16x32_bf16 v[0:3], v[176:179], a[144:147], 0
    s_waitcnt lgkmcnt(15)
    ds_read_b64_tr_b16 v[140:141], v252 offset:8704
    ds_read_b64_tr_b16 v[142:143], v252 offset:8736
    v_exp_f32 v164, v164
    v_mfma_f32_16x16x32_bf16 v[0:3], v[180:183], a[176:179], v[0:3]
    v_exp_f32 v165, v165
    v_mfma_f32_16x16x32_bf16 v[4:7], v[176:179], a[148:151], 0
    v_exp_f32 v166, v166
    v_mfma_f32_16x16x32_bf16 v[4:7], v[180:183], a[180:183], v[4:7]
    v_exp_f32 v167, v167
    v_mfma_f32_16x16x32_bf16 v[8:11], v[176:179], a[152:155], 0
    v_cvt_pk_bf16_f32 v186, v164, v165
    v_cvt_pk_bf16_f32 v187, v166, v167
    v_mfma_f32_16x16x32_bf16 v[8:11], v[180:183], a[184:187], v[8:11]
    v_exp_f32 v168, v168
    v_mfma_f32_16x16x32_bf16 v[12:15], v[176:179], a[156:159], 0
    s_waitcnt lgkmcnt(8)
    buffer_store_dwordx4 v[128:131], v244, s[16:19], s34 offen offset:0
    v_exp_f32 v172, v172
    v_mfma_f32_16x16x32_bf16 v[12:15], v[180:183], a[188:191], v[12:15]
    v_exp_f32 v169, v169
    v_mfma_f32_16x16x32_bf16 v[16:19], v[176:179], a[160:163], 0
    v_exp_f32 v173, v173
    v_mfma_f32_16x16x32_bf16 v[16:19], v[180:183], a[192:195], v[16:19]
    v_exp_f32 v170, v170
    v_mfma_f32_16x16x32_bf16 v[20:23], v[176:179], a[164:167], 0
    s_waitcnt lgkmcnt(0)
    buffer_store_dwordx4 v[132:135], v244, s[16:19], s34 offen offset:1024
    v_exp_f32 v174, v174
    v_mfma_f32_16x16x32_bf16 v[20:23], v[180:183], a[196:199], v[20:23]
    v_exp_f32 v171, v171
    v_mfma_f32_16x16x32_bf16 v[24:27], v[176:179], a[168:171], 0
    v_exp_f32 v175, v175
    v_mfma_f32_16x16x32_bf16 v[24:27], v[180:183], a[200:203], v[24:27]
    v_cvt_pk_bf16_f32 v188, v168, v169
    v_cvt_pk_bf16_f32 v189, v170, v171
    v_mfma_f32_16x16x32_bf16 v[28:31], v[176:179], a[172:175], 0
    buffer_store_dwordx4 v[136:139], v244, s[16:19], s34 offen offset:2048
    v_cvt_pk_bf16_f32 v190, v172, v173
    v_cvt_pk_bf16_f32 v191, v174, v175
    v_mfma_f32_16x16x32_bf16 v[28:31], v[180:183], a[204:207], v[28:31]
    s_waitcnt vmcnt(28)
    v_smfmac_f32_16x16x64_bf16 a[208:211], a[228:231], v[176:183], v247
    s_barrier
    v_mfma_f32_16x16x32_bf16 v[160:163], a[80:83], a[32:35], -4.0
    s_add_u32 m0, s26, 0
    s_waitcnt vmcnt(27)
    ds_read_b128 v[232:235], v245 offset:1088
    v_add_u32 v240, s27, v240
    v_mfma_f32_16x16x32_bf16 v[160:163], a[84:87], a[36:39], v[160:163]
    global_load_lds_dwordx4 v244, s[52:53] offset:0
    v_mfma_f32_16x16x32_bf16 v[160:163], a[88:91], a[40:43], v[160:163]
    s_add_u32 m0, s26, 32
    ds_read_b128 v[236:239], v245 offset:1152
    v_add_u32 v241, s27, v241
    v_mfma_f32_16x16x32_bf16 v[160:163], a[92:95], a[44:47], v[160:163]
    global_load_lds_dwordx4 v244, s[52:53] offset:1024
    v_mfma_f32_16x16x32_bf16 v[164:167], a[96:99], a[44:47], -4.0
    s_add_u32 m0, s26, 64
    v_add_u32 v242, s27, v242
    v_mfma_f32_16x16x32_bf16 v[164:167], a[100:103], a[40:43], v[164:167]
    global_load_lds_dwordx4 v244, s[52:53] offset:2048
    v_mfma_f32_16x16x32_bf16 v[164:167], a[104:107], a[36:39], v[164:167]
    v_exp_f32 v160, v160
    v_mfma_f32_16x16x32_bf16 v[164:167], a[108:111], a[32:35], v[164:167]
    s_add_u32 m0, s26, 96
    v_exp_f32 v161, v161
    v_mfma_f32_16x16x32_bf16 v[32:35], v[184:187], a[144:147], 0
    global_load_lds_dwordx4 v244, s[52:53] offset:3072
    v_exp_f32 v162, v162
    v_mfma_f32_16x16x32_bf16 v[32:35], v[188:191], a[176:179], v[32:35]
    v_exp_f32 v163, v163
    v_mfma_f32_16x16x32_bf16 v[36:39], v[184:187], a[148:151], 0
    s_add_u32 m0, s26, 16896
    v_cvt_pk_bf16_f32 v176, v160, v161
    v_cvt_pk_bf16_f32 v177, v162, v163
    v_mfma_f32_16x16x32_bf16 v[36:39], v[188:191], a[180:183], v[36:39]
    global_load_lds_dwordx4 v244, s[54:55] offset:0
    v_exp_f32 v164, v164
    v_mfma_f32_16x16x32_bf16 v[40:43], v[184:187], a[152:155], 0
    v_exp_f32 v165, v165
    v_mfma_f32_16x16x32_bf16 v[40:43], v[188:191], a[184:187], v[40:43]
    s_add_u32 m0, s26, 16912
    v_exp_f32 v166, v166
    v_mfma_f32_16x16x32_bf16 v[44:47], v[184:187], a[156:159], 0
    global_load_lds_dwordx4 v244, s[54:55] offset:1024
    v_exp_f32 v167, v167
    v_mfma_f32_16x16x32_bf16 v[44:47], v[188:191], a[188:191], v[44:47]
    v_cvt_pk_bf16_f32 v178, v164, v165
    v_cvt_pk_bf16_f32 v179, v166, v167
    v_mfma_f32_16x16x32_bf16 v[48:51], v[184:187], a[160:163], 0
    s_add_u32 m0, s26, 16928
    v_add_u32 v243, s27, v243
    v_mfma_f32_16x16x32_bf16 v[48:51], v[188:191], a[192:195], v[48:51]
    global_load_lds_dwordx4 v244, s[54:55] offset:2048
    v_mfma_f32_16x16x32_bf16 v[52:55], v[184:187], a[164:167], 0
    s_waitcnt lgkmcnt(0)
    v_lshlrev_b32 v248, 16, v232
    v_and_b32 v249, 0xffff0000, v232
    v_lshlrev_b32 v250, 16, v233
    v_and_b32 v251, 0xffff0000, v233
    v_pk_mul_f32 v[248:249], v[248:249], s[40:41]
    v_pk_mul_f32 v[250:251], v[250:251], s[40:41]
    v_cvt_pk_bf16_f32 v232, v248, v249
    v_cvt_pk_bf16_f32 v233, v250, v251
    v_accvgpr_write_b32 a64, v232
    v_accvgpr_write_b32 a65, v233
    v_lshlrev_b32 v248, 16, v234
    v_and_b32 v249, 0xffff0000, v234
    v_lshlrev_b32 v250, 16, v235
    v_and_b32 v251, 0xffff0000, v235
    v_pk_mul_f32 v[248:249], v[248:249], s[40:41]
    v_pk_mul_f32 v[250:251], v[250:251], s[40:41]
    v_cvt_pk_bf16_f32 v234, v248, v249
    v_cvt_pk_bf16_f32 v235, v250, v251
    v_accvgpr_write_b32 a66, v234
    v_accvgpr_write_b32 a67, v235
    v_mfma_f32_16x16x32_bf16 v[52:55], v[188:191], a[196:199], v[52:55]
    s_add_u32 m0, s26, 16944
    ds_read_b128 v[232:235], v245 offset:1216
    v_mfma_f32_16x16x32_bf16 v[56:59], v[184:187], a[168:171], 0
    global_load_lds_dwordx4 v244, s[54:55] offset:3072
    v_mfma_f32_16x16x32_bf16 v[56:59], v[188:191], a[200:203], v[56:59]
    s_add_u32 s24, s24, 16384
    v_lshlrev_b32 v248, 16, v236
    v_and_b32 v249, 0xffff0000, v236
    v_lshlrev_b32 v250, 16, v237
    v_and_b32 v251, 0xffff0000, v237
    v_pk_mul_f32 v[248:249], v[248:249], s[40:41]
    v_pk_mul_f32 v[250:251], v[250:251], s[40:41]
    v_cvt_pk_bf16_f32 v236, v248, v249
    v_cvt_pk_bf16_f32 v237, v250, v251
    v_accvgpr_write_b32 a68, v236
    v_accvgpr_write_b32 a69, v237
    v_lshlrev_b32 v248, 16, v238
    v_and_b32 v249, 0xffff0000, v238
    v_lshlrev_b32 v250, 16, v239
    v_and_b32 v251, 0xffff0000, v239
    v_pk_mul_f32 v[248:249], v[248:249], s[40:41]
    v_pk_mul_f32 v[250:251], v[250:251], s[40:41]
    v_cvt_pk_bf16_f32 v238, v248, v249
    v_cvt_pk_bf16_f32 v239, v250, v251
    v_accvgpr_write_b32 a70, v238
    v_accvgpr_write_b32 a71, v239
    v_mfma_f32_16x16x32_bf16 v[60:63], v[184:187], a[172:175], 0
    s_and_b32 s24, s24, 0x3ffff
    ds_read_b128 v[236:239], v245 offset:1280
    v_mfma_f32_16x16x32_bf16 v[60:63], v[188:191], a[204:207], v[60:63]
    s_add_u32 s65, s25, s24
    v_smfmac_f32_16x16x64_bf16 a[212:215], a[228:231], v[184:191], v247
    s_add_u32 s52, s8, s65
    s_addc_u32 s53, s9, 0
    v_mfma_f32_16x16x32_bf16 v[160:163], a[80:83], a[48:51], -4.0
    s_waitcnt lgkmcnt(1)
    v_lshlrev_b32 v248, 16, v232
    v_and_b32 v249, 0xffff0000, v232
    v_lshlrev_b32 v250, 16, v233
    v_and_b32 v251, 0xffff0000, v233
    v_pk_mul_f32 v[248:249], v[248:249], s[40:41]
    v_pk_mul_f32 v[250:251], v[250:251], s[40:41]
    v_cvt_pk_bf16_f32 v232, v248, v249
    v_cvt_pk_bf16_f32 v233, v250, v251
    v_accvgpr_write_b32 a72, v232
    v_accvgpr_write_b32 a73, v233
    v_lshlrev_b32 v248, 16, v234
    v_and_b32 v249, 0xffff0000, v234
    v_lshlrev_b32 v250, 16, v235
    v_and_b32 v251, 0xffff0000, v235
    v_pk_mul_f32 v[248:249], v[248:249], s[40:41]
    v_pk_mul_f32 v[250:251], v[250:251], s[40:41]
    v_cvt_pk_bf16_f32 v234, v248, v249
    v_cvt_pk_bf16_f32 v235, v250, v251
    v_accvgpr_write_b32 a74, v234
    v_accvgpr_write_b32 a75, v235
    v_mfma_f32_16x16x32_bf16 v[160:163], a[84:87], a[52:55], v[160:163]
    s_waitcnt lgkmcnt(0)
    v_lshlrev_b32 v248, 16, v236
    v_and_b32 v249, 0xffff0000, v236
    v_lshlrev_b32 v250, 16, v237
    v_and_b32 v251, 0xffff0000, v237
    v_pk_mul_f32 v[248:249], v[248:249], s[40:41]
    v_pk_mul_f32 v[250:251], v[250:251], s[40:41]
    v_cvt_pk_bf16_f32 v236, v248, v249
    v_cvt_pk_bf16_f32 v237, v250, v251
    v_accvgpr_write_b32 a76, v236
    v_accvgpr_write_b32 a77, v237
    v_lshlrev_b32 v248, 16, v238
    v_and_b32 v249, 0xffff0000, v238
    v_lshlrev_b32 v250, 16, v239
    v_and_b32 v251, 0xffff0000, v239
    v_pk_mul_f32 v[248:249], v[248:249], s[40:41]
    v_pk_mul_f32 v[250:251], v[250:251], s[40:41]
    v_cvt_pk_bf16_f32 v238, v248, v249
    v_cvt_pk_bf16_f32 v239, v250, v251
    v_accvgpr_write_b32 a78, v238
    v_accvgpr_write_b32 a79, v239
    v_mfma_f32_16x16x32_bf16 v[160:163], a[88:91], a[56:59], v[160:163]
    s_add_u32 s54, s12, s65
    s_addc_u32 s55, s13, 0
    v_mfma_f32_16x16x32_bf16 v[160:163], a[92:95], a[60:63], v[160:163]
    s_add_u32 s26, s26, s27
    v_mfma_f32_16x16x32_bf16 v[164:167], a[96:99], a[60:63], -4.0
    s_cmp_eq_u32 s26, s48
    s_cselect_b32 s27, s58, s59
    v_mfma_f32_16x16x32_bf16 v[164:167], a[100:103], a[56:59], v[164:167]
    s_mov_b32 s23, 15
    v_mfma_f32_16x16x32_bf16 v[164:167], a[104:107], a[52:55], v[164:167]
    s_mov_b32 s22, 16384
    v_exp_f32 v160, v160
    v_mfma_f32_16x16x32_bf16 v[164:167], a[108:111], a[48:51], v[164:167]
    v_exp_f32 v161, v161
    v_mfma_f32_16x16x32_bf16 v[168:171], a[112:115], a[48:51], -4.0
    v_exp_f32 v162, v162
    v_mfma_f32_16x16x32_bf16 v[168:171], a[116:119], a[52:55], v[168:171]
    v_exp_f32 v163, v163
    v_mfma_f32_16x16x32_bf16 v[168:171], a[120:123], a[56:59], v[168:171]
    v_cvt_pk_bf16_f32 v184, v160, v161
    v_cvt_pk_bf16_f32 v185, v162, v163
    v_mfma_f32_16x16x32_bf16 v[168:171], a[124:127], a[60:63], v[168:171]
    buffer_store_dwordx4 v[140:143], v244, s[16:19], s34 offen offset:3072
    v_exp_f32 v164, v164
    v_mfma_f32_16x16x32_bf16 v[172:175], a[128:131], a[60:63], -4.0
    v_exp_f32 v165, v165
    v_mfma_f32_16x16x32_bf16 v[172:175], a[132:135], a[56:59], v[172:175]
    v_exp_f32 v166, v166
    v_mfma_f32_16x16x32_bf16 v[172:175], a[136:139], a[52:55], v[172:175]
    v_exp_f32 v167, v167
    v_mfma_f32_16x16x32_bf16 v[172:175], a[140:143], a[48:51], v[172:175]
    v_cvt_pk_bf16_f32 v186, v164, v165
    v_cvt_pk_bf16_f32 v187, v166, v167
    v_mfma_f32_16x16x32_bf16 v[64:67], v[176:179], a[144:147], 0
    v_exp_f32 v168, v168
    v_mfma_f32_16x16x32_bf16 v[68:71], v[176:179], a[148:151], 0
    v_exp_f32 v169, v169
    v_mfma_f32_16x16x32_bf16 v[72:75], v[176:179], a[152:155], 0
    v_exp_f32 v170, v170
    v_mfma_f32_16x16x32_bf16 v[76:79], v[176:179], a[156:159], 0
    v_exp_f32 v171, v171
    v_mfma_f32_16x16x32_bf16 v[80:83], v[176:179], a[160:163], 0
    v_cvt_pk_bf16_f32 v188, v168, v169
    v_cvt_pk_bf16_f32 v189, v170, v171
    v_mfma_f32_16x16x32_bf16 v[84:87], v[176:179], a[164:167], 0
    v_exp_f32 v172, v172
    v_mfma_f32_16x16x32_bf16 v[88:91], v[176:179], a[168:171], 0
    v_exp_f32 v173, v173
    v_mfma_f32_16x16x32_bf16 v[92:95], v[176:179], a[172:175], 0
    v_cvt_pk_bf16_f32 v190, v172, v173
    v_mfma_f32_16x16x32_bf16 a[216:219], a[232:235], v[176:179], a[216:219]
    v_mfma_f32_16x16x32_bf16 v[160:163], a[80:83], a[64:67], -4.0
    v_exp_f32_e64 v174, v174
    v_mfma_f32_16x16x32_bf16 v[160:163], a[84:87], a[68:71], v[160:163]
    v_exp_f32_e64 v175, v175
    v_mfma_f32_16x16x32_bf16 v[160:163], a[88:91], a[72:75], v[160:163]
    ds_read_b128 a[80:83], v240 offset:0
    v_cvt_pk_bf16_f32 v191, v174, v175
    v_mfma_f32_16x16x32_bf16 v[160:163], a[92:95], a[76:79], v[160:163]
    ds_read_b128 a[84:87], v240 offset:64
    v_mfma_f32_16x16x32_bf16 v[164:167], a[96:99], a[76:79], -4.0
    ds_read_b128 a[88:91], v240 offset:128
    v_mfma_f32_16x16x32_bf16 v[164:167], a[100:103], a[72:75], v[164:167]
    ds_read_b128 a[92:95], v240 offset:192
    v_mfma_f32_16x16x32_bf16 v[164:167], a[104:107], a[68:71], v[164:167]
    v_exp_f32_e64 v160, v160
    v_mfma_f32_16x16x32_bf16 v[164:167], a[108:111], a[64:67], v[164:167]
    v_exp_f32_e64 v161, v161
    v_mfma_f32_16x16x32_bf16 v[168:171], a[112:115], a[64:67], -4.0
    ds_read_b128 a[96:99], v240 offset:704
    v_cvt_pk_bf16_f32 v192, v160, v161
    v_mfma_f32_16x16x32_bf16 v[168:171], a[116:119], a[68:71], v[168:171]
    v_exp_f32_e64 v162, v162
    v_mfma_f32_16x16x32_bf16 v[168:171], a[120:123], a[72:75], v[168:171]
    v_exp_f32_e64 v163, v163
    v_mfma_f32_16x16x32_bf16 v[168:171], a[124:127], a[76:79], v[168:171]
    ds_read_b128 a[100:103], v240 offset:640
    v_cvt_pk_bf16_f32 v193, v162, v163
    v_mfma_f32_16x16x32_bf16 v[172:175], a[128:131], a[76:79], -4.0
    v_exp_f32_e64 v164, v164
    v_mfma_f32_16x16x32_bf16 v[172:175], a[132:135], a[72:75], v[172:175]
    v_exp_f32_e64 v165, v165
    v_mfma_f32_16x16x32_bf16 v[172:175], a[136:139], a[68:71], v[172:175]
    ds_read_b128 a[104:107], v240 offset:576
    v_cvt_pk_bf16_f32 v194, v164, v165
    v_mfma_f32_16x16x32_bf16 v[172:175], a[140:143], a[64:67], v[172:175]
    v_exp_f32_e64 v166, v166
    v_mfma_f32_16x16x32_bf16 v[96:99], v[184:187], a[144:147], 0
    v_exp_f32_e64 v167, v167
    v_mfma_f32_16x16x32_bf16 v[96:99], v[188:191], a[176:179], v[96:99]
    ds_read_b128 a[108:111], v240 offset:512
    v_cvt_pk_bf16_f32 v195, v166, v167
    v_mfma_f32_16x16x32_bf16 v[100:103], v[184:187], a[148:151], 0
    v_exp_f32 v168, v168
    v_mfma_f32_16x16x32_bf16 v[100:103], v[188:191], a[180:183], v[100:103]
    v_exp_f32 v169, v169
    v_mfma_f32_16x16x32_bf16 v[104:107], v[184:187], a[152:155], 0
    ds_read_b128 a[112:115], v241 offset:0
    v_cvt_pk_bf16_f32 v196, v168, v169
    v_mfma_f32_16x16x32_bf16 v[104:107], v[188:191], a[184:187], v[104:107]
    v_exp_f32 v170, v170
    v_mfma_f32_16x16x32_bf16 v[108:111], v[184:187], a[156:159], 0
    v_exp_f32 v171, v171
    v_mfma_f32_16x16x32_bf16 v[108:111], v[188:191], a[188:191], v[108:111]
    ds_read_b128 a[116:119], v241 offset:64
    v_cvt_pk_bf16_f32 v197, v170, v171
    v_mfma_f32_16x16x32_bf16 v[112:115], v[184:187], a[160:163], 0
    v_exp_f32 v172, v172
    v_mfma_f32_16x16x32_bf16 v[112:115], v[188:191], a[192:195], v[112:115]
    v_exp_f32 v173, v173
    v_mfma_f32_16x16x32_bf16 v[116:119], v[184:187], a[164:167], 0
    ds_read_b128 a[120:123], v241 offset:128
    v_cvt_pk_bf16_f32 v198, v172, v173
    v_mfma_f32_16x16x32_bf16 v[116:119], v[188:191], a[196:199], v[116:119]
    v_exp_f32 v174, v174
    v_mfma_f32_16x16x32_bf16 v[120:123], v[184:187], a[168:171], 0
    v_exp_f32 v175, v175
    v_mfma_f32_16x16x32_bf16 v[120:123], v[188:191], a[200:203], v[120:123]
L_pad0_6:
    s_cbranch_execz L_ret1
    ds_read_b128 a[124:127], v241 offset:192
    v_cvt_pk_bf16_f32 v199, v174, v175
    v_mfma_f32_16x16x32_bf16 v[124:127], v[184:187], a[172:175], 0
    ds_read_b128 a[128:131], v241 offset:704
    v_mfma_f32_16x16x32_bf16 v[124:127], v[188:191], a[204:207], v[124:127]
    ds_read_b128 a[132:135], v241 offset:640
    v_smfmac_f32_16x16x64_bf16 a[220:223], a[228:231], v[184:191], v247
    s_waitcnt lgkmcnt(4)
    ds_read_b128 a[136:139], v241 offset:576
    v_mfma_f32_16x16x32_bf16 v[160:163], a[80:83], v[200:203], -4.0
    ds_read_b128 a[140:143], v241 offset:512
    v_mfma_f32_16x16x32_bf16 v[160:163], a[84:87], v[204:207], v[160:163]
    v_mfma_f32_16x16x32_bf16 v[160:163], a[88:91], v[208:211], v[160:163]
    v_mfma_f32_16x16x32_bf16 v[160:163], a[92:95], v[212:215], v[160:163]
    v_mfma_f32_16x16x32_bf16 v[164:167], a[96:99], v[212:215], -4.0
    v_mfma_f32_16x16x32_bf16 v[164:167], a[100:103], v[208:211], v[164:167]
    v_mfma_f32_16x16x32_bf16 v[164:167], a[104:107], v[204:207], v[164:167]
    v_exp_f32 v160, v160
    v_mfma_f32_16x16x32_bf16 v[164:167], a[108:111], v[200:203], v[164:167]
    v_exp_f32 v161, v161
    v_mfma_f32_16x16x32_bf16 v[168:171], a[112:115], v[200:203], -4.0
    v_exp_f32 v162, v162
    v_mfma_f32_16x16x32_bf16 v[168:171], a[116:119], v[204:207], v[168:171]
    s_waitcnt lgkmcnt(0)
    v_exp_f32 v163, v163
    v_mfma_f32_16x16x32_bf16 v[168:171], a[120:123], v[208:211], v[168:171]
    v_cvt_pk_bf16_f32 v176, v160, v161
    v_cvt_pk_bf16_f32 v177, v162, v163
    v_mfma_f32_16x16x32_bf16 v[168:171], a[124:127], v[212:215], v[168:171]
    v_exp_f32 v164, v164
    v_mfma_f32_16x16x32_bf16 v[172:175], a[128:131], v[212:215], -4.0
    v_exp_f32 v165, v165
    v_mfma_f32_16x16x32_bf16 v[172:175], a[132:135], v[208:211], v[172:175]
    v_exp_f32 v166, v166
    v_mfma_f32_16x16x32_bf16 v[172:175], a[136:139], v[204:207], v[172:175]
    v_exp_f32 v167, v167
    v_mfma_f32_16x16x32_bf16 v[172:175], a[140:143], v[200:203], v[172:175]
    v_cvt_pk_bf16_f32 v178, v164, v165
    v_cvt_pk_bf16_f32 v179, v166, v167
    v_mfma_f32_16x16x32_bf16 v[128:131], v[192:195], a[144:147], 0
    ds_read_b64_tr_b16 a[144:145], v242 offset:0
    ds_read_b64_tr_b16 a[146:147], v242 offset:512
    v_mfma_f32_16x16x32_bf16 v[128:131], v[196:199], a[176:179], v[128:131]
    v_exp_f32 v168, v168
    v_mfma_f32_16x16x32_bf16 v[132:135], v[192:195], a[148:151], 0
    ds_read_b64_tr_b16 a[176:177], v243 offset:0
    ds_read_b64_tr_b16 a[178:179], v243 offset:512
    v_mfma_f32_16x16x32_bf16 v[132:135], v[196:199], a[180:183], v[132:135]
    v_exp_f32 v169, v169
    v_mfma_f32_16x16x32_bf16 v[136:139], v[192:195], a[152:155], 0
    ds_read_b64_tr_b16 a[148:149], v242 offset:16
    ds_read_b64_tr_b16 a[150:151], v242 offset:528
    v_mfma_f32_16x16x32_bf16 v[136:139], v[196:199], a[184:187], v[136:139]
    v_exp_f32 v170, v170
    v_mfma_f32_16x16x32_bf16 v[140:143], v[192:195], a[156:159], 0
    ds_read_b64_tr_b16 a[180:181], v243 offset:16
    ds_read_b64_tr_b16 a[182:183], v243 offset:528
    v_mfma_f32_16x16x32_bf16 v[140:143], v[196:199], a[188:191], v[140:143]
    v_exp_f32 v171, v171
    v_mfma_f32_16x16x32_bf16 v[144:147], v[192:195], a[160:163], 0
    ds_read_b64_tr_b16 a[152:153], v242 offset:32
    ds_read_b64_tr_b16 a[154:155], v242 offset:544
    v_mfma_f32_16x16x32_bf16 v[144:147], v[196:199], a[192:195], v[144:147]
    v_exp_f32 v172, v172
    v_mfma_f32_16x16x32_bf16 v[148:151], v[192:195], a[164:167], 0
    ds_read_b64_tr_b16 a[184:185], v243 offset:32
    ds_read_b64_tr_b16 a[186:187], v243 offset:544
    v_mfma_f32_16x16x32_bf16 v[148:151], v[196:199], a[196:199], v[148:151]
    v_exp_f32 v173, v173
    v_mfma_f32_16x16x32_bf16 v[152:155], v[192:195], a[168:171], 0
    ds_read_b64_tr_b16 a[156:157], v242 offset:48
    ds_read_b64_tr_b16 a[158:159], v242 offset:560
    v_mfma_f32_16x16x32_bf16 v[152:155], v[196:199], a[200:203], v[152:155]
    v_exp_f32 v174, v174
    v_mfma_f32_16x16x32_bf16 v[156:159], v[192:195], a[172:175], 0
    ds_read_b64_tr_b16 a[188:189], v243 offset:48
    ds_read_b64_tr_b16 a[190:191], v243 offset:560
    v_mfma_f32_16x16x32_bf16 v[156:159], v[196:199], a[204:207], v[156:159]
    v_exp_f32 v175, v175
    v_smfmac_f32_16x16x64_bf16 a[224:227], a[228:231], v[192:199], v247
L_loop1r0:
    v_mfma_f32_16x16x32_bf16 v[160:163], a[80:83], v[216:219], -4.0
    ds_read_b64_tr_b16 a[160:161], v242 offset:128
    ds_read_b64_tr_b16 a[162:163], v242 offset:640
    v_mfma_f32_16x16x32_bf16 v[160:163], a[84:87], v[220:223], v[160:163]
    v_cvt_pk_bf16_f32 v180, v168, v169
    v_cvt_pk_bf16_f32 v181, v170, v171
    v_mfma_f32_16x16x32_bf16 v[160:163], a[88:91], v[224:227], v[160:163]
    ds_read_b64_tr_b16 a[192:193], v243 offset:128
    ds_read_b64_tr_b16 a[194:195], v243 offset:640
    v_mfma_f32_16x16x32_bf16 v[160:163], a[92:95], v[228:231], v[160:163]
    v_cvt_pk_bf16_f32 v182, v172, v173
    v_cvt_pk_bf16_f32 v183, v174, v175
    v_mfma_f32_16x16x32_bf16 v[164:167], a[96:99], v[228:231], -4.0
    ds_read_b64_tr_b16 a[164:165], v242 offset:144
    ds_read_b64_tr_b16 a[166:167], v242 offset:656
    v_mfma_f32_16x16x32_bf16 v[164:167], a[100:103], v[224:227], v[164:167]
    v_mfma_f32_16x16x32_bf16 v[164:167], a[104:107], v[220:223], v[164:167]
    ds_read_b64_tr_b16 a[196:197], v243 offset:144
    ds_read_b64_tr_b16 a[198:199], v243 offset:656
    v_mfma_f32_16x16x32_bf16 v[164:167], a[108:111], v[216:219], v[164:167]
    v_exp_f32 v160, v160
    v_mfma_f32_16x16x32_bf16 v[168:171], a[112:115], v[216:219], -4.0
    ds_read_b64_tr_b16 a[168:169], v242 offset:160
    ds_read_b64_tr_b16 a[170:171], v242 offset:672
    v_mfma_f32_16x16x32_bf16 v[168:171], a[116:119], v[220:223], v[168:171]
    v_exp_f32 v161, v161
    v_mfma_f32_16x16x32_bf16 v[168:171], a[120:123], v[224:227], v[168:171]
    ds_read_b64_tr_b16 a[200:201], v243 offset:160
    ds_read_b64_tr_b16 a[202:203], v243 offset:672
    v_mfma_f32_16x16x32_bf16 v[168:171], a[124:127], v[228:231], v[168:171]
    v_exp_f32 v162, v162
    v_mfma_f32_16x16x32_bf16 v[172:175], a[128:131], v[228:231], -4.0
    ds_read_b64_tr_b16 a[172:173], v242 offset:176
    ds_read_b64_tr_b16 a[174:175], v242 offset:688
    v_mfma_f32_16x16x32_bf16 v[172:175], a[132:135], v[224:227], v[172:175]
    v_exp_f32 v163, v163
    v_mfma_f32_16x16x32_bf16 v[172:175], a[136:139], v[220:223], v[172:175]
    ds_read_b64_tr_b16 a[204:205], v243 offset:176
    ds_read_b64_tr_b16 a[206:207], v243 offset:688
    v_mfma_f32_16x16x32_bf16 v[172:175], a[140:143], v[216:219], v[172:175]
    s_waitcnt lgkmcnt(8)
    v_cvt_pk_bf16_f32 v184, v160, v161
    v_cvt_pk_bf16_f32 v185, v162, v163
    v_mfma_f32_16x16x32_bf16 v[0:3], v[176:179], a[144:147], v[0:3]
    v_exp_f32 v164, v164
    v_mfma_f32_16x16x32_bf16 v[0:3], v[180:183], a[176:179], v[0:3]
    v_exp_f32 v165, v165
    v_mfma_f32_16x16x32_bf16 v[4:7], v[176:179], a[148:151], v[4:7]
    v_exp_f32 v166, v166
    v_mfma_f32_16x16x32_bf16 v[4:7], v[180:183], a[180:183], v[4:7]
    v_exp_f32 v167, v167
    v_mfma_f32_16x16x32_bf16 v[8:11], v[176:179], a[152:155], v[8:11]
    v_cvt_pk_bf16_f32 v186, v164, v165
    v_cvt_pk_bf16_f32 v187, v166, v167
    v_mfma_f32_16x16x32_bf16 v[8:11], v[180:183], a[184:187], v[8:11]
    v_exp_f32 v168, v168
    v_mfma_f32_16x16x32_bf16 v[12:15], v[176:179], a[156:159], v[12:15]
    v_exp_f32 v172, v172
    v_mfma_f32_16x16x32_bf16 v[12:15], v[180:183], a[188:191], v[12:15]
    v_exp_f32 v169, v169
    v_mfma_f32_16x16x32_bf16 v[16:19], v[176:179], a[160:163], v[16:19]
    v_exp_f32 v173, v173
    v_mfma_f32_16x16x32_bf16 v[16:19], v[180:183], a[192:195], v[16:19]
    v_exp_f32 v170, v170
    v_mfma_f32_16x16x32_bf16 v[20:23], v[176:179], a[164:167], v[20:23]
    v_exp_f32 v174, v174
    v_mfma_f32_16x16x32_bf16 v[20:23], v[180:183], a[196:199], v[20:23]
    s_waitcnt lgkmcnt(0)
    v_exp_f32 v171, v171
    v_mfma_f32_16x16x32_bf16 v[24:27], v[176:179], a[168:171], v[24:27]
    v_exp_f32 v175, v175
    v_mfma_f32_16x16x32_bf16 v[24:27], v[180:183], a[200:203], v[24:27]
    v_cvt_pk_bf16_f32 v188, v168, v169
    v_cvt_pk_bf16_f32 v189, v170, v171
    v_mfma_f32_16x16x32_bf16 v[28:31], v[176:179], a[172:175], v[28:31]
    v_cvt_pk_bf16_f32 v190, v172, v173
    v_cvt_pk_bf16_f32 v191, v174, v175
    v_mfma_f32_16x16x32_bf16 v[28:31], v[180:183], a[204:207], v[28:31]
    s_waitcnt vmcnt(8)
    v_smfmac_f32_16x16x64_bf16 a[208:211], a[228:231], v[176:183], v247
    s_barrier
    v_mfma_f32_16x16x32_bf16 v[160:163], a[80:83], a[32:35], -4.0
    s_add_u32 m0, s26, 0
    v_add_u32 v240, s27, v240
    v_mfma_f32_16x16x32_bf16 v[160:163], a[84:87], a[36:39], v[160:163]
    global_load_lds_dwordx4 v244, s[52:53] offset:0
    v_mfma_f32_16x16x32_bf16 v[160:163], a[88:91], a[40:43], v[160:163]
    s_add_u32 m0, s26, 32
    v_add_u32 v241, s27, v241
    v_mfma_f32_16x16x32_bf16 v[160:163], a[92:95], a[44:47], v[160:163]
    global_load_lds_dwordx4 v244, s[52:53] offset:1024
    v_mfma_f32_16x16x32_bf16 v[164:167], a[96:99], a[44:47], -4.0
    s_add_u32 m0, s26, 64
    v_add_u32 v242, s27, v242
    v_mfma_f32_16x16x32_bf16 v[164:167], a[100:103], a[40:43], v[164:167]
    global_load_lds_dwordx4 v244, s[52:53] offset:2048
    v_mfma_f32_16x16x32_bf16 v[164:167], a[104:107], a[36:39], v[164:167]
    v_exp_f32 v160, v160
    v_mfma_f32_16x16x32_bf16 v[164:167], a[108:111], a[32:35], v[164:167]
    v_exp_f32 v161, v161
    v_mfma_f32_16x16x32_bf16 v[32:35], v[184:187], a[144:147], v[32:35]
    v_exp_f32 v162, v162
    v_mfma_f32_16x16x32_bf16 v[32:35], v[188:191], a[176:179], v[32:35]
    v_exp_f32 v163, v163
    v_mfma_f32_16x16x32_bf16 v[36:39], v[184:187], a[148:151], v[36:39]
    v_cvt_pk_bf16_f32 v176, v160, v161
    v_cvt_pk_bf16_f32 v177, v162, v163
    v_mfma_f32_16x16x32_bf16 v[36:39], v[188:191], a[180:183], v[36:39]
    v_exp_f32 v164, v164
    v_mfma_f32_16x16x32_bf16 v[40:43], v[184:187], a[152:155], v[40:43]
    v_exp_f32 v165, v165
    v_mfma_f32_16x16x32_bf16 v[40:43], v[188:191], a[184:187], v[40:43]
    v_exp_f32 v166, v166
    v_mfma_f32_16x16x32_bf16 v[44:47], v[184:187], a[156:159], v[44:47]
    v_exp_f32 v167, v167
    v_mfma_f32_16x16x32_bf16 v[44:47], v[188:191], a[188:191], v[44:47]
    v_cvt_pk_bf16_f32 v178, v164, v165
    v_cvt_pk_bf16_f32 v179, v166, v167
    v_mfma_f32_16x16x32_bf16 v[48:51], v[184:187], a[160:163], v[48:51]
    v_add_u32 v243, s27, v243
    v_mfma_f32_16x16x32_bf16 v[48:51], v[188:191], a[192:195], v[48:51]
    v_mfma_f32_16x16x32_bf16 v[52:55], v[184:187], a[164:167], v[52:55]
    v_mfma_f32_16x16x32_bf16 v[52:55], v[188:191], a[196:199], v[52:55]
    v_mfma_f32_16x16x32_bf16 v[56:59], v[184:187], a[168:171], v[56:59]
    v_mfma_f32_16x16x32_bf16 v[56:59], v[188:191], a[200:203], v[56:59]
    v_mfma_f32_16x16x32_bf16 v[60:63], v[184:187], a[172:175], v[60:63]
    v_mfma_f32_16x16x32_bf16 v[60:63], v[188:191], a[204:207], v[60:63]
    s_add_u32 m0, s26, 96
    v_smfmac_f32_16x16x64_bf16 a[212:215], a[228:231], v[184:191], v247
    global_load_lds_dwordx4 v244, s[52:53] offset:3072
    v_mfma_f32_16x16x32_bf16 v[160:163], a[80:83], a[48:51], -4.0
    s_add_u32 m0, s26, 16896
    v_mfma_f32_16x16x32_bf16 v[160:163], a[84:87], a[52:55], v[160:163]
    global_load_lds_dwordx4 v244, s[54:55] offset:0
    v_mfma_f32_16x16x32_bf16 v[160:163], a[88:91], a[56:59], v[160:163]
    s_add_u32 m0, s26, 16912
    v_mfma_f32_16x16x32_bf16 v[160:163], a[92:95], a[60:63], v[160:163]
    global_load_lds_dwordx4 v244, s[54:55] offset:1024
    v_mfma_f32_16x16x32_bf16 v[164:167], a[96:99], a[60:63], -4.0
    s_add_u32 m0, s26, 16928
    v_mfma_f32_16x16x32_bf16 v[164:167], a[100:103], a[56:59], v[164:167]
    global_load_lds_dwordx4 v244, s[54:55] offset:2048
    v_mfma_f32_16x16x32_bf16 v[164:167], a[104:107], a[52:55], v[164:167]
    v_exp_f32 v160, v160
    v_mfma_f32_16x16x32_bf16 v[164:167], a[108:111], a[48:51], v[164:167]
    v_exp_f32 v161, v161
    v_mfma_f32_16x16x32_bf16 v[168:171], a[112:115], a[48:51], -4.0
    v_exp_f32 v162, v162
    v_mfma_f32_16x16x32_bf16 v[168:171], a[116:119], a[52:55], v[168:171]
    v_exp_f32 v163, v163
    v_mfma_f32_16x16x32_bf16 v[168:171], a[120:123], a[56:59], v[168:171]
    v_cvt_pk_bf16_f32 v184, v160, v161
    v_cvt_pk_bf16_f32 v185, v162, v163
    v_mfma_f32_16x16x32_bf16 v[168:171], a[124:127], a[60:63], v[168:171]
    v_exp_f32 v164, v164
    v_mfma_f32_16x16x32_bf16 v[172:175], a[128:131], a[60:63], -4.0
    v_exp_f32 v165, v165
    v_mfma_f32_16x16x32_bf16 v[172:175], a[132:135], a[56:59], v[172:175]
    v_exp_f32 v166, v166
    v_mfma_f32_16x16x32_bf16 v[172:175], a[136:139], a[52:55], v[172:175]
    v_exp_f32 v167, v167
    v_mfma_f32_16x16x32_bf16 v[172:175], a[140:143], a[48:51], v[172:175]
    v_cvt_pk_bf16_f32 v186, v164, v165
    v_cvt_pk_bf16_f32 v187, v166, v167
    v_mfma_f32_16x16x32_bf16 v[64:67], v[176:179], a[144:147], v[64:67]
    v_exp_f32 v168, v168
    v_mfma_f32_16x16x32_bf16 v[68:71], v[176:179], a[148:151], v[68:71]
    v_exp_f32 v169, v169
    v_mfma_f32_16x16x32_bf16 v[72:75], v[176:179], a[152:155], v[72:75]
    v_exp_f32 v170, v170
    v_mfma_f32_16x16x32_bf16 v[76:79], v[176:179], a[156:159], v[76:79]
    v_exp_f32 v171, v171
    v_mfma_f32_16x16x32_bf16 v[80:83], v[176:179], a[160:163], v[80:83]
    v_cvt_pk_bf16_f32 v188, v168, v169
    v_cvt_pk_bf16_f32 v189, v170, v171
    v_mfma_f32_16x16x32_bf16 v[84:87], v[176:179], a[164:167], v[84:87]
    v_exp_f32 v172, v172
    v_mfma_f32_16x16x32_bf16 v[88:91], v[176:179], a[168:171], v[88:91]
    v_exp_f32 v173, v173
    v_mfma_f32_16x16x32_bf16 v[92:95], v[176:179], a[172:175], v[92:95]
    s_add_u32 m0, s26, 16944
    v_cvt_pk_bf16_f32 v190, v172, v173
    v_mfma_f32_16x16x32_bf16 a[216:219], a[232:235], v[176:179], a[216:219]
    global_load_lds_dwordx4 v244, s[54:55] offset:3072
    v_mfma_f32_16x16x32_bf16 v[160:163], a[80:83], a[64:67], -4.0
    s_add_u32 s24, s24, s22
    v_exp_f32 v174, v174
    v_mfma_f32_16x16x32_bf16 v[160:163], a[84:87], a[68:71], v[160:163]
    s_and_b32 s24, s24, 0x3ffff
    v_exp_f32 v175, v175
    v_mfma_f32_16x16x32_bf16 v[160:163], a[88:91], a[72:75], v[160:163]
    s_cmp_eq_u32 s23, 4
    ds_read_b128 a[80:83], v240 offset:0
    v_cvt_pk_bf16_f32 v191, v174, v175
    v_mfma_f32_16x16x32_bf16 v[160:163], a[92:95], a[76:79], v[160:163]
    s_cselect_b32 s24, 0, s24
    ds_read_b128 a[84:87], v240 offset:64
    v_mfma_f32_16x16x32_bf16 v[164:167], a[96:99], a[76:79], -4.0
    s_cselect_b32 s22, 0, s22
    ds_read_b128 a[88:91], v240 offset:128
    v_mfma_f32_16x16x32_bf16 v[164:167], a[100:103], a[72:75], v[164:167]
    s_add_u32 s65, s25, s24
    ds_read_b128 a[92:95], v240 offset:192
    v_mfma_f32_16x16x32_bf16 v[164:167], a[104:107], a[68:71], v[164:167]
    s_add_u32 s52, s8, s65
    v_exp_f32 v160, v160
    v_mfma_f32_16x16x32_bf16 v[164:167], a[108:111], a[64:67], v[164:167]
    s_addc_u32 s53, s9, 0
    v_exp_f32 v161, v161
    v_mfma_f32_16x16x32_bf16 v[168:171], a[112:115], a[64:67], -4.0
    s_add_u32 s54, s12, s65
    ds_read_b128 a[96:99], v240 offset:704
    v_cvt_pk_bf16_f32 v192, v160, v161
    v_mfma_f32_16x16x32_bf16 v[168:171], a[116:119], a[68:71], v[168:171]
    s_addc_u32 s55, s13, 0
    v_exp_f32 v162, v162
    v_mfma_f32_16x16x32_bf16 v[168:171], a[120:123], a[72:75], v[168:171]
    s_add_u32 s26, s26, s27
    v_exp_f32 v163, v163
    v_mfma_f32_16x16x32_bf16 v[168:171], a[124:127], a[76:79], v[168:171]
    s_cmp_eq_u32 s26, s48
    ds_read_b128 a[100:103], v240 offset:640
    v_cvt_pk_bf16_f32 v193, v162, v163
    v_mfma_f32_16x16x32_bf16 v[172:175], a[128:131], a[76:79], -4.0
    s_cselect_b32 s27, s58, s59
    v_exp_f32 v164, v164
    v_mfma_f32_16x16x32_bf16 v[172:175], a[132:135], a[72:75], v[172:175]
    s_sub_u32 s23, s23, 1
    v_exp_f32 v165, v165
    v_mfma_f32_16x16x32_bf16 v[172:175], a[136:139], a[68:71], v[172:175]
    s_cmp_lg_u32 s23, 1
    ds_read_b128 a[104:107], v240 offset:576
    v_cvt_pk_bf16_f32 v194, v164, v165
    v_mfma_f32_16x16x32_bf16 v[172:175], a[140:143], a[64:67], v[172:175]
    v_exp_f32 v166, v166
    v_mfma_f32_16x16x32_bf16 v[96:99], v[184:187], a[144:147], v[96:99]
    v_exp_f32 v167, v167
    v_mfma_f32_16x16x32_bf16 v[96:99], v[188:191], a[176:179], v[96:99]
    ds_read_b128 a[108:111], v240 offset:512
    v_cvt_pk_bf16_f32 v195, v166, v167
    v_mfma_f32_16x16x32_bf16 v[100:103], v[184:187], a[148:151], v[100:103]
    v_exp_f32 v168, v168
    v_mfma_f32_16x16x32_bf16 v[100:103], v[188:191], a[180:183], v[100:103]
    v_exp_f32 v169, v169
    v_mfma_f32_16x16x32_bf16 v[104:107], v[184:187], a[152:155], v[104:107]
    ds_read_b128 a[112:115], v241 offset:0
    v_cvt_pk_bf16_f32 v196, v168, v169
    v_mfma_f32_16x16x32_bf16 v[104:107], v[188:191], a[184:187], v[104:107]
    v_exp_f32 v170, v170
    v_mfma_f32_16x16x32_bf16 v[108:111], v[184:187], a[156:159], v[108:111]
    v_exp_f32 v171, v171
    v_mfma_f32_16x16x32_bf16 v[108:111], v[188:191], a[188:191], v[108:111]
    ds_read_b128 a[116:119], v241 offset:64
    v_cvt_pk_bf16_f32 v197, v170, v171
    v_mfma_f32_16x16x32_bf16 v[112:115], v[184:187], a[160:163], v[112:115]
    v_exp_f32 v172, v172
    v_mfma_f32_16x16x32_bf16 v[112:115], v[188:191], a[192:195], v[112:115]
    v_exp_f32 v173, v173
    v_mfma_f32_16x16x32_bf16 v[116:119], v[184:187], a[164:167], v[116:119]
    ds_read_b128 a[120:123], v241 offset:128
    v_cvt_pk_bf16_f32 v198, v172, v173
    v_mfma_f32_16x16x32_bf16 v[116:119], v[188:191], a[196:199], v[116:119]
    v_exp_f32 v174, v174
    v_mfma_f32_16x16x32_bf16 v[120:123], v[184:187], a[168:171], v[120:123]
    v_exp_f32 v175, v175
    v_mfma_f32_16x16x32_bf16 v[120:123], v[188:191], a[200:203], v[120:123]
    ds_read_b128 a[124:127], v241 offset:192
    v_cvt_pk_bf16_f32 v199, v174, v175
    v_mfma_f32_16x16x32_bf16 v[124:127], v[184:187], a[172:175], v[124:127]
    ds_read_b128 a[128:131], v241 offset:704
    v_mfma_f32_16x16x32_bf16 v[124:127], v[188:191], a[204:207], v[124:127]
    ds_read_b128 a[132:135], v241 offset:640
    v_smfmac_f32_16x16x64_bf16 a[220:223], a[228:231], v[184:191], v247
    s_waitcnt lgkmcnt(4)
    ds_read_b128 a[136:139], v241 offset:576
    v_mfma_f32_16x16x32_bf16 v[160:163], a[80:83], v[200:203], -4.0
    ds_read_b128 a[140:143], v241 offset:512
    v_mfma_f32_16x16x32_bf16 v[160:163], a[84:87], v[204:207], v[160:163]
    v_mfma_f32_16x16x32_bf16 v[160:163], a[88:91], v[208:211], v[160:163]
    v_mfma_f32_16x16x32_bf16 v[160:163], a[92:95], v[212:215], v[160:163]
    v_mfma_f32_16x16x32_bf16 v[164:167], a[96:99], v[212:215], -4.0
    v_mfma_f32_16x16x32_bf16 v[164:167], a[100:103], v[208:211], v[164:167]
    v_mfma_f32_16x16x32_bf16 v[164:167], a[104:107], v[204:207], v[164:167]
    v_exp_f32 v160, v160
    v_mfma_f32_16x16x32_bf16 v[164:167], a[108:111], v[200:203], v[164:167]
    v_exp_f32 v161, v161
    v_mfma_f32_16x16x32_bf16 v[168:171], a[112:115], v[200:203], -4.0
    v_exp_f32 v162, v162
    v_mfma_f32_16x16x32_bf16 v[168:171], a[116:119], v[204:207], v[168:171]
    s_waitcnt lgkmcnt(0)
    v_exp_f32 v163, v163
    v_mfma_f32_16x16x32_bf16 v[168:171], a[120:123], v[208:211], v[168:171]
    v_cvt_pk_bf16_f32 v176, v160, v161
    v_cvt_pk_bf16_f32 v177, v162, v163
    v_mfma_f32_16x16x32_bf16 v[168:171], a[124:127], v[212:215], v[168:171]
    v_exp_f32 v164, v164
    v_mfma_f32_16x16x32_bf16 v[172:175], a[128:131], v[212:215], -4.0
    v_exp_f32 v165, v165
    v_mfma_f32_16x16x32_bf16 v[172:175], a[132:135], v[208:211], v[172:175]
    v_exp_f32 v166, v166
    v_mfma_f32_16x16x32_bf16 v[172:175], a[136:139], v[204:207], v[172:175]
    v_exp_f32 v167, v167
    v_mfma_f32_16x16x32_bf16 v[172:175], a[140:143], v[200:203], v[172:175]
    v_cvt_pk_bf16_f32 v178, v164, v165
    v_cvt_pk_bf16_f32 v179, v166, v167
    v_mfma_f32_16x16x32_bf16 v[128:131], v[192:195], a[144:147], v[128:131]
    ds_read_b64_tr_b16 a[144:145], v242 offset:0
    ds_read_b64_tr_b16 a[146:147], v242 offset:512
    v_mfma_f32_16x16x32_bf16 v[128:131], v[196:199], a[176:179], v[128:131]
    v_exp_f32 v168, v168
    v_mfma_f32_16x16x32_bf16 v[132:135], v[192:195], a[148:151], v[132:135]
    ds_read_b64_tr_b16 a[176:177], v243 offset:0
    ds_read_b64_tr_b16 a[178:179], v243 offset:512
    v_mfma_f32_16x16x32_bf16 v[132:135], v[196:199], a[180:183], v[132:135]
    v_exp_f32 v169, v169
    v_mfma_f32_16x16x32_bf16 v[136:139], v[192:195], a[152:155], v[136:139]
    ds_read_b64_tr_b16 a[148:149], v242 offset:16
    ds_read_b64_tr_b16 a[150:151], v242 offset:528
    v_mfma_f32_16x16x32_bf16 v[136:139], v[196:199], a[184:187], v[136:139]
    v_exp_f32 v170, v170
    v_mfma_f32_16x16x32_bf16 v[140:143], v[192:195], a[156:159], v[140:143]
    ds_read_b64_tr_b16 a[180:181], v243 offset:16
    ds_read_b64_tr_b16 a[182:183], v243 offset:528
    v_mfma_f32_16x16x32_bf16 v[140:143], v[196:199], a[188:191], v[140:143]
    v_exp_f32 v171, v171
    v_mfma_f32_16x16x32_bf16 v[144:147], v[192:195], a[160:163], v[144:147]
    ds_read_b64_tr_b16 a[152:153], v242 offset:32
    ds_read_b64_tr_b16 a[154:155], v242 offset:544
    v_mfma_f32_16x16x32_bf16 v[144:147], v[196:199], a[192:195], v[144:147]
    v_exp_f32 v172, v172
    v_mfma_f32_16x16x32_bf16 v[148:151], v[192:195], a[164:167], v[148:151]
    ds_read_b64_tr_b16 a[184:185], v243 offset:32
    ds_read_b64_tr_b16 a[186:187], v243 offset:544
    v_mfma_f32_16x16x32_bf16 v[148:151], v[196:199], a[196:199], v[148:151]
    v_exp_f32 v173, v173
    v_mfma_f32_16x16x32_bf16 v[152:155], v[192:195], a[168:171], v[152:155]
    ds_read_b64_tr_b16 a[156:157], v242 offset:48
    ds_read_b64_tr_b16 a[158:159], v242 offset:560
    v_mfma_f32_16x16x32_bf16 v[152:155], v[196:199], a[200:203], v[152:155]
    v_exp_f32 v174, v174
    v_mfma_f32_16x16x32_bf16 v[156:159], v[192:195], a[172:175], v[156:159]
    ds_read_b64_tr_b16 a[188:189], v243 offset:48
    ds_read_b64_tr_b16 a[190:191], v243 offset:560
    v_mfma_f32_16x16x32_bf16 v[156:159], v[196:199], a[204:207], v[156:159]
    v_exp_f32 v175, v175
    v_smfmac_f32_16x16x64_bf16 a[224:227], a[228:231], v[192:199], v247
    s_cbranch_scc1 L_loop1r0
L_lastr0:
    v_mfma_f32_16x16x32_bf16 v[160:163], a[80:83], v[216:219], -4.0
    ds_read_b64_tr_b16 a[160:161], v242 offset:128
    ds_read_b64_tr_b16 a[162:163], v242 offset:640
    v_mfma_f32_16x16x32_bf16 v[160:163], a[84:87], v[220:223], v[160:163]
    v_cvt_pk_bf16_f32 v180, v168, v169
    v_cvt_pk_bf16_f32 v181, v170, v171
    v_mfma_f32_16x16x32_bf16 v[160:163], a[88:91], v[224:227], v[160:163]
    ds_read_b64_tr_b16 a[192:193], v243 offset:128
    ds_read_b64_tr_b16 a[194:195], v243 offset:640
    v_mfma_f32_16x16x32_bf16 v[160:163], a[92:95], v[228:231], v[160:163]
    v_cvt_pk_bf16_f32 v182, v172, v173
    v_cvt_pk_bf16_f32 v183, v174, v175
    v_mfma_f32_16x16x32_bf16 v[164:167], a[96:99], v[228:231], -4.0
    ds_read_b64_tr_b16 a[164:165], v242 offset:144
    ds_read_b64_tr_b16 a[166:167], v242 offset:656
    v_mfma_f32_16x16x32_bf16 v[164:167], a[100:103], v[224:227], v[164:167]
    v_mfma_f32_16x16x32_bf16 v[164:167], a[104:107], v[220:223], v[164:167]
    ds_read_b64_tr_b16 a[196:197], v243 offset:144
    ds_read_b64_tr_b16 a[198:199], v243 offset:656
    v_mfma_f32_16x16x32_bf16 v[164:167], a[108:111], v[216:219], v[164:167]
    v_exp_f32 v160, v160
    v_mfma_f32_16x16x32_bf16 v[168:171], a[112:115], v[216:219], -4.0
    ds_read_b64_tr_b16 a[168:169], v242 offset:160
    ds_read_b64_tr_b16 a[170:171], v242 offset:672
    v_mfma_f32_16x16x32_bf16 v[168:171], a[116:119], v[220:223], v[168:171]
    v_exp_f32 v161, v161
    v_mfma_f32_16x16x32_bf16 v[168:171], a[120:123], v[224:227], v[168:171]
    ds_read_b64_tr_b16 a[200:201], v243 offset:160
    ds_read_b64_tr_b16 a[202:203], v243 offset:672
    v_mfma_f32_16x16x32_bf16 v[168:171], a[124:127], v[228:231], v[168:171]
    v_exp_f32 v162, v162
    v_mfma_f32_16x16x32_bf16 v[172:175], a[128:131], v[228:231], -4.0
    ds_read_b64_tr_b16 a[172:173], v242 offset:176
    ds_read_b64_tr_b16 a[174:175], v242 offset:688
    v_mfma_f32_16x16x32_bf16 v[172:175], a[132:135], v[224:227], v[172:175]
    v_exp_f32 v163, v163
    v_mfma_f32_16x16x32_bf16 v[172:175], a[136:139], v[220:223], v[172:175]
    ds_read_b64_tr_b16 a[204:205], v243 offset:176
    ds_read_b64_tr_b16 a[206:207], v243 offset:688
    v_mfma_f32_16x16x32_bf16 v[172:175], a[140:143], v[216:219], v[172:175]
    s_waitcnt lgkmcnt(8)
    v_cvt_pk_bf16_f32 v184, v160, v161
    v_cvt_pk_bf16_f32 v185, v162, v163
    v_mfma_f32_16x16x32_bf16 v[0:3], v[176:179], a[144:147], v[0:3]
    v_exp_f32 v164, v164
    v_mfma_f32_16x16x32_bf16 v[0:3], v[180:183], a[176:179], v[0:3]
    v_exp_f32 v165, v165
    v_smfmac_f32_16x16x64_bf16 a[208:211], a[228:231], v[176:183], v247
    v_mfma_f32_16x16x32_bf16 v[4:7], v[176:179], a[148:151], v[4:7]
    v_exp_f32 v166, v166
    v_mfma_f32_16x16x32_bf16 v[4:7], v[180:183], a[180:183], v[4:7]
    v_exp_f32 v167, v167
    v_mfma_f32_16x16x32_bf16 v[8:11], v[176:179], a[152:155], v[8:11]
    v_cvt_pk_bf16_f32 v186, v164, v165
    v_cvt_pk_bf16_f32 v187, v166, v167
    v_mfma_f32_16x16x32_bf16 v[8:11], v[180:183], a[184:187], v[8:11]
    v_exp_f32 v168, v168
    v_mfma_f32_16x16x32_bf16 v[12:15], v[176:179], a[156:159], v[12:15]
    v_exp_f32 v172, v172
    v_mfma_f32_16x16x32_bf16 v[12:15], v[180:183], a[188:191], v[12:15]
    v_exp_f32 v169, v169
    v_mfma_f32_16x16x32_bf16 v[16:19], v[176:179], a[160:163], v[16:19]
    v_exp_f32 v173, v173
    v_mfma_f32_16x16x32_bf16 v[16:19], v[180:183], a[192:195], v[16:19]
    v_exp_f32 v170, v170
    v_mfma_f32_16x16x32_bf16 v[20:23], v[176:179], a[164:167], v[20:23]
    v_exp_f32 v174, v174
    v_mfma_f32_16x16x32_bf16 v[20:23], v[180:183], a[196:199], v[20:23]
    s_waitcnt lgkmcnt(0)
    v_exp_f32 v171, v171
    v_mfma_f32_16x16x32_bf16 v[24:27], v[176:179], a[168:171], v[24:27]
    v_exp_f32 v175, v175
    v_mfma_f32_16x16x32_bf16 v[24:27], v[180:183], a[200:203], v[24:27]
    v_cvt_pk_bf16_f32 v188, v168, v169
    v_cvt_pk_bf16_f32 v189, v170, v171
    v_mfma_f32_16x16x32_bf16 v[28:31], v[176:179], a[172:175], v[28:31]
    v_cvt_pk_bf16_f32 v190, v172, v173
    v_cvt_pk_bf16_f32 v191, v174, v175
    v_mfma_f32_16x16x32_bf16 v[28:31], v[180:183], a[204:207], v[28:31]
    v_accvgpr_read_b32 v248, a208
    v_accvgpr_read_b32 v249, a209
    v_mfma_f32_16x16x32_bf16 v[160:163], a[80:83], a[32:35], -4.0
    v_add_f32 v248, v248, v249
    v_subrev_u32 v249, s42, v248
    v_mfma_f32_16x16x32_bf16 v[160:163], a[84:87], a[36:39], v[160:163]
    v_rcp_f32 v248, v248
    v_mfma_f32_16x16x32_bf16 v[160:163], a[88:91], a[40:43], v[160:163]
    v_cmp_le_u32 vcc, s43, v249
    v_mov_b32 v251, v248
    v_mov_b32_dpp v251, v248 row_ror:12 row_mask:0x2 bank_mask:0xf
    v_mov_b32_dpp v251, v248 row_ror:8 row_mask:0x4 bank_mask:0xf
    v_mov_b32_dpp v251, v248 row_ror:4 row_mask:0x8 bank_mask:0xf
    s_nop 1
    v_mov_b32_dpp v248, v251 row_newbcast:0 row_mask:0xf bank_mask:0xf
    v_mov_b32_dpp v249, v251 row_newbcast:1 row_mask:0xf bank_mask:0xf
    v_mov_b32_dpp v250, v251 row_newbcast:2 row_mask:0xf bank_mask:0xf
    v_mov_b32_dpp v251, v251 row_newbcast:3 row_mask:0xf bank_mask:0xf
    v_pk_mul_f32 v[0:1], v[0:1], v[248:249]
    v_pk_mul_f32 v[2:3], v[2:3], v[250:251]
    v_pk_mul_f32 v[4:5], v[4:5], v[248:249]
    v_pk_mul_f32 v[6:7], v[6:7], v[250:251]
    v_pk_mul_f32 v[8:9], v[8:9], v[248:249]
    v_pk_mul_f32 v[10:11], v[10:11], v[250:251]
    v_pk_mul_f32 v[12:13], v[12:13], v[248:249]
    v_pk_mul_f32 v[14:15], v[14:15], v[250:251]
    v_pk_mul_f32 v[16:17], v[16:17], v[248:249]
    v_pk_mul_f32 v[18:19], v[18:19], v[250:251]
    v_pk_mul_f32 v[20:21], v[20:21], v[248:249]
    v_pk_mul_f32 v[22:23], v[22:23], v[250:251]
    v_pk_mul_f32 v[24:25], v[24:25], v[248:249]
    v_pk_mul_f32 v[26:27], v[26:27], v[250:251]
    v_pk_mul_f32 v[28:29], v[28:29], v[248:249]
    v_pk_mul_f32 v[30:31], v[30:31], v[250:251]
    v_cvt_pk_bf16_f32 v0, v0, v4
    v_cvt_pk_bf16_f32 v4, v1, v5
    v_cvt_pk_bf16_f32 v1, v8, v12
    v_cvt_pk_bf16_f32 v5, v9, v13
    v_mfma_f32_16x16x32_bf16 v[160:163], a[92:95], a[44:47], v[160:163]
    s_or_b64 s[46:47], s[46:47], vcc
    ds_write_b64 v246, v[0:1] offset:5440
    v_cvt_pk_bf16_f32 v16, v16, v20
    v_cvt_pk_bf16_f32 v20, v17, v21
    v_mfma_f32_16x16x32_bf16 v[164:167], a[96:99], a[44:47], -4.0
    ds_write_b64 v246, v[4:5] offset:6528
    v_cvt_pk_bf16_f32 v17, v24, v28
    v_cvt_pk_bf16_f32 v21, v25, v29
    v_mfma_f32_16x16x32_bf16 v[164:167], a[100:103], a[40:43], v[164:167]
    ds_write_b64 v246, v[16:17] offset:5568
    v_cvt_pk_bf16_f32 v2, v2, v6
    v_cvt_pk_bf16_f32 v6, v3, v7
    v_mfma_f32_16x16x32_bf16 v[164:167], a[104:107], a[36:39], v[164:167]
    ds_write_b64 v246, v[20:21] offset:6656
    v_exp_f32 v160, v160
    v_cvt_pk_bf16_f32 v3, v10, v14
    v_cvt_pk_bf16_f32 v7, v11, v15
    v_mfma_f32_16x16x32_bf16 v[164:167], a[108:111], a[32:35], v[164:167]
    ds_read_b64_tr_b16 v[216:217], v252 offset:5440
    ds_read_b64_tr_b16 v[218:219], v252 offset:5472
    v_exp_f32 v161, v161
    v_cvt_pk_bf16_f32 v18, v18, v22
    v_cvt_pk_bf16_f32 v22, v19, v23
    v_mfma_f32_16x16x32_bf16 v[32:35], v[184:187], a[144:147], v[32:35]
    ds_read_b64_tr_b16 v[220:221], v252 offset:6528
    ds_read_b64_tr_b16 v[222:223], v252 offset:6560
    v_exp_f32 v162, v162
    v_cvt_pk_bf16_f32 v19, v26, v30
    v_cvt_pk_bf16_f32 v23, v27, v31
    v_mfma_f32_16x16x32_bf16 v[32:35], v[188:191], a[176:179], v[32:35]
    ds_write_b64 v246, v[2:3] offset:7616
    v_exp_f32 v163, v163
    v_smfmac_f32_16x16x64_bf16 a[212:215], a[228:231], v[184:191], v247
    ds_write_b64 v246, v[6:7] offset:8704
    v_mfma_f32_16x16x32_bf16 v[36:39], v[184:187], a[148:151], v[36:39]
    ds_write_b64 v246, v[18:19] offset:7744
    v_cvt_pk_bf16_f32 v176, v160, v161
    v_cvt_pk_bf16_f32 v177, v162, v163
    v_mfma_f32_16x16x32_bf16 v[36:39], v[188:191], a[180:183], v[36:39]
    ds_write_b64 v246, v[22:23] offset:8832
    v_exp_f32 v164, v164
    v_mfma_f32_16x16x32_bf16 v[40:43], v[184:187], a[152:155], v[40:43]
    s_waitcnt lgkmcnt(6)
    buffer_store_dwordx4 v[216:219], v244, s[16:19], s35 offen offset:0 nt
    v_exp_f32 v165, v165
    v_mfma_f32_16x16x32_bf16 v[40:43], v[188:191], a[184:187], v[40:43]
L_pad0_7:
    s_cbranch_execz L_ret1
    v_exp_f32 v166, v166
    v_mfma_f32_16x16x32_bf16 v[44:47], v[184:187], a[156:159], v[44:47]
    v_exp_f32 v167, v167
    v_mfma_f32_16x16x32_bf16 v[44:47], v[188:191], a[188:191], v[44:47]
    v_cvt_pk_bf16_f32 v178, v164, v165
    v_cvt_pk_bf16_f32 v179, v166, v167
    v_mfma_f32_16x16x32_bf16 v[48:51], v[184:187], a[160:163], v[48:51]
    ds_read_b64_tr_b16 v[224:225], v252 offset:7616
    ds_read_b64_tr_b16 v[226:227], v252 offset:7648
    v_mfma_f32_16x16x32_bf16 v[48:51], v[188:191], a[192:195], v[48:51]
    ds_read_b64_tr_b16 v[228:229], v252 offset:8704
    ds_read_b64_tr_b16 v[230:231], v252 offset:8736
    v_mfma_f32_16x16x32_bf16 v[52:55], v[184:187], a[164:167], v[52:55]
    s_waitcnt lgkmcnt(6)
    buffer_store_dwordx4 v[220:223], v244, s[16:19], s35 offen offset:1024 nt
    v_mfma_f32_16x16x32_bf16 v[52:55], v[188:191], a[196:199], v[52:55]
    v_accvgpr_read_b32 v248, a212
    v_accvgpr_read_b32 v249, a213
    v_mfma_f32_16x16x32_bf16 v[56:59], v[184:187], a[168:171], v[56:59]
    v_add_f32 v248, v248, v249
    v_subrev_u32 v249, s42, v248
    v_mfma_f32_16x16x32_bf16 v[56:59], v[188:191], a[200:203], v[56:59]
    s_waitcnt lgkmcnt(2)
    buffer_store_dwordx4 v[224:227], v244, s[16:19], s35 offen offset:2048 nt
    v_mfma_f32_16x16x32_bf16 v[60:63], v[184:187], a[172:175], v[60:63]
    v_rcp_f32 v248, v248
    v_mfma_f32_16x16x32_bf16 v[60:63], v[188:191], a[204:207], v[60:63]
    v_cmp_le_u32 vcc, s43, v249
    v_mov_b32 v251, v248
    v_mfma_f32_16x16x32_bf16 v[160:163], a[80:83], a[48:51], -4.0
    s_waitcnt lgkmcnt(0)
    buffer_store_dwordx4 v[228:231], v244, s[16:19], s35 offen offset:3072 nt
    v_mfma_f32_16x16x32_bf16 v[160:163], a[84:87], a[52:55], v[160:163]
    s_or_b64 s[46:47], s[46:47], vcc
    v_mov_b32_dpp v251, v248 row_ror:12 row_mask:0x2 bank_mask:0xf
    v_mov_b32_dpp v251, v248 row_ror:8 row_mask:0x4 bank_mask:0xf
    v_mfma_f32_16x16x32_bf16 v[160:163], a[88:91], a[56:59], v[160:163]
    v_mov_b32_dpp v251, v248 row_ror:4 row_mask:0x8 bank_mask:0xf
    s_nop 1
    v_mov_b32_dpp v248, v251 row_newbcast:0 row_mask:0xf bank_mask:0xf
    v_mov_b32_dpp v249, v251 row_newbcast:1 row_mask:0xf bank_mask:0xf
    v_mov_b32_dpp v250, v251 row_newbcast:2 row_mask:0xf bank_mask:0xf
    v_mov_b32_dpp v251, v251 row_newbcast:3 row_mask:0xf bank_mask:0xf
    v_pk_mul_f32 v[32:33], v[32:33], v[248:249]
    v_pk_mul_f32 v[34:35], v[34:35], v[250:251]
    v_pk_mul_f32 v[36:37], v[36:37], v[248:249]
    v_pk_mul_f32 v[38:39], v[38:39], v[250:251]
    v_pk_mul_f32 v[40:41], v[40:41], v[248:249]
    v_pk_mul_f32 v[42:43], v[42:43], v[250:251]
    v_pk_mul_f32 v[44:45], v[44:45], v[248:249]
    v_pk_mul_f32 v[46:47], v[46:47], v[250:251]
    v_pk_mul_f32 v[48:49], v[48:49], v[248:249]
    v_pk_mul_f32 v[50:51], v[50:51], v[250:251]
    v_pk_mul_f32 v[52:53], v[52:53], v[248:249]
    v_pk_mul_f32 v[54:55], v[54:55], v[250:251]
    v_pk_mul_f32 v[56:57], v[56:57], v[248:249]
    v_pk_mul_f32 v[58:59], v[58:59], v[250:251]
    v_pk_mul_f32 v[60:61], v[60:61], v[248:249]
    v_pk_mul_f32 v[62:63], v[62:63], v[250:251]
    v_cvt_pk_bf16_f32 v32, v32, v36
    v_cvt_pk_bf16_f32 v36, v33, v37
    v_cvt_pk_bf16_f32 v33, v40, v44
    v_cvt_pk_bf16_f32 v37, v41, v45
    v_mfma_f32_16x16x32_bf16 v[160:163], a[92:95], a[60:63], v[160:163]
    ds_write_b64 v246, v[32:33] offset:1088
    v_cvt_pk_bf16_f32 v48, v48, v52
    v_cvt_pk_bf16_f32 v52, v49, v53
    v_mfma_f32_16x16x32_bf16 v[164:167], a[96:99], a[60:63], -4.0
    ds_write_b64 v246, v[36:37] offset:2176
    v_cvt_pk_bf16_f32 v49, v56, v60
    v_cvt_pk_bf16_f32 v53, v57, v61
    v_mfma_f32_16x16x32_bf16 v[164:167], a[100:103], a[56:59], v[164:167]
    ds_write_b64 v246, v[48:49] offset:1216
    v_cvt_pk_bf16_f32 v34, v34, v38
    v_cvt_pk_bf16_f32 v38, v35, v39
    v_mfma_f32_16x16x32_bf16 v[164:167], a[104:107], a[52:55], v[164:167]
    ds_write_b64 v246, v[52:53] offset:2304
    v_exp_f32 v160, v160
    v_cvt_pk_bf16_f32 v35, v42, v46
    v_cvt_pk_bf16_f32 v39, v43, v47
    v_mfma_f32_16x16x32_bf16 v[164:167], a[108:111], a[48:51], v[164:167]
    ds_read_b64_tr_b16 v[200:201], v252 offset:1088
    ds_read_b64_tr_b16 v[202:203], v252 offset:1120
    v_exp_f32 v161, v161
    v_cvt_pk_bf16_f32 v50, v50, v54
    v_cvt_pk_bf16_f32 v54, v51, v55
    v_mfma_f32_16x16x32_bf16 v[168:171], a[112:115], a[48:51], -4.0
    ds_read_b64_tr_b16 v[204:205], v252 offset:2176
    ds_read_b64_tr_b16 v[206:207], v252 offset:2208
    v_exp_f32 v162, v162
    v_cvt_pk_bf16_f32 v51, v58, v62
    v_cvt_pk_bf16_f32 v55, v59, v63
    v_mfma_f32_16x16x32_bf16 v[168:171], a[116:119], a[52:55], v[168:171]
    ds_write_b64 v246, v[34:35] offset:3264
    v_exp_f32 v163, v163
    v_mfma_f32_16x16x32_bf16 v[168:171], a[120:123], a[56:59], v[168:171]
    ds_write_b64 v246, v[38:39] offset:4352
    v_cvt_pk_bf16_f32 v184, v160, v161
    v_cvt_pk_bf16_f32 v185, v162, v163
    v_mfma_f32_16x16x32_bf16 v[168:171], a[124:127], a[60:63], v[168:171]
    ds_write_b64 v246, v[50:51] offset:3392
    v_exp_f32 v164, v164
    v_mfma_f32_16x16x32_bf16 v[172:175], a[128:131], a[60:63], -4.0
    ds_write_b64 v246, v[54:55] offset:4480
    v_exp_f32 v165, v165
    v_mfma_f32_16x16x32_bf16 v[172:175], a[132:135], a[56:59], v[172:175]
    s_waitcnt lgkmcnt(6)
    buffer_store_dwordx4 v[200:203], v244, s[16:19], s36 offen offset:0 nt
    v_exp_f32 v166, v166
    v_mfma_f32_16x16x32_bf16 v[172:175], a[136:139], a[52:55], v[172:175]
    ds_read_b64_tr_b16 v[208:209], v252 offset:3264
    ds_read_b64_tr_b16 v[210:211], v252 offset:3296
    v_exp_f32 v167, v167
    v_mfma_f32_16x16x32_bf16 v[172:175], a[140:143], a[48:51], v[172:175]
    ds_read_b64_tr_b16 v[212:213], v252 offset:4352
    ds_read_b64_tr_b16 v[214:215], v252 offset:4384
    v_cvt_pk_bf16_f32 v186, v164, v165
    v_cvt_pk_bf16_f32 v187, v166, v167
    v_mfma_f32_16x16x32_bf16 v[64:67], v[176:179], a[144:147], v[64:67]
    v_exp_f32 v168, v168
    v_mfma_f32_16x16x32_bf16 v[68:71], v[176:179], a[148:151], v[68:71]
    v_exp_f32 v169, v169
    v_mfma_f32_16x16x32_bf16 a[216:219], a[232:235], v[176:179], a[216:219]
    s_waitcnt lgkmcnt(7)
    buffer_store_dwordx4 v[204:207], v244, s[16:19], s36 offen offset:1024 nt
    v_mfma_f32_16x16x32_bf16 v[72:75], v[176:179], a[152:155], v[72:75]
    v_exp_f32 v170, v170
    v_mfma_f32_16x16x32_bf16 v[76:79], v[176:179], a[156:159], v[76:79]
    v_exp_f32 v171, v171
    v_mfma_f32_16x16x32_bf16 v[80:83], v[176:179], a[160:163], v[80:83]
    s_waitcnt lgkmcnt(2)
    buffer_store_dwordx4 v[208:211], v244, s[16:19], s36 offen offset:2048 nt
    v_cvt_pk_bf16_f32 v188, v168, v169
    v_cvt_pk_bf16_f32 v189, v170, v171
    v_mfma_f32_16x16x32_bf16 v[84:87], v[176:179], a[164:167], v[84:87]
    v_exp_f32 v172, v172
    v_mfma_f32_16x16x32_bf16 v[88:91], v[176:179], a[168:171], v[88:91]
    v_exp_f32 v173, v173
    v_mfma_f32_16x16x32_bf16 v[92:95], v[176:179], a[172:175], v[92:95]
    s_waitcnt lgkmcnt(0)
    buffer_store_dwordx4 v[212:215], v244, s[16:19], s36 offen offset:3072 nt
    v_cvt_pk_bf16_f32 v190, v172, v173
    v_mfma_f32_16x16x32_bf16 v[160:163], a[80:83], a[64:67], -4.0
    v_exp_f32 v174, v174
    v_mfma_f32_16x16x32_bf16 v[160:163], a[84:87], a[68:71], v[160:163]
    v_exp_f32 v175, v175
    v_mfma_f32_16x16x32_bf16 v[160:163], a[88:91], a[72:75], v[160:163]
    v_cvt_pk_bf16_f32 v191, v174, v175
    v_mfma_f32_16x16x32_bf16 v[160:163], a[92:95], a[76:79], v[160:163]
    v_accvgpr_read_b32 v255, a216
    v_accvgpr_read_b32 v253, a217
    v_add_f32 v255, v255, v253
    v_add_u32 v253, s28, v244
    v_mfma_f32_16x16x32_bf16 v[164:167], a[96:99], a[76:79], -4.0
    ds_write_b32 v253, v255 offset:14144
    s_cmp_lg_u32 s29, 0
    v_mfma_f32_16x16x32_bf16 v[164:167], a[100:103], a[72:75], v[164:167]
    s_cbranch_scc1 L_parr0b0o
    ds_write_b128 v253, v[80:83] offset:9792
    v_mfma_f32_16x16x32_bf16 v[164:167], a[104:107], a[68:71], v[164:167]
    v_exp_f32 v160, v160
    v_mfma_f32_16x16x32_bf16 v[164:167], a[108:111], a[64:67], v[164:167]
    ds_write_b128 v253, v[84:87] offset:10816
    v_exp_f32 v161, v161
    v_mfma_f32_16x16x32_bf16 v[168:171], a[112:115], a[64:67], -4.0
    v_exp_f32 v162, v162
    v_mfma_f32_16x16x32_bf16 v[168:171], a[116:119], a[68:71], v[168:171]
    ds_write_b128 v253, v[88:91] offset:11840
    v_exp_f32 v163, v163
    v_mfma_f32_16x16x32_bf16 v[168:171], a[120:123], a[72:75], v[168:171]
    v_cvt_pk_bf16_f32 v192, v160, v161
    v_cvt_pk_bf16_f32 v193, v162, v163
    v_mfma_f32_16x16x32_bf16 v[168:171], a[124:127], a[76:79], v[168:171]
    ds_write_b128 v253, v[92:95] offset:12864
    v_exp_f32 v164, v164
    v_mfma_f32_16x16x32_bf16 v[172:175], a[128:131], a[76:79], -4.0
    s_branch L_parr0b0e
L_parr0b0o:
    ds_write_b128 v253, v[64:67] offset:9792
    v_mfma_f32_16x16x32_bf16 v[164:167], a[104:107], a[68:71], v[164:167]
    v_exp_f32 v160, v160
    v_mfma_f32_16x16x32_bf16 v[164:167], a[108:111], a[64:67], v[164:167]
    ds_write_b128 v253, v[68:71] offset:10816
    v_exp_f32 v161, v161
    v_mfma_f32_16x16x32_bf16 v[168:171], a[112:115], a[64:67], -4.0
    v_exp_f32 v162, v162
    v_mfma_f32_16x16x32_bf16 v[168:171], a[116:119], a[68:71], v[168:171]
    ds_write_b128 v253, v[72:75] offset:11840
    v_exp_f32 v163, v163
    v_mfma_f32_16x16x32_bf16 v[168:171], a[120:123], a[72:75], v[168:171]
    v_cvt_pk_bf16_f32 v192, v160, v161
    v_cvt_pk_bf16_f32 v193, v162, v163
    v_mfma_f32_16x16x32_bf16 v[168:171], a[124:127], a[76:79], v[168:171]
    ds_write_b128 v253, v[76:79] offset:12864
    v_exp_f32 v164, v164
    v_mfma_f32_16x16x32_bf16 v[172:175], a[128:131], a[76:79], -4.0
L_parr0b0e:
    v_exp_f32 v165, v165
    v_add_u32 v253, s3, v253
    v_mfma_f32_16x16x32_bf16 v[172:175], a[132:135], a[72:75], v[172:175]
    s_waitcnt lgkmcnt(0)
    v_exp_f32 v166, v166
    v_mfma_f32_16x16x32_bf16 v[172:175], a[136:139], a[68:71], v[172:175]
    s_barrier
    v_mfma_f32_16x16x32_bf16 v[172:175], a[140:143], a[64:67], v[172:175]
    v_exp_f32 v167, v167
    s_cmp_lg_u32 s29, 0
    v_mfma_f32_16x16x32_bf16 v[96:99], v[184:187], a[144:147], v[96:99]
    s_cbranch_scc1 L_parr0b1o
    ds_read_b128 v[80:83], v253 offset:9792
    v_cvt_pk_bf16_f32 v194, v164, v165
    v_mfma_f32_16x16x32_bf16 v[96:99], v[188:191], a[176:179], v[96:99]
    ds_read_b128 v[84:87], v253 offset:10816
    v_cvt_pk_bf16_f32 v195, v166, v167
    v_smfmac_f32_16x16x64_bf16 a[220:223], a[228:231], v[184:191], v247
    ds_read_b128 v[88:91], v253 offset:11840
    v_mfma_f32_16x16x32_bf16 v[100:103], v[184:187], a[148:151], v[100:103]
    ds_read_b128 v[92:95], v253 offset:12864
    v_exp_f32 v168, v168
    v_mfma_f32_16x16x32_bf16 v[100:103], v[188:191], a[180:183], v[100:103]
    s_branch L_parr0b1e
L_parr0b1o:
    ds_read_b128 v[64:67], v253 offset:9792
    v_cvt_pk_bf16_f32 v194, v164, v165
    v_mfma_f32_16x16x32_bf16 v[96:99], v[188:191], a[176:179], v[96:99]
    ds_read_b128 v[68:71], v253 offset:10816
    v_cvt_pk_bf16_f32 v195, v166, v167
    v_smfmac_f32_16x16x64_bf16 a[220:223], a[228:231], v[184:191], v247
    ds_read_b128 v[72:75], v253 offset:11840
    v_mfma_f32_16x16x32_bf16 v[100:103], v[184:187], a[148:151], v[100:103]
    ds_read_b128 v[76:79], v253 offset:12864
    v_exp_f32 v168, v168
    v_mfma_f32_16x16x32_bf16 v[100:103], v[188:191], a[180:183], v[100:103]
L_parr0b1e:
    ds_read_b32 v253, v253 offset:14144
    v_exp_f32 v169, v169
    v_mfma_f32_16x16x32_bf16 v[104:107], v[184:187], a[152:155], v[104:107]
    v_exp_f32 v170, v170
    v_mfma_f32_16x16x32_bf16 v[104:107], v[188:191], a[184:187], v[104:107]
    v_exp_f32 v171, v171
    v_mfma_f32_16x16x32_bf16 v[108:111], v[184:187], a[156:159], v[108:111]
    v_cvt_pk_bf16_f32 v196, v168, v169
    v_mfma_f32_16x16x32_bf16 v[108:111], v[188:191], a[188:191], v[108:111]
    v_cvt_pk_bf16_f32 v197, v170, v171
    v_mfma_f32_16x16x32_bf16 v[112:115], v[184:187], a[160:163], v[112:115]
    s_waitcnt lgkmcnt(0)
    v_exp_f32 v172, v172
    v_add_f32 v248, v255, v253
    v_subrev_u32 v249, s42, v248
    v_rcp_f32 v248, v248
    v_cmp_le_u32 vcc, s43, v249
    v_mov_b32 v251, v248
    v_mov_b32_dpp v251, v248 row_ror:12 row_mask:0x2 bank_mask:0xf
    v_mov_b32_dpp v251, v248 row_ror:8 row_mask:0x4 bank_mask:0xf
    v_mov_b32_dpp v251, v248 row_ror:4 row_mask:0x8 bank_mask:0xf
    v_bfe_u32 v253, v244, 5, 1
    v_mad_u32_u24 v253, v253, s64, v252
    v_and_b32 v255, 0x80, v244
    v_mad_u32_u24 v255, v255, 7, v244
    v_lshl_add_u32 v255, s29, 7, v255
    v_mov_b32_dpp v248, v251 row_newbcast:0 row_mask:0xf bank_mask:0xf
    v_mov_b32_dpp v249, v251 row_newbcast:1 row_mask:0xf bank_mask:0xf
    v_mov_b32_dpp v250, v251 row_newbcast:2 row_mask:0xf bank_mask:0xf
    v_mov_b32_dpp v251, v251 row_newbcast:3 row_mask:0xf bank_mask:0xf
    v_pk_add_f32 v[64:65], v[64:65], v[80:81]
    v_pk_add_f32 v[66:67], v[66:67], v[82:83]
    v_pk_add_f32 v[68:69], v[68:69], v[84:85]
    v_pk_add_f32 v[70:71], v[70:71], v[86:87]
    v_pk_add_f32 v[72:73], v[72:73], v[88:89]
    v_pk_add_f32 v[74:75], v[74:75], v[90:91]
    v_pk_add_f32 v[76:77], v[76:77], v[92:93]
    v_pk_add_f32 v[78:79], v[78:79], v[94:95]
    v_pk_mul_f32 v[64:65], v[64:65], v[248:249]
    v_pk_mul_f32 v[66:67], v[66:67], v[250:251]
    v_pk_mul_f32 v[68:69], v[68:69], v[248:249]
    v_pk_mul_f32 v[70:71], v[70:71], v[250:251]
    v_pk_mul_f32 v[72:73], v[72:73], v[248:249]
    v_pk_mul_f32 v[74:75], v[74:75], v[250:251]
    v_pk_mul_f32 v[76:77], v[76:77], v[248:249]
    v_pk_mul_f32 v[78:79], v[78:79], v[250:251]
    v_mfma_f32_16x16x32_bf16 v[112:115], v[188:191], a[192:195], v[112:115]
    s_or_b64 s[46:47], s[46:47], vcc
    v_exp_f32 v173, v173
    v_mfma_f32_16x16x32_bf16 v[116:119], v[184:187], a[164:167], v[116:119]
    v_exp_f32 v174, v174
    v_mfma_f32_16x16x32_bf16 v[116:119], v[188:191], a[196:199], v[116:119]
    v_exp_f32 v175, v175
    v_mfma_f32_16x16x32_bf16 v[120:123], v[184:187], a[168:171], v[120:123]
    v_cvt_pk_bf16_f32 v198, v172, v173
    v_accvgpr_read_b32 v248, a220
    v_mfma_f32_16x16x32_bf16 v[120:123], v[188:191], a[200:203], v[120:123]
    v_cvt_pk_bf16_f32 v199, v174, v175
    v_accvgpr_read_b32 v249, a221
    v_mfma_f32_16x16x32_bf16 v[124:127], v[184:187], a[172:175], v[124:127]
    v_cvt_pk_bf16_f32 v64, v64, v68
    v_cvt_pk_bf16_f32 v68, v65, v69
    v_mfma_f32_16x16x32_bf16 v[124:127], v[188:191], a[204:207], v[124:127]
    v_cvt_pk_bf16_f32 v65, v72, v76
    v_cvt_pk_bf16_f32 v69, v73, v77
    v_mfma_f32_16x16x32_bf16 v[128:131], v[192:195], a[144:147], v[128:131]
    ds_write_b64 v246, v[64:65] offset:1088
    v_mfma_f32_16x16x32_bf16 v[128:131], v[196:199], a[176:179], v[128:131]
    v_cvt_pk_bf16_f32 v66, v66, v70
    v_cvt_pk_bf16_f32 v70, v67, v71
    v_smfmac_f32_16x16x64_bf16 a[224:227], a[228:231], v[192:199], v247
    ds_write_b64 v246, v[68:69] offset:2176
    v_mfma_f32_16x16x32_bf16 v[132:135], v[192:195], a[148:151], v[132:135]
    v_cvt_pk_bf16_f32 v67, v74, v78
    v_cvt_pk_bf16_f32 v71, v75, v79
    v_add_f32 v248, v248, v249
    v_subrev_u32 v249, s42, v248
    v_rcp_f32 v248, v248
    v_cmp_le_u32 vcc, s43, v249
    v_mov_b32 v251, v248
    v_mov_b32_dpp v251, v248 row_ror:12 row_mask:0x2 bank_mask:0xf
    v_mov_b32_dpp v251, v248 row_ror:8 row_mask:0x4 bank_mask:0xf
    v_mov_b32_dpp v251, v248 row_ror:4 row_mask:0x8 bank_mask:0xf
    s_nop 1
    v_mov_b32_dpp v248, v251 row_newbcast:0 row_mask:0xf bank_mask:0xf
    v_mov_b32_dpp v249, v251 row_newbcast:1 row_mask:0xf bank_mask:0xf
    v_mov_b32_dpp v250, v251 row_newbcast:2 row_mask:0xf bank_mask:0xf
    v_mov_b32_dpp v251, v251 row_newbcast:3 row_mask:0xf bank_mask:0xf
    v_pk_mul_f32 v[96:97], v[96:97], v[248:249]
    v_pk_mul_f32 v[98:99], v[98:99], v[250:251]
    v_pk_mul_f32 v[100:101], v[100:101], v[248:249]
    v_pk_mul_f32 v[102:103], v[102:103], v[250:251]
    v_pk_mul_f32 v[104:105], v[104:105], v[248:249]
    v_pk_mul_f32 v[106:107], v[106:107], v[250:251]
    v_pk_mul_f32 v[108:109], v[108:109], v[248:249]
    v_pk_mul_f32 v[110:111], v[110:111], v[250:251]
    v_pk_mul_f32 v[112:113], v[112:113], v[248:249]
    v_pk_mul_f32 v[114:115], v[114:115], v[250:251]
    v_pk_mul_f32 v[116:117], v[116:117], v[248:249]
    v_pk_mul_f32 v[118:119], v[118:119], v[250:251]
    v_pk_mul_f32 v[120:121], v[120:121], v[248:249]
    v_pk_mul_f32 v[122:123], v[122:123], v[250:251]
    v_pk_mul_f32 v[124:125], v[124:125], v[248:249]
    v_pk_mul_f32 v[126:127], v[126:127], v[250:251]
    v_cvt_pk_bf16_f32 v96, v96, v100
    v_cvt_pk_bf16_f32 v100, v97, v101
    v_cvt_pk_bf16_f32 v97, v104, v108
    v_cvt_pk_bf16_f32 v101, v105, v109
    v_mfma_f32_16x16x32_bf16 v[132:135], v[196:199], a[180:183], v[132:135]
    s_or_b64 s[46:47], s[46:47], vcc
    ds_write_b64 v246, v[66:67] offset:3264
    ds_write_b64 v246, v[96:97] offset:5440
    v_cvt_pk_bf16_f32 v112, v112, v116
    v_cvt_pk_bf16_f32 v116, v113, v117
    v_mfma_f32_16x16x32_bf16 v[136:139], v[192:195], a[152:155], v[136:139]
    ds_write_b64 v246, v[70:71] offset:4352
    ds_write_b64 v246, v[100:101] offset:6528
    v_cvt_pk_bf16_f32 v113, v120, v124
    v_cvt_pk_bf16_f32 v117, v121, v125
    v_mfma_f32_16x16x32_bf16 v[136:139], v[196:199], a[184:187], v[136:139]
    ds_write_b64 v246, v[112:113] offset:5568
    v_cvt_pk_bf16_f32 v98, v98, v102
    v_cvt_pk_bf16_f32 v102, v99, v103
    v_mfma_f32_16x16x32_bf16 v[140:143], v[192:195], a[156:159], v[140:143]
    ds_read_b64_tr_b16 v[64:65], v253 offset:1088
    ds_read_b64_tr_b16 v[66:67], v253 offset:1120
    ds_write_b64 v246, v[116:117] offset:6656
    v_cvt_pk_bf16_f32 v99, v106, v110
    v_cvt_pk_bf16_f32 v103, v107, v111
    v_mfma_f32_16x16x32_bf16 v[140:143], v[196:199], a[188:191], v[140:143]
    ds_read_b64_tr_b16 v[68:69], v253 offset:3264
    ds_read_b64_tr_b16 v[70:71], v253 offset:3296
    ds_read_b64_tr_b16 v[200:201], v252 offset:5440
    ds_read_b64_tr_b16 v[202:203], v252 offset:5472
    v_cvt_pk_bf16_f32 v114, v114, v118
    v_cvt_pk_bf16_f32 v118, v115, v119
    v_mfma_f32_16x16x32_bf16 v[144:147], v[192:195], a[160:163], v[144:147]
    ds_read_b64_tr_b16 v[204:205], v252 offset:6528
    ds_read_b64_tr_b16 v[206:207], v252 offset:6560
    v_cvt_pk_bf16_f32 v115, v122, v126
    v_cvt_pk_bf16_f32 v119, v123, v127
    v_mfma_f32_16x16x32_bf16 v[144:147], v[196:199], a[192:195], v[144:147]
    ds_write_b64 v246, v[98:99] offset:7616
    v_mfma_f32_16x16x32_bf16 v[148:151], v[192:195], a[164:167], v[148:151]
    ds_write_b64 v246, v[102:103] offset:8704
    v_mfma_f32_16x16x32_bf16 v[148:151], v[196:199], a[196:199], v[148:151]
    ds_write_b64 v246, v[114:115] offset:7744
    v_mfma_f32_16x16x32_bf16 v[152:155], v[192:195], a[168:171], v[152:155]
    ds_write_b64 v246, v[118:119] offset:8832
    v_mfma_f32_16x16x32_bf16 v[152:155], v[196:199], a[200:203], v[152:155]
    v_accvgpr_read_b32 v248, a224
    v_accvgpr_read_b32 v249, a225
    v_add_f32 v248, v248, v249
    v_subrev_u32 v249, s42, v248
    v_rcp_f32 v248, v248
    v_cmp_le_u32 vcc, s43, v249
    v_mfma_f32_16x16x32_bf16 v[156:159], v[192:195], a[172:175], v[156:159]
    v_mov_b32 v251, v248
    v_mov_b32_dpp v251, v248 row_ror:12 row_mask:0x2 bank_mask:0xf
    v_mov_b32_dpp v251, v248 row_ror:8 row_mask:0x4 bank_mask:0xf
    v_mov_b32_dpp v251, v248 row_ror:4 row_mask:0x8 bank_mask:0xf
    v_mfma_f32_16x16x32_bf16 v[156:159], v[196:199], a[204:207], v[156:159]
    s_or_b64 s[46:47], s[46:47], vcc
    s_nop 0
    v_mov_b32_dpp v248, v251 row_newbcast:0 row_mask:0xf bank_mask:0xf
    v_mov_b32_dpp v249, v251 row_newbcast:1 row_mask:0xf bank_mask:0xf
    v_mov_b32_dpp v250, v251 row_newbcast:2 row_mask:0xf bank_mask:0xf
    v_mov_b32_dpp v251, v251 row_newbcast:3 row_mask:0xf bank_mask:0xf
    ds_read_b64_tr_b16 v[208:209], v252 offset:7616
    ds_read_b64_tr_b16 v[210:211], v252 offset:7648
    ds_read_b64_tr_b16 v[212:213], v252 offset:8704
    ds_read_b64_tr_b16 v[214:215], v252 offset:8736
    s_waitcnt lgkmcnt(15)
    buffer_store_dwordx4 v[64:67], v255, s[16:19], s37 offen offset:0 nt
    s_nop 1
    v_pk_mul_f32 v[128:129], v[128:129], v[248:249]
    v_pk_mul_f32 v[132:133], v[132:133], v[248:249]
    v_pk_mul_f32 v[136:137], v[136:137], v[248:249]
    v_pk_mul_f32 v[140:141], v[140:141], v[248:249]
    v_pk_mul_f32 v[144:145], v[144:145], v[248:249]
    v_pk_mul_f32 v[148:149], v[148:149], v[248:249]
    v_pk_mul_f32 v[152:153], v[152:153], v[248:249]
    v_pk_mul_f32 v[156:157], v[156:157], v[248:249]
    s_waitcnt lgkmcnt(12)
    buffer_store_dwordx4 v[68:71], v255, s[16:19], s37 offen offset:2048 nt
    v_cvt_pk_bf16_f32 v128, v128, v132
    v_cvt_pk_bf16_f32 v132, v129, v133
    v_cvt_pk_bf16_f32 v129, v136, v140
    v_cvt_pk_bf16_f32 v133, v137, v141
    v_cvt_pk_bf16_f32 v144, v144, v148
    v_cvt_pk_bf16_f32 v148, v145, v149
    v_cvt_pk_bf16_f32 v145, v152, v156
    v_cvt_pk_bf16_f32 v149, v153, v157
    s_waitcnt lgkmcnt(10)
    buffer_store_dwordx4 v[200:203], v244, s[16:19], s38 offen offset:0 nt
    ds_write_b64 v246, v[128:129] offset:1088
    v_pk_mul_f32 v[130:131], v[130:131], v[250:251]
    v_pk_mul_f32 v[134:135], v[134:135], v[250:251]
    v_pk_mul_f32 v[138:139], v[138:139], v[250:251]
    v_pk_mul_f32 v[142:143], v[142:143], v[250:251]
    ds_write_b64 v246, v[144:145] offset:1216
    v_pk_mul_f32 v[146:147], v[146:147], v[250:251]
    v_pk_mul_f32 v[150:151], v[150:151], v[250:251]
    v_pk_mul_f32 v[154:155], v[154:155], v[250:251]
    v_pk_mul_f32 v[158:159], v[158:159], v[250:251]
    s_waitcnt lgkmcnt(10)
    buffer_store_dwordx4 v[204:207], v244, s[16:19], s38 offen offset:1024 nt
    ds_write_b64 v246, v[132:133] offset:2176
    v_cvt_pk_bf16_f32 v130, v130, v134
    v_cvt_pk_bf16_f32 v134, v131, v135
    v_cvt_pk_bf16_f32 v131, v138, v142
    v_cvt_pk_bf16_f32 v135, v139, v143
    ds_write_b64 v246, v[148:149] offset:2304
    v_cvt_pk_bf16_f32 v146, v146, v150
    v_cvt_pk_bf16_f32 v150, v147, v151
    v_cvt_pk_bf16_f32 v147, v154, v158
    v_cvt_pk_bf16_f32 v151, v155, v159
    ds_read_b64_tr_b16 v[216:217], v252 offset:1088
    ds_read_b64_tr_b16 v[218:219], v252 offset:1120
    ds_read_b64_tr_b16 v[220:221], v252 offset:2176
    ds_read_b64_tr_b16 v[222:223], v252 offset:2208
    s_waitcnt lgkmcnt(10)
    buffer_store_dwordx4 v[208:211], v244, s[16:19], s38 offen offset:2048 nt
    ds_write_b64 v246, v[130:131] offset:3264
    ds_write_b64 v246, v[146:147] offset:3392
    s_waitcnt lgkmcnt(10)
    buffer_store_dwordx4 v[212:215], v244, s[16:19], s38 offen offset:3072 nt
    ds_write_b64 v246, v[134:135] offset:4352
    ds_write_b64 v246, v[150:151] offset:4480
    ds_read_b64_tr_b16 v[224:225], v252 offset:3264
    ds_read_b64_tr_b16 v[226:227], v252 offset:3296
    ds_read_b64_tr_b16 v[228:229], v252 offset:4352
    ds_read_b64_tr_b16 v[230:231], v252 offset:4384
    s_waitcnt lgkmcnt(10)
    buffer_store_dwordx4 v[216:219], v244, s[16:19], s39 offen offset:0 nt
    s_waitcnt lgkmcnt(8)
    buffer_store_dwordx4 v[220:223], v244, s[16:19], s39 offen offset:1024 nt
    s_waitcnt lgkmcnt(2)
    buffer_store_dwordx4 v[224:227], v244, s[16:19], s39 offen offset:2048 nt
    s_waitcnt lgkmcnt(0)
    buffer_store_dwordx4 v[228:231], v244, s[16:19], s39 offen offset:3072 nt
L_rendr0:
    s_or_b64 s[60:61], s[44:45], s[46:47]
    s_cbranch_scc1 L_done
    s_endpgm
.fill 165, 4, 0xbf810000
L_pad1_0:
    s_branch L_ret0
L_role1:
    s_add_u32 s62, s24, 0
    s_and_b32 s62, s62, 0x3ffff
    s_add_u32 s62, s62, s25
    s_add_u32 s6, s12, s62
    s_addc_u32 s7, s13, 0
    s_add_u32 s10, s4, s32
    s_addc_u32 s11, s5, 0
    s_add_u32 s14, s4, s33
    s_addc_u32 s15, s5, 0
    s_add_u32 s62, s24, 16384
    s_and_b32 s62, s62, 0x3ffff
    s_add_u32 s62, s62, s25
    s_add_u32 s60, s8, s62
    s_addc_u32 s61, s9, 0
    s_add_u32 s62, s24, 65536
    s_and_b32 s62, s62, 0x3ffff
    s_add_u32 s62, s62, s25
    s_add_u32 s52, s8, s62
    s_addc_u32 s53, s9, 0
    s_add_u32 s54, s12, s62
    s_addc_u32 s55, s13, 0
    s_waitcnt vmcnt(8)
    ds_read_b128 v[200:203], v253 offset:0
    ds_read_b128 v[204:207], v253 offset:64
    ds_read_b128 v[208:211], v253 offset:128
    ds_read_b128 v[212:215], v253 offset:192
    s_add_u32 m0, s26, 16896
    s_waitcnt lgkmcnt(0)
    global_load_lds_dwordx4 v244, s[6:7] offset:0 nt
    v_lshlrev_b32 v248, 16, v200
    v_and_b32 v249, 0xffff0000, v200
    v_lshlrev_b32 v250, 16, v201
    v_and_b32 v251, 0xffff0000, v201
    v_pk_mul_f32 v[248:249], v[248:249], s[40:41]
    v_pk_mul_f32 v[250:251], v[250:251], s[40:41]
    v_cvt_pk_bf16_f32 v200, v248, v249
    v_cvt_pk_bf16_f32 v201, v250, v251
    v_accvgpr_write_b32 a0, v200
    v_accvgpr_write_b32 a1, v201
    v_lshlrev_b32 v248, 16, v202
    v_and_b32 v249, 0xffff0000, v202
    v_lshlrev_b32 v250, 16, v203
    v_and_b32 v251, 0xffff0000, v203
    v_pk_mul_f32 v[248:249], v[248:249], s[40:41]
    v_pk_mul_f32 v[250:251], v[250:251], s[40:41]
    v_cvt_pk_bf16_f32 v202, v248, v249
    v_cvt_pk_bf16_f32 v203, v250, v251
    v_accvgpr_write_b32 a2, v202
    v_accvgpr_write_b32 a3, v203
    s_add_u32 m0, s26, 16912
    s_nop 0
    global_load_lds_dwordx4 v244, s[6:7] offset:1024 nt
    v_lshlrev_b32 v248, 16, v204
    v_and_b32 v249, 0xffff0000, v204
    v_lshlrev_b32 v250, 16, v205
    v_and_b32 v251, 0xffff0000, v205
    v_pk_mul_f32 v[248:249], v[248:249], s[40:41]
    v_pk_mul_f32 v[250:251], v[250:251], s[40:41]
    v_cvt_pk_bf16_f32 v204, v248, v249
    v_cvt_pk_bf16_f32 v205, v250, v251
    v_accvgpr_write_b32 a4, v204
    v_accvgpr_write_b32 a5, v205
    v_lshlrev_b32 v248, 16, v206
    v_and_b32 v249, 0xffff0000, v206
    v_lshlrev_b32 v250, 16, v207
    v_and_b32 v251, 0xffff0000, v207
    v_pk_mul_f32 v[248:249], v[248:249], s[40:41]
    v_pk_mul_f32 v[250:251], v[250:251], s[40:41]
    v_cvt_pk_bf16_f32 v206, v248, v249
    v_cvt_pk_bf16_f32 v207, v250, v251
    v_accvgpr_write_b32 a6, v206
    v_accvgpr_write_b32 a7, v207
    s_add_u32 m0, s26, 16928
    s_nop 0
    global_load_lds_dwordx4 v244, s[6:7] offset:2048 nt
    v_lshlrev_b32 v248, 16, v208
    v_and_b32 v249, 0xffff0000, v208
    v_lshlrev_b32 v250, 16, v209
    v_and_b32 v251, 0xffff0000, v209
    v_pk_mul_f32 v[248:249], v[248:249], s[40:41]
    v_pk_mul_f32 v[250:251], v[250:251], s[40:41]
    v_cvt_pk_bf16_f32 v208, v248, v249
    v_cvt_pk_bf16_f32 v209, v250, v251
    v_accvgpr_write_b32 a8, v208
    v_accvgpr_write_b32 a9, v209
    v_lshlrev_b32 v248, 16, v210
    v_and_b32 v249, 0xffff0000, v210
    v_lshlrev_b32 v250, 16, v211
    v_and_b32 v251, 0xffff0000, v211
    v_pk_mul_f32 v[248:249], v[248:249], s[40:41]
    v_pk_mul_f32 v[250:251], v[250:251], s[40:41]
    v_cvt_pk_bf16_f32 v210, v248, v249
    v_cvt_pk_bf16_f32 v211, v250, v251
    v_accvgpr_write_b32 a10, v210
    v_accvgpr_write_b32 a11, v211
    s_add_u32 m0, s26, 16944
    s_nop 0
    global_load_lds_dwordx4 v244, s[6:7] offset:3072 nt
    v_lshlrev_b32 v248, 16, v212
    v_and_b32 v249, 0xffff0000, v212
    v_lshlrev_b32 v250, 16, v213
    v_and_b32 v251, 0xffff0000, v213
    v_pk_mul_f32 v[248:249], v[248:249], s[40:41]
    v_pk_mul_f32 v[250:251], v[250:251], s[40:41]
    v_cvt_pk_bf16_f32 v212, v248, v249
    v_cvt_pk_bf16_f32 v213, v250, v251
    v_accvgpr_write_b32 a12, v212
    v_accvgpr_write_b32 a13, v213
    v_lshlrev_b32 v248, 16, v214
    v_and_b32 v249, 0xffff0000, v214
    v_lshlrev_b32 v250, 16, v215
    v_and_b32 v251, 0xffff0000, v215
    v_pk_mul_f32 v[248:249], v[248:249], s[40:41]
    v_pk_mul_f32 v[250:251], v[250:251], s[40:41]
    v_cvt_pk_bf16_f32 v214, v248, v249
    v_cvt_pk_bf16_f32 v215, v250, v251
    v_accvgpr_write_b32 a14, v214
    v_accvgpr_write_b32 a15, v215
    s_waitcnt vmcnt(8)
    s_barrier
    ds_read_b128 a[80:83], v240 offset:0
    ds_read_b128 a[84:87], v240 offset:64
    ds_read_b128 a[88:91], v240 offset:128
    ds_read_b128 a[92:95], v240 offset:192
    ds_read_b128 a[96:99], v240 offset:704
    ds_read_b128 a[100:103], v240 offset:640
    ds_read_b128 a[104:107], v240 offset:576
    ds_read_b128 a[108:111], v240 offset:512
    ds_read_b128 a[112:115], v241 offset:0
    ds_read_b128 a[116:119], v241 offset:64
    ds_read_b128 a[120:123], v241 offset:128
    ds_read_b128 a[124:127], v241 offset:192
    ds_read_b128 a[128:131], v241 offset:704
    ds_read_b128 a[132:135], v241 offset:640
    ds_read_b128 a[136:139], v241 offset:576
    ds_read_b128 a[140:143], v241 offset:512
    s_waitcnt lgkmcnt(12)
    v_mfma_f32_16x16x32_bf16 v[160:163], a[80:83], a[0:3], -4.0
    s_add_u32 m0, s28, 1088
    v_mfma_f32_16x16x32_bf16 v[160:163], a[84:87], a[4:7], v[160:163]
    global_load_lds_dwordx4 v244, s[10:11] offset:0 nt
    v_mfma_f32_16x16x32_bf16 v[160:163], a[88:91], a[8:11], v[160:163]
    v_mfma_f32_16x16x32_bf16 v[160:163], a[92:95], a[12:15], v[160:163]
    s_waitcnt lgkmcnt(8)
    v_mfma_f32_16x16x32_bf16 v[164:167], a[96:99], a[12:15], -4.0
    s_add_u32 m0, s28, 1152
    v_mfma_f32_16x16x32_bf16 v[164:167], a[100:103], a[8:11], v[164:167]
    global_load_lds_dwordx4 v244, s[10:11] offset:1024 nt
    v_mfma_f32_16x16x32_bf16 v[164:167], a[104:107], a[4:7], v[164:167]
    v_mfma_f32_16x16x32_bf16 v[164:167], a[108:111], a[0:3], v[164:167]
    s_waitcnt lgkmcnt(4)
    v_mfma_f32_16x16x32_bf16 v[168:171], a[112:115], a[0:3], -4.0
    s_add_u32 m0, s28, 1216
    v_mfma_f32_16x16x32_bf16 v[168:171], a[116:119], a[4:7], v[168:171]
    global_load_lds_dwordx4 v244, s[10:11] offset:2048 nt
    v_mfma_f32_16x16x32_bf16 v[168:171], a[120:123], a[8:11], v[168:171]
    v_mfma_f32_16x16x32_bf16 v[168:171], a[124:127], a[12:15], v[168:171]
    s_waitcnt lgkmcnt(0)
    v_mfma_f32_16x16x32_bf16 v[172:175], a[128:131], a[12:15], -4.0
    s_add_u32 m0, s28, 1280
    v_mfma_f32_16x16x32_bf16 v[172:175], a[132:135], a[8:11], v[172:175]
    global_load_lds_dwordx4 v244, s[10:11] offset:3072 nt
    v_mfma_f32_16x16x32_bf16 v[172:175], a[136:139], a[4:7], v[172:175]
    v_mfma_f32_16x16x32_bf16 v[172:175], a[140:143], a[0:3], v[172:175]
    s_nop 3
    v_exp_f32 v160, v160
    v_exp_f32 v161, v161
    v_exp_f32 v162, v162
    v_exp_f32 v163, v163
    s_nop 0
    v_cvt_pk_bf16_f32 v176, v160, v161
    v_cvt_pk_bf16_f32 v177, v162, v163
    v_exp_f32 v164, v164
    v_exp_f32 v165, v165
    v_exp_f32 v166, v166
    v_exp_f32 v167, v167
    s_nop 0
    v_cvt_pk_bf16_f32 v178, v164, v165
    v_cvt_pk_bf16_f32 v179, v166, v167
    v_exp_f32 v168, v168
    v_exp_f32 v169, v169
    v_exp_f32 v170, v170
    v_exp_f32 v171, v171
    v_exp_f32 v172, v172
    v_exp_f32 v173, v173
    v_exp_f32 v174, v174
    v_exp_f32 v175, v175
    s_waitcnt vmcnt(8)
    ds_read_b128 v[200:203], v253 offset:16896
    ds_read_b128 v[204:207], v253 offset:16960
    ds_read_b128 v[208:211], v253 offset:17024
    ds_read_b128 v[212:215], v253 offset:17088
    s_add_u32 m0, s28, 5440
    s_waitcnt lgkmcnt(0)
    global_load_lds_dwordx4 v244, s[14:15] offset:0 nt
    v_lshlrev_b32 v248, 16, v200
    v_and_b32 v249, 0xffff0000, v200
    v_lshlrev_b32 v250, 16, v201
    v_and_b32 v251, 0xffff0000, v201
    v_pk_mul_f32 v[248:249], v[248:249], s[40:41]
    v_pk_mul_f32 v[250:251], v[250:251], s[40:41]
    v_cvt_pk_bf16_f32 v200, v248, v249
    v_cvt_pk_bf16_f32 v201, v250, v251
    v_accvgpr_write_b32 a16, v200
    v_accvgpr_write_b32 a17, v201
    v_lshlrev_b32 v248, 16, v202
    v_and_b32 v249, 0xffff0000, v202
    v_lshlrev_b32 v250, 16, v203
    v_and_b32 v251, 0xffff0000, v203
    v_pk_mul_f32 v[248:249], v[248:249], s[40:41]
    v_pk_mul_f32 v[250:251], v[250:251], s[40:41]
    v_cvt_pk_bf16_f32 v202, v248, v249
    v_cvt_pk_bf16_f32 v203, v250, v251
    v_accvgpr_write_b32 a18, v202
    v_accvgpr_write_b32 a19, v203
    s_add_u32 m0, s28, 5504
    s_nop 0
    global_load_lds_dwordx4 v244, s[14:15] offset:1024 nt
    v_lshlrev_b32 v248, 16, v204
    v_and_b32 v249, 0xffff0000, v204
    v_lshlrev_b32 v250, 16, v205
    v_and_b32 v251, 0xffff0000, v205
    v_pk_mul_f32 v[248:249], v[248:249], s[40:41]
    v_pk_mul_f32 v[250:251], v[250:251], s[40:41]
    v_cvt_pk_bf16_f32 v204, v248, v249
    v_cvt_pk_bf16_f32 v205, v250, v251
    v_accvgpr_write_b32 a20, v204
    v_accvgpr_write_b32 a21, v205
    v_lshlrev_b32 v248, 16, v206
    v_and_b32 v249, 0xffff0000, v206
    v_lshlrev_b32 v250, 16, v207
    v_and_b32 v251, 0xffff0000, v207
    v_pk_mul_f32 v[248:249], v[248:249], s[40:41]
    v_pk_mul_f32 v[250:251], v[250:251], s[40:41]
    v_cvt_pk_bf16_f32 v206, v248, v249
    v_cvt_pk_bf16_f32 v207, v250, v251
    v_accvgpr_write_b32 a22, v206
    v_accvgpr_write_b32 a23, v207
    s_add_u32 m0, s28, 5568
    s_nop 0
    global_load_lds_dwordx4 v244, s[14:15] offset:2048 nt
    v_lshlrev_b32 v248, 16, v208
    v_and_b32 v249, 0xffff0000, v208
    v_lshlrev_b32 v250, 16, v209
    v_and_b32 v251, 0xffff0000, v209
    v_pk_mul_f32 v[248:249], v[248:249], s[40:41]
    v_pk_mul_f32 v[250:251], v[250:251], s[40:41]
    v_cvt_pk_bf16_f32 v208, v248, v249
    v_cvt_pk_bf16_f32 v209, v250, v251
    v_accvgpr_write_b32 a24, v208
    v_accvgpr_write_b32 a25, v209
    v_lshlrev_b32 v248, 16, v210
    v_and_b32 v249, 0xffff0000, v210
    v_lshlrev_b32 v250, 16, v211
    v_and_b32 v251, 0xffff0000, v211
    v_pk_mul_f32 v[248:249], v[248:249], s[40:41]
    v_pk_mul_f32 v[250:251], v[250:251], s[40:41]
    v_cvt_pk_bf16_f32 v210, v248, v249
    v_cvt_pk_bf16_f32 v211, v250, v251
    v_accvgpr_write_b32 a26, v210
    v_accvgpr_write_b32 a27, v211
    s_add_u32 m0, s28, 5632
    s_nop 0
    global_load_lds_dwordx4 v244, s[14:15] offset:3072 nt
    v_lshlrev_b32 v248, 16, v212
    v_and_b32 v249, 0xffff0000, v212
    v_lshlrev_b32 v250, 16, v213
    v_and_b32 v251, 0xffff0000, v213
    v_pk_mul_f32 v[248:249], v[248:249], s[40:41]
    v_pk_mul_f32 v[250:251], v[250:251], s[40:41]
    v_cvt_pk_bf16_f32 v212, v248, v249
    v_cvt_pk_bf16_f32 v213, v250, v251
    v_accvgpr_write_b32 a28, v212
    v_accvgpr_write_b32 a29, v213
    v_lshlrev_b32 v248, 16, v214
    v_and_b32 v249, 0xffff0000, v214
    v_lshlrev_b32 v250, 16, v215
    v_and_b32 v251, 0xffff0000, v215
    v_pk_mul_f32 v[248:249], v[248:249], s[40:41]
    v_pk_mul_f32 v[250:251], v[250:251], s[40:41]
    v_cvt_pk_bf16_f32 v214, v248, v249
    v_cvt_pk_bf16_f32 v215, v250, v251
    v_accvgpr_write_b32 a30, v214
    v_accvgpr_write_b32 a31, v215
    s_add_u32 s6, s4, s34
    s_addc_u32 s7, s5, 0
    s_add_u32 s62, s24, 16384
    s_and_b32 s62, s62, 0x3ffff
    s_add_u32 s62, s62, s25
    s_add_u32 s10, s12, s62
    s_addc_u32 s11, s13, 0
    s_add_u32 s62, s24, 32768
    s_and_b32 s62, s62, 0x3ffff
    s_add_u32 s62, s62, s25
    s_add_u32 s14, s8, s62
    s_addc_u32 s15, s9, 0
    s_waitcnt vmcnt(8)
    s_barrier
    ds_read_b64_tr_b16 a[144:145], v242 offset:0
    ds_read_b64_tr_b16 a[146:147], v242 offset:512
    ds_read_b64_tr_b16 a[176:177], v243 offset:0
    ds_read_b64_tr_b16 a[178:179], v243 offset:512
    ds_read_b64_tr_b16 a[148:149], v242 offset:16
    ds_read_b64_tr_b16 a[150:151], v242 offset:528
    ds_read_b64_tr_b16 a[180:181], v243 offset:16
    ds_read_b64_tr_b16 a[182:183], v243 offset:528
    ds_read_b64_tr_b16 a[152:153], v242 offset:32
    ds_read_b64_tr_b16 a[154:155], v242 offset:544
    ds_read_b64_tr_b16 a[184:185], v243 offset:32
    ds_read_b64_tr_b16 a[186:187], v243 offset:544
    ds_read_b64_tr_b16 a[156:157], v242 offset:48
    ds_read_b64_tr_b16 a[158:159], v242 offset:560
    ds_read_b64_tr_b16 a[188:189], v243 offset:48
    ds_read_b64_tr_b16 a[190:191], v243 offset:560
    v_mfma_f32_16x16x32_bf16 v[160:163], a[80:83], a[16:19], -4.0
    s_add_u32 m0, s26, 33792
    ds_read_b64_tr_b16 a[160:161], v242 offset:128
    ds_read_b64_tr_b16 a[162:163], v242 offset:640
    v_mfma_f32_16x16x32_bf16 v[160:163], a[84:87], a[20:23], v[160:163]
    global_load_lds_dwordx4 v244, s[60:61] offset:0 nt
    v_cvt_pk_bf16_f32 v180, v168, v169
    v_cvt_pk_bf16_f32 v181, v170, v171
    v_mfma_f32_16x16x32_bf16 v[160:163], a[88:91], a[24:27], v[160:163]
    ds_read_b64_tr_b16 a[192:193], v243 offset:128
    ds_read_b64_tr_b16 a[194:195], v243 offset:640
    v_mfma_f32_16x16x32_bf16 v[160:163], a[92:95], a[28:31], v[160:163]
    s_add_u32 m0, s26, 33824
    v_cvt_pk_bf16_f32 v182, v172, v173
    v_cvt_pk_bf16_f32 v183, v174, v175
    v_mfma_f32_16x16x32_bf16 v[164:167], a[96:99], a[28:31], -4.0
    ds_read_b64_tr_b16 a[164:165], v242 offset:144
    ds_read_b64_tr_b16 a[166:167], v242 offset:656
    v_mfma_f32_16x16x32_bf16 v[164:167], a[100:103], a[24:27], v[164:167]
    global_load_lds_dwordx4 v244, s[60:61] offset:1024 nt
    v_mfma_f32_16x16x32_bf16 v[164:167], a[104:107], a[20:23], v[164:167]
    ds_read_b64_tr_b16 a[196:197], v243 offset:144
    ds_read_b64_tr_b16 a[198:199], v243 offset:656
    v_mfma_f32_16x16x32_bf16 v[164:167], a[108:111], a[16:19], v[164:167]
    s_add_u32 m0, s26, 33856
    v_exp_f32 v160, v160
    v_mfma_f32_16x16x32_bf16 v[168:171], a[112:115], a[16:19], -4.0
    ds_read_b64_tr_b16 a[168:169], v242 offset:160
    ds_read_b64_tr_b16 a[170:171], v242 offset:672
    global_load_lds_dwordx4 v244, s[60:61] offset:2048 nt
    v_mfma_f32_16x16x32_bf16 v[168:171], a[116:119], a[20:23], v[168:171]
    v_exp_f32 v161, v161
    v_mfma_f32_16x16x32_bf16 v[168:171], a[120:123], a[24:27], v[168:171]
    s_add_u32 m0, s26, 33888
    ds_read_b64_tr_b16 a[200:201], v243 offset:160
    ds_read_b64_tr_b16 a[202:203], v243 offset:672
    v_mfma_f32_16x16x32_bf16 v[168:171], a[124:127], a[28:31], v[168:171]
    global_load_lds_dwordx4 v244, s[60:61] offset:3072 nt
    v_exp_f32 v162, v162
    v_mfma_f32_16x16x32_bf16 v[172:175], a[128:131], a[28:31], -4.0
    ds_read_b64_tr_b16 a[172:173], v242 offset:176
    ds_read_b64_tr_b16 a[174:175], v242 offset:688
    v_mfma_f32_16x16x32_bf16 v[172:175], a[132:135], a[24:27], v[172:175]
    v_exp_f32 v163, v163
    v_mfma_f32_16x16x32_bf16 v[172:175], a[136:139], a[20:23], v[172:175]
    ds_read_b64_tr_b16 a[204:205], v243 offset:176
    ds_read_b64_tr_b16 a[206:207], v243 offset:688
    v_mfma_f32_16x16x32_bf16 v[172:175], a[140:143], a[16:19], v[172:175]
    s_waitcnt lgkmcnt(8)
    v_cvt_pk_bf16_f32 v184, v160, v161
    v_cvt_pk_bf16_f32 v185, v162, v163
    v_mfma_f32_16x16x32_bf16 v[0:3], v[176:179], a[144:147], 0
    v_exp_f32 v164, v164
    v_mfma_f32_16x16x32_bf16 v[0:3], v[180:183], a[176:179], v[0:3]
    v_exp_f32 v165, v165
    v_mfma_f32_16x16x32_bf16 v[4:7], v[176:179], a[148:151], 0
    v_exp_f32 v166, v166
    v_mfma_f32_16x16x32_bf16 v[4:7], v[180:183], a[180:183], v[4:7]
    v_exp_f32 v167, v167
    v_mfma_f32_16x16x32_bf16 v[8:11], v[176:179], a[152:155], 0
    v_cvt_pk_bf16_f32 v186, v164, v165
    v_cvt_pk_bf16_f32 v187, v166, v167
    v_mfma_f32_16x16x32_bf16 v[8:11], v[180:183], a[184:187], v[8:11]
    v_exp_f32 v168, v168
    v_mfma_f32_16x16x32_bf16 v[12:15], v[176:179], a[156:159], 0
    v_exp_f32 v172, v172
    v_mfma_f32_16x16x32_bf16 v[12:15], v[180:183], a[188:191], v[12:15]
    v_exp_f32 v169, v169
    v_mfma_f32_16x16x32_bf16 v[16:19], v[176:179], a[160:163], 0
    v_exp_f32 v173, v173
    v_mfma_f32_16x16x32_bf16 v[16:19], v[180:183], a[192:195], v[16:19]
    v_exp_f32 v170, v170
    v_mfma_f32_16x16x32_bf16 v[20:23], v[176:179], a[164:167], 0
    v_exp_f32 v174, v174
    v_mfma_f32_16x16x32_bf16 v[20:23], v[180:183], a[196:199], v[20:23]
    s_waitcnt lgkmcnt(0)
    v_exp_f32 v171, v171
    v_mfma_f32_16x16x32_bf16 v[24:27], v[176:179], a[168:171], 0
    v_exp_f32 v175, v175
    v_mfma_f32_16x16x32_bf16 v[24:27], v[180:183], a[200:203], v[24:27]
    v_cvt_pk_bf16_f32 v188, v168, v169
    v_cvt_pk_bf16_f32 v189, v170, v171
    v_mfma_f32_16x16x32_bf16 v[28:31], v[176:179], a[172:175], 0
    v_cvt_pk_bf16_f32 v190, v172, v173
    v_cvt_pk_bf16_f32 v191, v174, v175
    v_mfma_f32_16x16x32_bf16 v[28:31], v[180:183], a[204:207], v[28:31]
    v_smfmac_f32_16x16x64_bf16 a[208:211], a[228:231], v[176:183], v247
    s_add_u32 s62, s24, 32768
    s_and_b32 s62, s62, 0x3ffff
    s_add_u32 s62, s62, s25
    s_add_u32 s60, s12, s62
    s_addc_u32 s61, s13, 0
    s_waitcnt vmcnt(8)
    ds_read_b128 v[200:203], v245 offset:1088
    ds_read_b128 v[204:207], v245 offset:1152
    ds_read_b128 v[208:211], v245 offset:1216
    ds_read_b128 v[212:215], v245 offset:1280
    s_add_u32 m0, s28, 9792
    s_waitcnt lgkmcnt(0)
    global_load_lds_dwordx4 v244, s[6:7] offset:0 nt
    v_lshlrev_b32 v248, 16, v200
    v_and_b32 v249, 0xffff0000, v200
    v_lshlrev_b32 v250, 16, v201
    v_and_b32 v251, 0xffff0000, v201
    v_pk_mul_f32 v[248:249], v[248:249], s[40:41]
    v_pk_mul_f32 v[250:251], v[250:251], s[40:41]
    v_cvt_pk_bf16_f32 v200, v248, v249
    v_cvt_pk_bf16_f32 v201, v250, v251
    v_accvgpr_write_b32 a32, v200
    v_accvgpr_write_b32 a33, v201
    v_lshlrev_b32 v248, 16, v202
    v_and_b32 v249, 0xffff0000, v202
    v_lshlrev_b32 v250, 16, v203
    v_and_b32 v251, 0xffff0000, v203
    v_pk_mul_f32 v[248:249], v[248:249], s[40:41]
    v_pk_mul_f32 v[250:251], v[250:251], s[40:41]
    v_cvt_pk_bf16_f32 v202, v248, v249
    v_cvt_pk_bf16_f32 v203, v250, v251
    v_accvgpr_write_b32 a34, v202
    v_accvgpr_write_b32 a35, v203
    s_add_u32 m0, s28, 9856
    s_nop 0
    global_load_lds_dwordx4 v244, s[6:7] offset:1024 nt
    v_lshlrev_b32 v248, 16, v204
    v_and_b32 v249, 0xffff0000, v204
    v_lshlrev_b32 v250, 16, v205
    v_and_b32 v251, 0xffff0000, v205
    v_pk_mul_f32 v[248:249], v[248:249], s[40:41]
    v_pk_mul_f32 v[250:251], v[250:251], s[40:41]
    v_cvt_pk_bf16_f32 v204, v248, v249
    v_cvt_pk_bf16_f32 v205, v250, v251
    v_accvgpr_write_b32 a36, v204
    v_accvgpr_write_b32 a37, v205
    v_lshlrev_b32 v248, 16, v206
    v_and_b32 v249, 0xffff0000, v206
    v_lshlrev_b32 v250, 16, v207
    v_and_b32 v251, 0xffff0000, v207
    v_pk_mul_f32 v[248:249], v[248:249], s[40:41]
    v_pk_mul_f32 v[250:251], v[250:251], s[40:41]
    v_cvt_pk_bf16_f32 v206, v248, v249
    v_cvt_pk_bf16_f32 v207, v250, v251
    v_accvgpr_write_b32 a38, v206
    v_accvgpr_write_b32 a39, v207
    s_add_u32 m0, s28, 9920
    s_nop 0
    global_load_lds_dwordx4 v244, s[6:7] offset:2048 nt
    v_lshlrev_b32 v248, 16, v208
    v_and_b32 v249, 0xffff0000, v208
    v_lshlrev_b32 v250, 16, v209
    v_and_b32 v251, 0xffff0000, v209
    v_pk_mul_f32 v[248:249], v[248:249], s[40:41]
    v_pk_mul_f32 v[250:251], v[250:251], s[40:41]
    v_cvt_pk_bf16_f32 v208, v248, v249
    v_cvt_pk_bf16_f32 v209, v250, v251
    v_accvgpr_write_b32 a40, v208
    v_accvgpr_write_b32 a41, v209
    v_lshlrev_b32 v248, 16, v210
    v_and_b32 v249, 0xffff0000, v210
    v_lshlrev_b32 v250, 16, v211
    v_and_b32 v251, 0xffff0000, v211
    v_pk_mul_f32 v[248:249], v[248:249], s[40:41]
    v_pk_mul_f32 v[250:251], v[250:251], s[40:41]
    v_cvt_pk_bf16_f32 v210, v248, v249
    v_cvt_pk_bf16_f32 v211, v250, v251
    v_accvgpr_write_b32 a42, v210
    v_accvgpr_write_b32 a43, v211
    s_add_u32 m0, s28, 9984
    s_nop 0
    global_load_lds_dwordx4 v244, s[6:7] offset:3072 nt
    v_lshlrev_b32 v248, 16, v212
    v_and_b32 v249, 0xffff0000, v212
    v_lshlrev_b32 v250, 16, v213
    v_and_b32 v251, 0xffff0000, v213
    v_pk_mul_f32 v[248:249], v[248:249], s[40:41]
    v_pk_mul_f32 v[250:251], v[250:251], s[40:41]
    v_cvt_pk_bf16_f32 v212, v248, v249
    v_cvt_pk_bf16_f32 v213, v250, v251
    v_accvgpr_write_b32 a44, v212
    v_accvgpr_write_b32 a45, v213
    v_lshlrev_b32 v248, 16, v214
    v_and_b32 v249, 0xffff0000, v214
    v_lshlrev_b32 v250, 16, v215
    v_and_b32 v251, 0xffff0000, v215
    v_pk_mul_f32 v[248:249], v[248:249], s[40:41]
    v_pk_mul_f32 v[250:251], v[250:251], s[40:41]
    v_cvt_pk_bf16_f32 v214, v248, v249
    v_cvt_pk_bf16_f32 v215, v250, v251
    v_accvgpr_write_b32 a46, v214
    v_accvgpr_write_b32 a47, v215
    s_nop 0
    v_mfma_f32_16x16x32_bf16 v[160:163], a[80:83], a[32:35], -4.0
    v_add_u32 v240, s27, v240
    v_mfma_f32_16x16x32_bf16 v[160:163], a[84:87], a[36:39], v[160:163]
    v_mfma_f32_16x16x32_bf16 v[160:163], a[88:91], a[40:43], v[160:163]
    v_add_u32 v241, s27, v241
    v_mfma_f32_16x16x32_bf16 v[160:163], a[92:95], a[44:47], v[160:163]
    v_mfma_f32_16x16x32_bf16 v[164:167], a[96:99], a[44:47], -4.0
    v_add_u32 v242, s27, v242
    v_mfma_f32_16x16x32_bf16 v[164:167], a[100:103], a[40:43], v[164:167]
    v_mfma_f32_16x16x32_bf16 v[164:167], a[104:107], a[36:39], v[164:167]
    v_exp_f32 v160, v160
    v_mfma_f32_16x16x32_bf16 v[164:167], a[108:111], a[32:35], v[164:167]
    v_exp_f32 v161, v161
    v_mfma_f32_16x16x32_bf16 v[32:35], v[184:187], a[144:147], 0
    v_exp_f32 v162, v162
    v_mfma_f32_16x16x32_bf16 v[32:35], v[188:191], a[176:179], v[32:35]
    v_exp_f32 v163, v163
    v_mfma_f32_16x16x32_bf16 v[36:39], v[184:187], a[148:151], 0
    v_cvt_pk_bf16_f32 v176, v160, v161
    v_cvt_pk_bf16_f32 v177, v162, v163
    v_mfma_f32_16x16x32_bf16 v[36:39], v[188:191], a[180:183], v[36:39]
    v_exp_f32 v164, v164
    v_mfma_f32_16x16x32_bf16 v[40:43], v[184:187], a[152:155], 0
    v_exp_f32 v165, v165
    v_mfma_f32_16x16x32_bf16 v[40:43], v[188:191], a[184:187], v[40:43]
    v_exp_f32 v166, v166
    v_mfma_f32_16x16x32_bf16 v[44:47], v[184:187], a[156:159], 0
    v_exp_f32 v167, v167
    v_mfma_f32_16x16x32_bf16 v[44:47], v[188:191], a[188:191], v[44:47]
    v_cvt_pk_bf16_f32 v178, v164, v165
    v_cvt_pk_bf16_f32 v179, v166, v167
    v_mfma_f32_16x16x32_bf16 v[48:51], v[184:187], a[160:163], 0
    v_add_u32 v243, s27, v243
    v_mfma_f32_16x16x32_bf16 v[48:51], v[188:191], a[192:195], v[48:51]
    v_mfma_f32_16x16x32_bf16 v[52:55], v[184:187], a[164:167], 0
    v_mfma_f32_16x16x32_bf16 v[52:55], v[188:191], a[196:199], v[52:55]
    v_mfma_f32_16x16x32_bf16 v[56:59], v[184:187], a[168:171], 0
    v_mfma_f32_16x16x32_bf16 v[56:59], v[188:191], a[200:203], v[56:59]
    v_lshrrev_b32 v254, 2, v244
    v_add_u32 v254, s28, v254
    v_mfma_f32_16x16x32_bf16 v[60:63], v[184:187], a[172:175], 0
    v_mfma_f32_16x16x32_bf16 v[60:63], v[188:191], a[204:207], v[60:63]
    v_smfmac_f32_16x16x64_bf16 a[212:215], a[228:231], v[184:191], v247
    s_add_u32 s62, s24, 49152
    s_and_b32 s62, s62, 0x3ffff
    s_add_u32 s62, s62, s25
    s_add_u32 s6, s8, s62
    s_addc_u32 s7, s9, 0
    s_waitcnt vmcnt(8)
    ds_read_b128 v[200:203], v245 offset:5440
    ds_read_b128 v[204:207], v245 offset:5504
    ds_read_b128 v[208:211], v245 offset:5568
    ds_read_b128 v[212:215], v245 offset:5632
    s_add_u32 m0, s26, 50688
    s_waitcnt lgkmcnt(0)
    global_load_lds_dwordx4 v244, s[10:11] offset:0 nt
    v_lshlrev_b32 v248, 16, v200
    v_and_b32 v249, 0xffff0000, v200
    v_lshlrev_b32 v250, 16, v201
    v_and_b32 v251, 0xffff0000, v201
    v_pk_mul_f32 v[248:249], v[248:249], s[40:41]
    v_pk_mul_f32 v[250:251], v[250:251], s[40:41]
    v_cvt_pk_bf16_f32 v200, v248, v249
    v_cvt_pk_bf16_f32 v201, v250, v251
    v_accvgpr_write_b32 a48, v200
    v_accvgpr_write_b32 a49, v201
    v_lshlrev_b32 v248, 16, v202
    v_and_b32 v249, 0xffff0000, v202
    v_lshlrev_b32 v250, 16, v203
    v_and_b32 v251, 0xffff0000, v203
    v_pk_mul_f32 v[248:249], v[248:249], s[40:41]
    v_pk_mul_f32 v[250:251], v[250:251], s[40:41]
    v_cvt_pk_bf16_f32 v202, v248, v249
    v_cvt_pk_bf16_f32 v203, v250, v251
    v_accvgpr_write_b32 a50, v202
    v_accvgpr_write_b32 a51, v203
    s_add_u32 m0, s26, 50704
    s_nop 0
    global_load_lds_dwordx4 v244, s[10:11] offset:1024 nt
    v_lshlrev_b32 v248, 16, v204
    v_and_b32 v249, 0xffff0000, v204
    v_lshlrev_b32 v250, 16, v205
    v_and_b32 v251, 0xffff0000, v205
    v_pk_mul_f32 v[248:249], v[248:249], s[40:41]
    v_pk_mul_f32 v[250:251], v[250:251], s[40:41]
    v_cvt_pk_bf16_f32 v204, v248, v249
    v_cvt_pk_bf16_f32 v205, v250, v251
    v_accvgpr_write_b32 a52, v204
    v_accvgpr_write_b32 a53, v205
L_pad1_1:
    s_cbranch_execz L_ret0
    v_lshlrev_b32 v248, 16, v206
    v_and_b32 v249, 0xffff0000, v206
    v_lshlrev_b32 v250, 16, v207
    v_and_b32 v251, 0xffff0000, v207
    v_pk_mul_f32 v[248:249], v[248:249], s[40:41]
    v_pk_mul_f32 v[250:251], v[250:251], s[40:41]
    v_cvt_pk_bf16_f32 v206, v248, v249
    v_cvt_pk_bf16_f32 v207, v250, v251
    v_accvgpr_write_b32 a54, v206
    v_accvgpr_write_b32 a55, v207
    s_add_u32 m0, s26, 50720
    s_nop 0
    global_load_lds_dwordx4 v244, s[10:11] offset:2048 nt
    v_lshlrev_b32 v248, 16, v208
    v_and_b32 v249, 0xffff0000, v208
    v_lshlrev_b32 v250, 16, v209
    v_and_b32 v251, 0xffff0000, v209
    v_pk_mul_f32 v[248:249], v[248:249], s[40:41]
    v_pk_mul_f32 v[250:251], v[250:251], s[40:41]
    v_cvt_pk_bf16_f32 v208, v248, v249
    v_cvt_pk_bf16_f32 v209, v250, v251
    v_accvgpr_write_b32 a56, v208
    v_accvgpr_write_b32 a57, v209
    v_lshlrev_b32 v248, 16, v210
    v_and_b32 v249, 0xffff0000, v210
    v_lshlrev_b32 v250, 16, v211
    v_and_b32 v251, 0xffff0000, v211
    v_pk_mul_f32 v[248:249], v[248:249], s[40:41]
    v_pk_mul_f32 v[250:251], v[250:251], s[40:41]
    v_cvt_pk_bf16_f32 v210, v248, v249
    v_cvt_pk_bf16_f32 v211, v250, v251
    v_accvgpr_write_b32 a58, v210
    v_accvgpr_write_b32 a59, v211
    s_add_u32 m0, s26, 50736
    s_nop 0
    global_load_lds_dwordx4 v244, s[10:11] offset:3072 nt
    v_lshlrev_b32 v248, 16, v212
    v_and_b32 v249, 0xffff0000, v212
    v_lshlrev_b32 v250, 16, v213
    v_and_b32 v251, 0xffff0000, v213
    v_pk_mul_f32 v[248:249], v[248:249], s[40:41]
    v_pk_mul_f32 v[250:251], v[250:251], s[40:41]
    v_cvt_pk_bf16_f32 v212, v248, v249
    v_cvt_pk_bf16_f32 v213, v250, v251
    v_accvgpr_write_b32 a60, v212
    v_accvgpr_write_b32 a61, v213
    v_lshlrev_b32 v248, 16, v214
    v_and_b32 v249, 0xffff0000, v214
    v_lshlrev_b32 v250, 16, v215
    v_and_b32 v251, 0xffff0000, v215
    v_pk_mul_f32 v[248:249], v[248:249], s[40:41]
    v_pk_mul_f32 v[250:251], v[250:251], s[40:41]
    v_cvt_pk_bf16_f32 v214, v248, v249
    v_cvt_pk_bf16_f32 v215, v250, v251
    v_accvgpr_write_b32 a62, v214
    v_accvgpr_write_b32 a63, v215
    s_nop 0
    v_mfma_f32_16x16x32_bf16 v[160:163], a[80:83], a[48:51], -4.0
    v_mfma_f32_16x16x32_bf16 v[160:163], a[84:87], a[52:55], v[160:163]
    v_mfma_f32_16x16x32_bf16 v[160:163], a[88:91], a[56:59], v[160:163]
    v_mfma_f32_16x16x32_bf16 v[160:163], a[92:95], a[60:63], v[160:163]
    v_mfma_f32_16x16x32_bf16 v[164:167], a[96:99], a[60:63], -4.0
    v_mfma_f32_16x16x32_bf16 v[164:167], a[100:103], a[56:59], v[164:167]
    v_mfma_f32_16x16x32_bf16 v[164:167], a[104:107], a[52:55], v[164:167]
    v_exp_f32 v160, v160
    v_mfma_f32_16x16x32_bf16 v[164:167], a[108:111], a[48:51], v[164:167]
    v_exp_f32 v161, v161
    v_mfma_f32_16x16x32_bf16 v[168:171], a[112:115], a[48:51], -4.0
    v_exp_f32 v162, v162
    v_mfma_f32_16x16x32_bf16 v[168:171], a[116:119], a[52:55], v[168:171]
    v_exp_f32 v163, v163
    v_mfma_f32_16x16x32_bf16 v[168:171], a[120:123], a[56:59], v[168:171]
    v_cvt_pk_bf16_f32 v184, v160, v161
    v_cvt_pk_bf16_f32 v185, v162, v163
    v_mfma_f32_16x16x32_bf16 v[168:171], a[124:127], a[60:63], v[168:171]
    v_exp_f32 v164, v164
    v_mfma_f32_16x16x32_bf16 v[172:175], a[128:131], a[60:63], -4.0
    v_exp_f32 v165, v165
    v_mfma_f32_16x16x32_bf16 v[172:175], a[132:135], a[56:59], v[172:175]
    v_exp_f32 v166, v166
    v_mfma_f32_16x16x32_bf16 v[172:175], a[136:139], a[52:55], v[172:175]
    v_exp_f32 v167, v167
    v_mfma_f32_16x16x32_bf16 v[172:175], a[140:143], a[48:51], v[172:175]
    v_cvt_pk_bf16_f32 v186, v164, v165
    v_cvt_pk_bf16_f32 v187, v166, v167
    v_mfma_f32_16x16x32_bf16 v[64:67], v[176:179], a[144:147], 0
    s_add_u32 m0, s26, 67584
    v_exp_f32 v168, v168
    v_mfma_f32_16x16x32_bf16 v[68:71], v[176:179], a[148:151], 0
    global_load_lds_dwordx4 v244, s[14:15] offset:0 nt
    v_exp_f32 v169, v169
    v_mfma_f32_16x16x32_bf16 v[72:75], v[176:179], a[152:155], 0
    s_add_u32 m0, s26, 67616
    v_exp_f32 v170, v170
    v_mfma_f32_16x16x32_bf16 v[76:79], v[176:179], a[156:159], 0
    global_load_lds_dwordx4 v244, s[14:15] offset:1024 nt
    v_exp_f32 v171, v171
    v_mfma_f32_16x16x32_bf16 v[80:83], v[176:179], a[160:163], 0
    s_add_u32 m0, s26, 67648
    v_cvt_pk_bf16_f32 v188, v168, v169
    v_cvt_pk_bf16_f32 v189, v170, v171
    v_mfma_f32_16x16x32_bf16 v[84:87], v[176:179], a[164:167], 0
    global_load_lds_dwordx4 v244, s[14:15] offset:2048 nt
    v_exp_f32 v172, v172
    v_mfma_f32_16x16x32_bf16 v[88:91], v[176:179], a[168:171], 0
    s_add_u32 m0, s26, 67680
    v_exp_f32 v173, v173
    v_mfma_f32_16x16x32_bf16 v[92:95], v[176:179], a[172:175], 0
    v_cvt_pk_bf16_f32 v190, v172, v173
    v_mfma_f32_16x16x32_bf16 a[216:219], a[232:235], v[176:179], a[216:219]
    global_load_lds_dwordx4 v244, s[14:15] offset:3072 nt
    s_add_u32 s62, s24, 49152
    s_and_b32 s62, s62, 0x3ffff
    s_add_u32 s62, s62, s25
    s_add_u32 s10, s12, s62
    s_addc_u32 s11, s13, 0
    s_add_u32 s24, s24, 65536
    s_and_b32 s24, s24, 0x3ffff
    s_mov_b32 s23, 15
    s_mov_b32 s67, 4
    s_mov_b64 vcc, -1
    s_mov_b32 s21, 0
    s_waitcnt vmcnt(8)
    ds_read_b128 v[200:203], v245 offset:9792
    ds_read_b128 v[204:207], v245 offset:9856
    ds_read_b128 v[208:211], v245 offset:9920
    ds_read_b128 v[212:215], v245 offset:9984
    s_waitcnt lgkmcnt(0)
    v_lshlrev_b32 v248, 16, v200
    v_and_b32 v249, 0xffff0000, v200
    v_lshlrev_b32 v250, 16, v201
    v_and_b32 v251, 0xffff0000, v201
    v_pk_mul_f32 v[248:249], v[248:249], s[40:41]
    v_pk_mul_f32 v[250:251], v[250:251], s[40:41]
    v_cvt_pk_bf16_f32 v200, v248, v249
    v_cvt_pk_bf16_f32 v201, v250, v251
    v_accvgpr_write_b32 a64, v200
    v_accvgpr_write_b32 a65, v201
    v_lshlrev_b32 v248, 16, v202
    v_and_b32 v249, 0xffff0000, v202
    v_lshlrev_b32 v250, 16, v203
    v_and_b32 v251, 0xffff0000, v203
    v_pk_mul_f32 v[248:249], v[248:249], s[40:41]
    v_pk_mul_f32 v[250:251], v[250:251], s[40:41]
    v_cvt_pk_bf16_f32 v202, v248, v249
    v_cvt_pk_bf16_f32 v203, v250, v251
    v_accvgpr_write_b32 a66, v202
    v_accvgpr_write_b32 a67, v203
    v_lshlrev_b32 v248, 16, v204
    v_and_b32 v249, 0xffff0000, v204
    v_lshlrev_b32 v250, 16, v205
    v_and_b32 v251, 0xffff0000, v205
    v_pk_mul_f32 v[248:249], v[248:249], s[40:41]
    v_pk_mul_f32 v[250:251], v[250:251], s[40:41]
    v_cvt_pk_bf16_f32 v204, v248, v249
    v_cvt_pk_bf16_f32 v205, v250, v251
    v_accvgpr_write_b32 a68, v204
    v_accvgpr_write_b32 a69, v205
    v_lshlrev_b32 v248, 16, v206
    v_and_b32 v249, 0xffff0000, v206
    v_lshlrev_b32 v250, 16, v207
    v_and_b32 v251, 0xffff0000, v207
    v_pk_mul_f32 v[248:249], v[248:249], s[40:41]
    v_pk_mul_f32 v[250:251], v[250:251], s[40:41]
    v_cvt_pk_bf16_f32 v206, v248, v249
    v_cvt_pk_bf16_f32 v207, v250, v251
    v_accvgpr_write_b32 a70, v206
    v_accvgpr_write_b32 a71, v207
    v_lshlrev_b32 v248, 16, v208
    v_and_b32 v249, 0xffff0000, v208
    v_lshlrev_b32 v250, 16, v209
    v_and_b32 v251, 0xffff0000, v209
    v_pk_mul_f32 v[248:249], v[248:249], s[40:41]
    v_pk_mul_f32 v[250:251], v[250:251], s[40:41]
    v_cvt_pk_bf16_f32 v208, v248, v249
    v_cvt_pk_bf16_f32 v209, v250, v251
    v_accvgpr_write_b32 a72, v208
    v_accvgpr_write_b32 a73, v209
    v_lshlrev_b32 v248, 16, v210
    v_and_b32 v249, 0xffff0000, v210
    v_lshlrev_b32 v250, 16, v211
    v_and_b32 v251, 0xffff0000, v211
    v_pk_mul_f32 v[248:249], v[248:249], s[40:41]
    v_pk_mul_f32 v[250:251], v[250:251], s[40:41]
    v_cvt_pk_bf16_f32 v210, v248, v249
    v_cvt_pk_bf16_f32 v211, v250, v251
    v_accvgpr_write_b32 a74, v210
    v_accvgpr_write_b32 a75, v211
    v_lshlrev_b32 v248, 16, v212
    v_and_b32 v249, 0xffff0000, v212
    v_lshlrev_b32 v250, 16, v213
    v_and_b32 v251, 0xffff0000, v213
    v_pk_mul_f32 v[248:249], v[248:249], s[40:41]
    v_pk_mul_f32 v[250:251], v[250:251], s[40:41]
    v_cvt_pk_bf16_f32 v212, v248, v249
    v_cvt_pk_bf16_f32 v213, v250, v251
    v_accvgpr_write_b32 a76, v212
    v_accvgpr_write_b32 a77, v213
    v_lshlrev_b32 v248, 16, v214
    v_and_b32 v249, 0xffff0000, v214
    v_lshlrev_b32 v250, 16, v215
    v_and_b32 v251, 0xffff0000, v215
    v_pk_mul_f32 v[248:249], v[248:249], s[40:41]
    v_pk_mul_f32 v[250:251], v[250:251], s[40:41]
    v_cvt_pk_bf16_f32 v214, v248, v249
    v_cvt_pk_bf16_f32 v215, v250, v251
    v_accvgpr_write_b32 a78, v214
    v_accvgpr_write_b32 a79, v215
    s_waitcnt vmcnt(12)
    s_barrier
    v_mfma_f32_16x16x32_bf16 v[160:163], a[80:83], a[64:67], -4.0
    s_add_u32 m0, s26, 84480
    v_exp_f32 v174, v174
    v_mfma_f32_16x16x32_bf16 v[160:163], a[84:87], a[68:71], v[160:163]
    global_load_lds_dwordx4 v244, s[60:61] offset:0 nt
    v_exp_f32 v175, v175
    v_mfma_f32_16x16x32_bf16 v[160:163], a[88:91], a[72:75], v[160:163]
    ds_read_b128 a[80:83], v240 offset:0
    v_cvt_pk_bf16_f32 v191, v174, v175
    v_mfma_f32_16x16x32_bf16 v[160:163], a[92:95], a[76:79], v[160:163]
    ds_read_b128 a[84:87], v240 offset:64
    v_mfma_f32_16x16x32_bf16 v[164:167], a[96:99], a[76:79], -4.0
    ds_read_b128 a[88:91], v240 offset:128
    v_mfma_f32_16x16x32_bf16 v[164:167], a[100:103], a[72:75], v[164:167]
    s_add_u32 m0, s26, 84496
    ds_read_b128 a[92:95], v240 offset:192
    v_mfma_f32_16x16x32_bf16 v[164:167], a[104:107], a[68:71], v[164:167]
    global_load_lds_dwordx4 v244, s[60:61] offset:1024 nt
    v_exp_f32 v160, v160
    v_mfma_f32_16x16x32_bf16 v[164:167], a[108:111], a[64:67], v[164:167]
    v_exp_f32 v161, v161
    v_mfma_f32_16x16x32_bf16 v[168:171], a[112:115], a[64:67], -4.0
    ds_read_b128 a[96:99], v240 offset:704
    v_cvt_pk_bf16_f32 v192, v160, v161
    v_mfma_f32_16x16x32_bf16 v[168:171], a[116:119], a[68:71], v[168:171]
    v_exp_f32 v162, v162
    v_mfma_f32_16x16x32_bf16 v[168:171], a[120:123], a[72:75], v[168:171]
    s_add_u32 m0, s26, 84512
    v_exp_f32 v163, v163
    v_mfma_f32_16x16x32_bf16 v[168:171], a[124:127], a[76:79], v[168:171]
    ds_read_b128 a[100:103], v240 offset:640
    global_load_lds_dwordx4 v244, s[60:61] offset:2048 nt
    v_cvt_pk_bf16_f32 v193, v162, v163
    v_mfma_f32_16x16x32_bf16 v[172:175], a[128:131], a[76:79], -4.0
    v_exp_f32 v164, v164
    v_mfma_f32_16x16x32_bf16 v[172:175], a[132:135], a[72:75], v[172:175]
    v_exp_f32 v165, v165
    v_mfma_f32_16x16x32_bf16 v[172:175], a[136:139], a[68:71], v[172:175]
    ds_read_b128 a[104:107], v240 offset:576
    v_cvt_pk_bf16_f32 v194, v164, v165
    v_mfma_f32_16x16x32_bf16 v[172:175], a[140:143], a[64:67], v[172:175]
    s_add_u32 m0, s26, 84528
    v_exp_f32 v166, v166
    v_mfma_f32_16x16x32_bf16 v[96:99], v[184:187], a[144:147], 0
    global_load_lds_dwordx4 v244, s[60:61] offset:3072 nt
    v_exp_f32 v167, v167
    v_mfma_f32_16x16x32_bf16 v[96:99], v[188:191], a[176:179], v[96:99]
    ds_read_b128 a[108:111], v240 offset:512
    v_cvt_pk_bf16_f32 v195, v166, v167
    v_mfma_f32_16x16x32_bf16 v[100:103], v[184:187], a[148:151], 0
    v_exp_f32 v168, v168
    v_mfma_f32_16x16x32_bf16 v[100:103], v[188:191], a[180:183], v[100:103]
    v_exp_f32 v169, v169
    v_mfma_f32_16x16x32_bf16 v[104:107], v[184:187], a[152:155], 0
    s_mov_b32 m0, s49
    ds_read_b128 a[112:115], v241 offset:0
    v_cvt_pk_bf16_f32 v196, v168, v169
    v_mfma_f32_16x16x32_bf16 v[104:107], v[188:191], a[184:187], v[104:107]
    global_load_lds_dwordx4 v244, s[56:57] nt
    v_exp_f32 v170, v170
    v_mfma_f32_16x16x32_bf16 v[108:111], v[184:187], a[156:159], 0
    s_add_u32 s49, s49, 1088
    v_exp_f32 v171, v171
    v_mfma_f32_16x16x32_bf16 v[108:111], v[188:191], a[188:191], v[108:111]
    s_add_u32 s56, s56, 1024
    s_addc_u32 s57, s57, 0
    ds_read_b128 a[116:119], v241 offset:64
    v_cvt_pk_bf16_f32 v197, v170, v171
    v_mfma_f32_16x16x32_bf16 v[112:115], v[184:187], a[160:163], 0
    v_exp_f32 v172, v172
    v_mfma_f32_16x16x32_bf16 v[112:115], v[188:191], a[192:195], v[112:115]
    s_add_u32 m0, s26, 0
    v_exp_f32 v173, v173
    v_mfma_f32_16x16x32_bf16 v[116:119], v[184:187], a[164:167], 0
    ds_read_b128 a[120:123], v241 offset:128
    global_load_lds_dwordx4 v244, s[6:7] offset:0 nt
    v_cvt_pk_bf16_f32 v198, v172, v173
    v_mfma_f32_16x16x32_bf16 v[116:119], v[188:191], a[196:199], v[116:119]
    v_exp_f32 v174, v174
    v_mfma_f32_16x16x32_bf16 v[120:123], v[184:187], a[168:171], 0
    v_exp_f32 v175, v175
    v_mfma_f32_16x16x32_bf16 v[120:123], v[188:191], a[200:203], v[120:123]
    ds_read_b128 a[124:127], v241 offset:192
    v_cvt_pk_bf16_f32 v199, v174, v175
    v_mfma_f32_16x16x32_bf16 v[124:127], v[184:187], a[172:175], 0
    s_add_u32 m0, s26, 32
    ds_read_b128 a[128:131], v241 offset:704
    v_mfma_f32_16x16x32_bf16 v[124:127], v[188:191], a[204:207], v[124:127]
    ds_read_b128 a[132:135], v241 offset:640
    global_load_lds_dwordx4 v244, s[6:7] offset:1024 nt
    v_smfmac_f32_16x16x64_bf16 a[220:223], a[228:231], v[184:191], v247
    s_waitcnt lgkmcnt(4)
    ds_read_b128 a[136:139], v241 offset:576
    v_mfma_f32_16x16x32_bf16 v[160:163], a[80:83], a[0:3], -4.0
    ds_read_b128 a[140:143], v241 offset:512
    v_mfma_f32_16x16x32_bf16 v[160:163], a[84:87], a[4:7], v[160:163]
    v_mfma_f32_16x16x32_bf16 v[160:163], a[88:91], a[8:11], v[160:163]
    s_add_u32 m0, s26, 64
    v_mfma_f32_16x16x32_bf16 v[160:163], a[92:95], a[12:15], v[160:163]
    global_load_lds_dwordx4 v244, s[6:7] offset:2048 nt
    v_mfma_f32_16x16x32_bf16 v[164:167], a[96:99], a[12:15], -4.0
    s_waitcnt vmcnt(12)
    v_mfma_f32_16x16x32_bf16 v[164:167], a[100:103], a[8:11], v[164:167]
    s_barrier
    v_mfma_f32_16x16x32_bf16 v[164:167], a[104:107], a[4:7], v[164:167]
    v_exp_f32 v160, v160
    v_mfma_f32_16x16x32_bf16 v[164:167], a[108:111], a[0:3], v[164:167]
    s_add_u32 m0, s26, 96
    v_exp_f32 v161, v161
    v_mfma_f32_16x16x32_bf16 v[168:171], a[112:115], a[0:3], -4.0
    global_load_lds_dwordx4 v244, s[6:7] offset:3072 nt
    v_exp_f32 v162, v162
    v_mfma_f32_16x16x32_bf16 v[168:171], a[116:119], a[4:7], v[168:171]
    s_waitcnt lgkmcnt(0)
    v_exp_f32 v163, v163
    v_mfma_f32_16x16x32_bf16 v[168:171], a[120:123], a[8:11], v[168:171]
    v_cvt_pk_bf16_f32 v176, v160, v161
    v_cvt_pk_bf16_f32 v177, v162, v163
    v_mfma_f32_16x16x32_bf16 v[168:171], a[124:127], a[12:15], v[168:171]
    v_exp_f32 v164, v164
    v_mfma_f32_16x16x32_bf16 v[172:175], a[128:131], a[12:15], -4.0
    s_add_u32 m0, s26, 16896
    v_exp_f32 v165, v165
    v_mfma_f32_16x16x32_bf16 v[172:175], a[132:135], a[8:11], v[172:175]
    global_load_lds_dwordx4 v244, s[10:11] offset:0 nt
    v_exp_f32 v166, v166
    v_mfma_f32_16x16x32_bf16 v[172:175], a[136:139], a[4:7], v[172:175]
    v_exp_f32 v167, v167
    v_mfma_f32_16x16x32_bf16 v[172:175], a[140:143], a[0:3], v[172:175]
    v_cvt_pk_bf16_f32 v178, v164, v165
    v_cvt_pk_bf16_f32 v179, v166, v167
    v_mfma_f32_16x16x32_bf16 v[128:131], v[192:195], a[144:147], 0
    ds_read_b64_tr_b16 a[144:145], v242 offset:0
    ds_read_b64_tr_b16 a[146:147], v242 offset:512
    v_mfma_f32_16x16x32_bf16 v[128:131], v[196:199], a[176:179], v[128:131]
    s_add_u32 m0, s26, 16912
    v_exp_f32 v168, v168
    v_mfma_f32_16x16x32_bf16 v[132:135], v[192:195], a[148:151], 0
    ds_read_b64_tr_b16 a[176:177], v243 offset:0
    ds_read_b64_tr_b16 a[178:179], v243 offset:512
    global_load_lds_dwordx4 v244, s[10:11] offset:1024 nt
    v_mfma_f32_16x16x32_bf16 v[132:135], v[196:199], a[180:183], v[132:135]
    v_exp_f32 v169, v169
    v_mfma_f32_16x16x32_bf16 v[136:139], v[192:195], a[152:155], 0
    ds_read_b64_tr_b16 a[148:149], v242 offset:16
    ds_read_b64_tr_b16 a[150:151], v242 offset:528
    v_mfma_f32_16x16x32_bf16 v[136:139], v[196:199], a[184:187], v[136:139]
    v_exp_f32 v170, v170
    v_mfma_f32_16x16x32_bf16 v[140:143], v[192:195], a[156:159], 0
    s_add_u32 m0, s26, 16928
    ds_read_b64_tr_b16 a[180:181], v243 offset:16
    ds_read_b64_tr_b16 a[182:183], v243 offset:528
    v_mfma_f32_16x16x32_bf16 v[140:143], v[196:199], a[188:191], v[140:143]
    global_load_lds_dwordx4 v244, s[10:11] offset:2048 nt
    v_exp_f32 v171, v171
    v_mfma_f32_16x16x32_bf16 v[144:147], v[192:195], a[160:163], 0
    ds_read_b64_tr_b16 a[152:153], v242 offset:32
    ds_read_b64_tr_b16 a[154:155], v242 offset:544
    v_mfma_f32_16x16x32_bf16 v[144:147], v[196:199], a[192:195], v[144:147]
    v_exp_f32 v172, v172
    v_mfma_f32_16x16x32_bf16 v[148:151], v[192:195], a[164:167], 0
    ds_read_b64_tr_b16 a[184:185], v243 offset:32
    ds_read_b64_tr_b16 a[186:187], v243 offset:544
    v_mfma_f32_16x16x32_bf16 v[148:151], v[196:199], a[196:199], v[148:151]
    s_add_u32 m0, s26, 16944
    s_add_u32 s26, s26, 33792
    v_exp_f32 v173, v173
    v_mfma_f32_16x16x32_bf16 v[152:155], v[192:195], a[168:171], 0
    ds_read_b64_tr_b16 a[156:157], v242 offset:48
    ds_read_b64_tr_b16 a[158:159], v242 offset:560
    global_load_lds_dwordx4 v244, s[10:11] offset:3072 nt
    v_mfma_f32_16x16x32_bf16 v[152:155], v[196:199], a[200:203], v[152:155]
    v_exp_f32 v174, v174
    v_mfma_f32_16x16x32_bf16 v[156:159], v[192:195], a[172:175], 0
    ds_read_b64_tr_b16 a[188:189], v243 offset:48
    ds_read_b64_tr_b16 a[190:191], v243 offset:560
    v_mfma_f32_16x16x32_bf16 v[156:159], v[196:199], a[204:207], v[156:159]
    v_exp_f32 v175, v175
    v_smfmac_f32_16x16x64_bf16 a[224:227], a[228:231], v[192:199], v247
    s_branch L_loop0r1
.fill 400+5, 4, 0xbf810000
L_pad1_2:
    s_branch L_ret0
L_pad1_3:
    s_branch L_ret0
L_midr1:
    v_mfma_f32_16x16x32_bf16 v[160:163], a[80:83], a[16:19], -4.0
    ds_read_b64_tr_b16 a[160:161], v242 offset:128
    ds_read_b64_tr_b16 a[162:163], v242 offset:640
    v_mfma_f32_16x16x32_bf16 v[160:163], a[84:87], a[20:23], v[160:163]
    ds_read_b128 v[200:203], v245 offset:1088
    v_cvt_pk_bf16_f32 v180, v168, v169
    v_cvt_pk_bf16_f32 v181, v170, v171
    v_mfma_f32_16x16x32_bf16 v[160:163], a[88:91], a[24:27], v[160:163]
    s_add_u32 s49, s28, 4352
    ds_read_b64_tr_b16 a[192:193], v243 offset:128
    ds_read_b64_tr_b16 a[194:195], v243 offset:640
    v_mfma_f32_16x16x32_bf16 v[160:163], a[92:95], a[28:31], v[160:163]
    s_mov_b32 s67, 1
    ds_read_b128 v[204:207], v245 offset:1152
    v_cvt_pk_bf16_f32 v182, v172, v173
    v_cvt_pk_bf16_f32 v183, v174, v175
    v_mfma_f32_16x16x32_bf16 v[164:167], a[96:99], a[28:31], -4.0
    s_mov_b64 vcc, 0
    ds_read_b64_tr_b16 a[164:165], v242 offset:144
    ds_read_b64_tr_b16 a[166:167], v242 offset:656
    v_mfma_f32_16x16x32_bf16 v[164:167], a[100:103], a[24:27], v[164:167]
    ds_read_b128 v[208:211], v245 offset:1216
    v_and_b32 v251, 0xffff0000, v235
    v_mul_f32 v250, s40, v250
    v_mfma_f32_16x16x32_bf16 v[164:167], a[104:107], a[20:23], v[164:167]
    ds_read_b64_tr_b16 a[196:197], v243 offset:144
    ds_read_b64_tr_b16 a[198:199], v243 offset:656
    v_mfma_f32_16x16x32_bf16 v[164:167], a[108:111], a[16:19], v[164:167]
    ds_read_b128 v[212:215], v245 offset:1280
    v_exp_f32 v160, v160
    v_mfma_f32_16x16x32_bf16 v[168:171], a[112:115], a[16:19], -4.0
    ds_read_b64_tr_b16 a[168:169], v242 offset:160
    ds_read_b64_tr_b16 a[170:171], v242 offset:672
    v_mfma_f32_16x16x32_bf16 v[168:171], a[116:119], a[20:23], v[168:171]
    ds_read_b128 v[216:219], v245 offset:5440
    v_exp_f32 v161, v161
    v_mfma_f32_16x16x32_bf16 v[168:171], a[120:123], a[24:27], v[168:171]
    ds_read_b64_tr_b16 a[200:201], v243 offset:160
    ds_read_b64_tr_b16 a[202:203], v243 offset:672
    v_mfma_f32_16x16x32_bf16 v[168:171], a[124:127], a[28:31], v[168:171]
    ds_read_b128 v[220:223], v245 offset:5504
    v_exp_f32 v162, v162
    v_mfma_f32_16x16x32_bf16 v[172:175], a[128:131], a[28:31], -4.0
    ds_read_b64_tr_b16 a[172:173], v242 offset:176
    ds_read_b64_tr_b16 a[174:175], v242 offset:688
    v_mfma_f32_16x16x32_bf16 v[172:175], a[132:135], a[24:27], v[172:175]
    ds_read_b128 v[224:227], v245 offset:5568
    v_exp_f32 v163, v163
    v_mfma_f32_16x16x32_bf16 v[172:175], a[136:139], a[20:23], v[172:175]
    ds_read_b64_tr_b16 a[204:205], v243 offset:176
    ds_read_b64_tr_b16 a[206:207], v243 offset:688
    v_mfma_f32_16x16x32_bf16 v[172:175], a[140:143], a[16:19], v[172:175]
    s_waitcnt lgkmcnt(12)
    ds_read_b128 v[228:231], v245 offset:5632
    v_cvt_pk_bf16_f32 v184, v160, v161
    v_cvt_pk_bf16_f32 v185, v162, v163
    v_mfma_f32_16x16x32_bf16 v[0:3], v[176:179], a[144:147], v[0:3]
    s_waitcnt lgkmcnt(12)
    v_exp_f32 v164, v164
    v_mfma_f32_16x16x32_bf16 v[0:3], v[180:183], a[176:179], v[0:3]
    s_add_u32 m0, s28, 1088
    v_exp_f32 v165, v165
    v_mfma_f32_16x16x32_bf16 v[4:7], v[176:179], a[148:151], v[4:7]
    global_load_lds_dwordx4 v244, s[56:57] offset:0 nt
    v_exp_f32 v166, v166
    v_mfma_f32_16x16x32_bf16 v[4:7], v[180:183], a[180:183], v[4:7]
    v_exp_f32 v167, v167
    v_mfma_f32_16x16x32_bf16 v[8:11], v[176:179], a[152:155], v[8:11]
    s_add_u32 m0, s28, 1152
    v_cvt_pk_bf16_f32 v186, v164, v165
    v_cvt_pk_bf16_f32 v187, v166, v167
    v_mfma_f32_16x16x32_bf16 v[8:11], v[180:183], a[184:187], v[8:11]
    global_load_lds_dwordx4 v244, s[56:57] offset:1024 nt
    v_exp_f32 v168, v168
    v_mfma_f32_16x16x32_bf16 v[12:15], v[176:179], a[156:159], v[12:15]
    v_exp_f32 v172, v172
    v_mfma_f32_16x16x32_bf16 v[12:15], v[180:183], a[188:191], v[12:15]
    s_add_u32 m0, s28, 1216
    v_exp_f32 v169, v169
    v_mfma_f32_16x16x32_bf16 v[16:19], v[176:179], a[160:163], v[16:19]
    global_load_lds_dwordx4 v244, s[56:57] offset:2048 nt
    v_exp_f32 v173, v173
    v_mfma_f32_16x16x32_bf16 v[16:19], v[180:183], a[192:195], v[16:19]
    s_add_u32 s56, s56, 3072
    s_addc_u32 s57, s57, 0
    v_exp_f32 v170, v170
    v_mfma_f32_16x16x32_bf16 v[20:23], v[176:179], a[164:167], v[20:23]
    v_exp_f32 v174, v174
    v_mfma_f32_16x16x32_bf16 v[20:23], v[180:183], a[196:199], v[20:23]
    s_waitcnt lgkmcnt(0)
    v_exp_f32 v171, v171
    v_mfma_f32_16x16x32_bf16 v[24:27], v[176:179], a[168:171], v[24:27]
    s_waitcnt lgkmcnt(0)
    v_exp_f32 v175, v175
    v_mfma_f32_16x16x32_bf16 v[24:27], v[180:183], a[200:203], v[24:27]
    v_cvt_pk_bf16_f32 v188, v168, v169
    v_cvt_pk_bf16_f32 v189, v170, v171
    v_mfma_f32_16x16x32_bf16 v[28:31], v[176:179], a[172:175], v[28:31]
    s_branch L_inr1
L_loop0r1:
    v_mfma_f32_16x16x32_bf16 v[160:163], a[80:83], a[16:19], -4.0
    ds_read_b64_tr_b16 a[160:161], v242 offset:128
    ds_read_b64_tr_b16 a[162:163], v242 offset:640
    v_mfma_f32_16x16x32_bf16 v[160:163], a[84:87], a[20:23], v[160:163]
    v_cvt_pk_bf16_f32 v180, v168, v169
    v_cvt_pk_bf16_f32 v181, v170, v171
    v_mfma_f32_16x16x32_bf16 v[160:163], a[88:91], a[24:27], v[160:163]
    ds_read_b64_tr_b16 a[192:193], v243 offset:128
    ds_read_b64_tr_b16 a[194:195], v243 offset:640
    v_mfma_f32_16x16x32_bf16 v[160:163], a[92:95], a[28:31], v[160:163]
    v_cvt_pk_bf16_f32 v182, v172, v173
    v_cvt_pk_bf16_f32 v183, v174, v175
    v_mfma_f32_16x16x32_bf16 v[164:167], a[96:99], a[28:31], -4.0
    ds_read_b64_tr_b16 a[164:165], v242 offset:144
    ds_read_b64_tr_b16 a[166:167], v242 offset:656
    v_mfma_f32_16x16x32_bf16 v[164:167], a[100:103], a[24:27], v[164:167]
    v_and_b32 v251, 0xffff0000, v235
    v_mul_f32 v250, s40, v250
    v_mfma_f32_16x16x32_bf16 v[164:167], a[104:107], a[20:23], v[164:167]
    ds_read_b64_tr_b16 a[196:197], v243 offset:144
    ds_read_b64_tr_b16 a[198:199], v243 offset:656
    v_mfma_f32_16x16x32_bf16 v[164:167], a[108:111], a[16:19], v[164:167]
    v_exp_f32 v160, v160
    v_mfma_f32_16x16x32_bf16 v[168:171], a[112:115], a[16:19], -4.0
    ds_read_b64_tr_b16 a[168:169], v242 offset:160
    ds_read_b64_tr_b16 a[170:171], v242 offset:672
    v_mfma_f32_16x16x32_bf16 v[168:171], a[116:119], a[20:23], v[168:171]
    v_exp_f32 v161, v161
    v_mfma_f32_16x16x32_bf16 v[168:171], a[120:123], a[24:27], v[168:171]
    ds_read_b64_tr_b16 a[200:201], v243 offset:160
    ds_read_b64_tr_b16 a[202:203], v243 offset:672
    v_mfma_f32_16x16x32_bf16 v[168:171], a[124:127], a[28:31], v[168:171]
    v_exp_f32 v162, v162
    v_mfma_f32_16x16x32_bf16 v[172:175], a[128:131], a[28:31], -4.0
    ds_read_b64_tr_b16 a[172:173], v242 offset:176
    ds_read_b64_tr_b16 a[174:175], v242 offset:688
    v_mfma_f32_16x16x32_bf16 v[172:175], a[132:135], a[24:27], v[172:175]
    v_exp_f32 v163, v163
    v_mfma_f32_16x16x32_bf16 v[172:175], a[136:139], a[20:23], v[172:175]
    ds_read_b64_tr_b16 a[204:205], v243 offset:176
    ds_read_b64_tr_b16 a[206:207], v243 offset:688
    v_mfma_f32_16x16x32_bf16 v[172:175], a[140:143], a[16:19], v[172:175]
    s_waitcnt lgkmcnt(8)
    v_cvt_pk_bf16_f32 v184, v160, v161
    v_cvt_pk_bf16_f32 v185, v162, v163
    v_mfma_f32_16x16x32_bf16 v[0:3], v[176:179], a[144:147], v[0:3]
    v_exp_f32 v164, v164
    v_mfma_f32_16x16x32_bf16 v[0:3], v[180:183], a[176:179], v[0:3]
    v_exp_f32 v165, v165
    v_mfma_f32_16x16x32_bf16 v[4:7], v[176:179], a[148:151], v[4:7]
    v_exp_f32 v166, v166
    v_mfma_f32_16x16x32_bf16 v[4:7], v[180:183], a[180:183], v[4:7]
    v_exp_f32 v167, v167
    v_mfma_f32_16x16x32_bf16 v[8:11], v[176:179], a[152:155], v[8:11]
    v_cvt_pk_bf16_f32 v186, v164, v165
    v_cvt_pk_bf16_f32 v187, v166, v167
    v_mfma_f32_16x16x32_bf16 v[8:11], v[180:183], a[184:187], v[8:11]
    v_exp_f32 v168, v168
    v_mfma_f32_16x16x32_bf16 v[12:15], v[176:179], a[156:159], v[12:15]
    v_exp_f32 v172, v172
    v_mfma_f32_16x16x32_bf16 v[12:15], v[180:183], a[188:191], v[12:15]
    v_exp_f32 v169, v169
    v_mfma_f32_16x16x32_bf16 v[16:19], v[176:179], a[160:163], v[16:19]
    v_exp_f32 v173, v173
    v_mfma_f32_16x16x32_bf16 v[16:19], v[180:183], a[192:195], v[16:19]
    v_exp_f32 v170, v170
    v_mfma_f32_16x16x32_bf16 v[20:23], v[176:179], a[164:167], v[20:23]
    v_exp_f32 v174, v174
    v_mfma_f32_16x16x32_bf16 v[20:23], v[180:183], a[196:199], v[20:23]
    s_waitcnt lgkmcnt(0)
    v_exp_f32 v171, v171
    v_mfma_f32_16x16x32_bf16 v[24:27], v[176:179], a[168:171], v[24:27]
    v_exp_f32 v175, v175
    v_mfma_f32_16x16x32_bf16 v[24:27], v[180:183], a[200:203], v[24:27]
    v_cvt_pk_bf16_f32 v188, v168, v169
    v_cvt_pk_bf16_f32 v189, v170, v171
    v_mfma_f32_16x16x32_bf16 v[28:31], v[176:179], a[172:175], v[28:31]
L_inr1:
    v_cvt_pk_bf16_f32 v190, v172, v173
    v_cvt_pk_bf16_f32 v191, v174, v175
    v_mfma_f32_16x16x32_bf16 v[28:31], v[180:183], a[204:207], v[28:31]
    s_waitcnt vmcnt(9)
    v_mul_f32 v251, s40, v251
    v_cvt_pk_bf16_f32 v235, v250, v251
    v_smfmac_f32_16x16x64_bf16 a[208:211], a[228:231], v[176:183], v247
    s_barrier
    v_mfma_f32_16x16x32_bf16 v[160:163], a[80:83], a[32:35], -4.0
    s_mov_b32 m0, s49
    v_add_u32 v240, s27, v240
    v_mfma_f32_16x16x32_bf16 v[160:163], a[84:87], a[36:39], v[160:163]
    global_load_lds_dwordx4 v244, s[56:57] nt
    v_mfma_f32_16x16x32_bf16 v[160:163], a[88:91], a[40:43], v[160:163]
    s_add_u32 m0, s26, 0
    v_add_u32 v241, s27, v241
    v_mfma_f32_16x16x32_bf16 v[160:163], a[92:95], a[44:47], v[160:163]
    global_load_lds_dwordx4 v244, s[52:53] offset:0
    v_mfma_f32_16x16x32_bf16 v[164:167], a[96:99], a[44:47], -4.0
    s_add_u32 m0, s26, 32
    v_add_u32 v242, s27, v242
    v_mfma_f32_16x16x32_bf16 v[164:167], a[100:103], a[40:43], v[164:167]
    global_load_lds_dwordx4 v244, s[52:53] offset:1024
    v_mfma_f32_16x16x32_bf16 v[164:167], a[104:107], a[36:39], v[164:167]
    v_exp_f32 v160, v160
    v_mfma_f32_16x16x32_bf16 v[164:167], a[108:111], a[32:35], v[164:167]
    v_exp_f32 v161, v161
    v_mfma_f32_16x16x32_bf16 v[32:35], v[184:187], a[144:147], v[32:35]
    v_exp_f32 v162, v162
    v_mfma_f32_16x16x32_bf16 v[32:35], v[188:191], a[176:179], v[32:35]
    v_exp_f32 v163, v163
    v_mfma_f32_16x16x32_bf16 v[36:39], v[184:187], a[148:151], v[36:39]
    v_cvt_pk_bf16_f32 v176, v160, v161
    v_cvt_pk_bf16_f32 v177, v162, v163
    v_mfma_f32_16x16x32_bf16 v[36:39], v[188:191], a[180:183], v[36:39]
    v_exp_f32 v164, v164
    v_mfma_f32_16x16x32_bf16 v[40:43], v[184:187], a[152:155], v[40:43]
    v_exp_f32 v165, v165
    v_mfma_f32_16x16x32_bf16 v[40:43], v[188:191], a[184:187], v[40:43]
    v_exp_f32 v166, v166
    v_mfma_f32_16x16x32_bf16 v[44:47], v[184:187], a[156:159], v[44:47]
    v_exp_f32 v167, v167
    v_mfma_f32_16x16x32_bf16 v[44:47], v[188:191], a[188:191], v[44:47]
    v_cvt_pk_bf16_f32 v178, v164, v165
    v_cvt_pk_bf16_f32 v179, v166, v167
    v_mfma_f32_16x16x32_bf16 v[48:51], v[184:187], a[160:163], v[48:51]
    v_add_u32 v243, s27, v243
    v_mfma_f32_16x16x32_bf16 v[48:51], v[188:191], a[192:195], v[48:51]
    ds_write_b32 v254, v232 offset:0
    v_mfma_f32_16x16x32_bf16 v[52:55], v[184:187], a[164:167], v[52:55]
    ds_write_b32 v254, v233 offset:256
    v_mfma_f32_16x16x32_bf16 v[52:55], v[188:191], a[196:199], v[52:55]
    s_add_u32 m0, s26, 64
    v_mfma_f32_16x16x32_bf16 v[56:59], v[184:187], a[168:171], v[56:59]
    global_load_lds_dwordx4 v244, s[52:53] offset:2048
    v_mfma_f32_16x16x32_bf16 v[56:59], v[188:191], a[200:203], v[56:59]
    ds_write_b32 v254, v234 offset:512
    v_mfma_f32_16x16x32_bf16 v[60:63], v[184:187], a[172:175], v[60:63]
    ds_write_b32 v254, v235 offset:768
    v_mfma_f32_16x16x32_bf16 v[60:63], v[188:191], a[204:207], v[60:63]
    s_add_u32 m0, s26, 96
    v_add_u32 v254, s21, v254
    v_smfmac_f32_16x16x64_bf16 a[212:215], a[228:231], v[184:191], v247
    global_load_lds_dwordx4 v244, s[52:53] offset:3072
    v_mfma_f32_16x16x32_bf16 v[160:163], a[80:83], a[48:51], -4.0
    s_add_u32 m0, s26, 16896
    ds_read2st64_b32 v[232:233], v254 offset0:0 offset1:1
    v_mfma_f32_16x16x32_bf16 v[160:163], a[84:87], a[52:55], v[160:163]
    global_load_lds_dwordx4 v244, s[54:55] offset:0
    v_mfma_f32_16x16x32_bf16 v[160:163], a[88:91], a[56:59], v[160:163]
    s_add_u32 m0, s26, 16912
    ds_read2st64_b32 v[234:235], v254 offset0:2 offset1:3
    v_mfma_f32_16x16x32_bf16 v[160:163], a[92:95], a[60:63], v[160:163]
    global_load_lds_dwordx4 v244, s[54:55] offset:1024
    v_mfma_f32_16x16x32_bf16 v[164:167], a[96:99], a[60:63], -4.0
    s_add_u32 m0, s26, 16928
    v_mfma_f32_16x16x32_bf16 v[164:167], a[100:103], a[56:59], v[164:167]
    global_load_lds_dwordx4 v244, s[54:55] offset:2048
    v_mfma_f32_16x16x32_bf16 v[164:167], a[104:107], a[52:55], v[164:167]
    v_exp_f32 v160, v160
    v_mfma_f32_16x16x32_bf16 v[164:167], a[108:111], a[48:51], v[164:167]
    v_exp_f32 v161, v161
    v_mfma_f32_16x16x32_bf16 v[168:171], a[112:115], a[48:51], -4.0
    v_exp_f32 v162, v162
    v_mfma_f32_16x16x32_bf16 v[168:171], a[116:119], a[52:55], v[168:171]
    v_exp_f32 v163, v163
    v_mfma_f32_16x16x32_bf16 v[168:171], a[120:123], a[56:59], v[168:171]
    v_cvt_pk_bf16_f32 v184, v160, v161
    v_cvt_pk_bf16_f32 v185, v162, v163
    v_mfma_f32_16x16x32_bf16 v[168:171], a[124:127], a[60:63], v[168:171]
    v_exp_f32 v164, v164
    v_mfma_f32_16x16x32_bf16 v[172:175], a[128:131], a[60:63], -4.0
    v_exp_f32 v165, v165
    v_mfma_f32_16x16x32_bf16 v[172:175], a[132:135], a[56:59], v[172:175]
    v_exp_f32 v166, v166
    v_mfma_f32_16x16x32_bf16 v[172:175], a[136:139], a[52:55], v[172:175]
    v_exp_f32 v167, v167
    v_mfma_f32_16x16x32_bf16 v[172:175], a[140:143], a[48:51], v[172:175]
    v_cvt_pk_bf16_f32 v186, v164, v165
    v_cvt_pk_bf16_f32 v187, v166, v167
    v_mfma_f32_16x16x32_bf16 v[64:67], v[176:179], a[144:147], v[64:67]
    v_exp_f32 v168, v168
    v_mfma_f32_16x16x32_bf16 v[68:71], v[176:179], a[148:151], v[68:71]
    v_exp_f32 v169, v169
    v_mfma_f32_16x16x32_bf16 v[72:75], v[176:179], a[152:155], v[72:75]
    v_exp_f32 v170, v170
    v_mfma_f32_16x16x32_bf16 v[76:79], v[176:179], a[156:159], v[76:79]
    v_exp_f32 v171, v171
    v_mfma_f32_16x16x32_bf16 v[80:83], v[176:179], a[160:163], v[80:83]
    v_cvt_pk_bf16_f32 v188, v168, v169
    v_cvt_pk_bf16_f32 v189, v170, v171
    v_mfma_f32_16x16x32_bf16 v[84:87], v[176:179], a[164:167], v[84:87]
    v_exp_f32 v172, v172
    v_mfma_f32_16x16x32_bf16 v[88:91], v[176:179], a[168:171], v[88:91]
    v_exp_f32 v173, v173
    v_mfma_f32_16x16x32_bf16 v[92:95], v[176:179], a[172:175], v[92:95]
    s_add_u32 m0, s26, 16944
    v_cvt_pk_bf16_f32 v190, v172, v173
    v_mfma_f32_16x16x32_bf16 a[216:219], a[232:235], v[176:179], a[216:219]
    global_load_lds_dwordx4 v244, s[54:55] offset:3072
    v_mfma_f32_16x16x32_bf16 v[160:163], a[80:83], a[64:67], -4.0
    s_add_u32 s49, s49, 1088
    v_exp_f32 v174, v174
    v_mfma_f32_16x16x32_bf16 v[160:163], a[84:87], a[68:71], v[160:163]
    s_add_u32 s56, s56, 1024
    v_exp_f32 v175, v175
    v_mfma_f32_16x16x32_bf16 v[160:163], a[88:91], a[72:75], v[160:163]
    s_addc_u32 s57, s57, 0
    ds_read_b128 a[80:83], v240 offset:0
    v_cvt_pk_bf16_f32 v191, v174, v175
    v_mfma_f32_16x16x32_bf16 v[160:163], a[92:95], a[76:79], v[160:163]
    s_waitcnt lgkmcnt(1)
    ds_read_b128 a[84:87], v240 offset:64
    v_lshlrev_b32 v236, 16, v232
    v_mfma_f32_16x16x32_bf16 v[164:167], a[96:99], a[76:79], -4.0
    s_mov_b32 s21, 1088
    ds_read_b128 a[88:91], v240 offset:128
    v_and_b32 v237, 0xffff0000, v232
    v_mfma_f32_16x16x32_bf16 v[164:167], a[100:103], a[72:75], v[164:167]
    s_add_u32 s24, s24, 16384
    ds_read_b128 a[92:95], v240 offset:192
    v_mul_f32 v236, s40, v236
    v_mfma_f32_16x16x32_bf16 v[164:167], a[104:107], a[68:71], v[164:167]
    s_and_b32 s24, s24, 0x3ffff
    v_exp_f32 v160, v160
    v_mfma_f32_16x16x32_bf16 v[164:167], a[108:111], a[64:67], v[164:167]
    s_cmp_eq_u32 s23, 4
    v_exp_f32 v161, v161
    v_mfma_f32_16x16x32_bf16 v[168:171], a[112:115], a[64:67], -4.0
    s_cselect_b32 s25, s51, s25
    ds_read_b128 a[96:99], v240 offset:704
    v_cvt_pk_bf16_f32 v192, v160, v161
    v_mfma_f32_16x16x32_bf16 v[168:171], a[116:119], a[68:71], v[168:171]
    s_add_u32 s65, s25, s24
    v_exp_f32 v162, v162
    v_mfma_f32_16x16x32_bf16 v[168:171], a[120:123], a[72:75], v[168:171]
    s_add_u32 s52, s8, s65
    v_exp_f32 v163, v163
    v_mfma_f32_16x16x32_bf16 v[168:171], a[124:127], a[76:79], v[168:171]
    s_addc_u32 s53, s9, 0
    ds_read_b128 a[100:103], v240 offset:640
    v_cvt_pk_bf16_f32 v193, v162, v163
    v_mfma_f32_16x16x32_bf16 v[172:175], a[128:131], a[76:79], -4.0
    s_add_u32 s54, s12, s65
    v_exp_f32 v164, v164
    v_mfma_f32_16x16x32_bf16 v[172:175], a[132:135], a[72:75], v[172:175]
    s_addc_u32 s55, s13, 0
    v_exp_f32 v165, v165
    v_mfma_f32_16x16x32_bf16 v[172:175], a[136:139], a[68:71], v[172:175]
    s_add_u32 s26, s26, s27
    ds_read_b128 a[104:107], v240 offset:576
    v_cvt_pk_bf16_f32 v194, v164, v165
    v_mfma_f32_16x16x32_bf16 v[172:175], a[140:143], a[64:67], v[172:175]
    s_cmp_eq_u32 s26, s48
    v_exp_f32 v166, v166
    v_mfma_f32_16x16x32_bf16 v[96:99], v[184:187], a[144:147], v[96:99]
    s_cselect_b32 s27, s58, s59
    v_exp_f32 v167, v167
    v_mfma_f32_16x16x32_bf16 v[96:99], v[188:191], a[176:179], v[96:99]
    s_sub_u32 s23, s23, 1
    ds_read_b128 a[108:111], v240 offset:512
    v_cvt_pk_bf16_f32 v195, v166, v167
    v_mfma_f32_16x16x32_bf16 v[100:103], v[184:187], a[148:151], v[100:103]
    s_cmp_lg_u32 s23, s67
    v_exp_f32 v168, v168
    v_mfma_f32_16x16x32_bf16 v[100:103], v[188:191], a[180:183], v[100:103]
    v_exp_f32 v169, v169
    v_mfma_f32_16x16x32_bf16 v[104:107], v[184:187], a[152:155], v[104:107]
    ds_read_b128 a[112:115], v241 offset:0
    v_cvt_pk_bf16_f32 v196, v168, v169
    v_mfma_f32_16x16x32_bf16 v[104:107], v[188:191], a[184:187], v[104:107]
    v_exp_f32 v170, v170
    v_mfma_f32_16x16x32_bf16 v[108:111], v[184:187], a[156:159], v[108:111]
    v_exp_f32 v171, v171
    v_mfma_f32_16x16x32_bf16 v[108:111], v[188:191], a[188:191], v[108:111]
    ds_read_b128 a[116:119], v241 offset:64
    v_cvt_pk_bf16_f32 v197, v170, v171
    v_mfma_f32_16x16x32_bf16 v[112:115], v[184:187], a[160:163], v[112:115]
    v_exp_f32 v172, v172
    v_mfma_f32_16x16x32_bf16 v[112:115], v[188:191], a[192:195], v[112:115]
    v_exp_f32 v173, v173
    v_mfma_f32_16x16x32_bf16 v[116:119], v[184:187], a[164:167], v[116:119]
    ds_read_b128 a[120:123], v241 offset:128
    v_cvt_pk_bf16_f32 v198, v172, v173
    v_mfma_f32_16x16x32_bf16 v[116:119], v[188:191], a[196:199], v[116:119]
    v_exp_f32 v174, v174
    v_mfma_f32_16x16x32_bf16 v[120:123], v[184:187], a[168:171], v[120:123]
    v_exp_f32 v175, v175
    v_mfma_f32_16x16x32_bf16 v[120:123], v[188:191], a[200:203], v[120:123]
    ds_read_b128 a[124:127], v241 offset:192
    v_cvt_pk_bf16_f32 v199, v174, v175
    v_mfma_f32_16x16x32_bf16 v[124:127], v[184:187], a[172:175], v[124:127]
    ds_read_b128 a[128:131], v241 offset:704
    v_mul_f32 v237, s40, v237
    v_mfma_f32_16x16x32_bf16 v[124:127], v[188:191], a[204:207], v[124:127]
    ds_read_b128 a[132:135], v241 offset:640
    v_cvt_pk_bf16_f32 v232, v236, v237
    v_smfmac_f32_16x16x64_bf16 a[220:223], a[228:231], v[184:191], v247
    s_waitcnt lgkmcnt(4)
    ds_read_b128 a[136:139], v241 offset:576
    v_mfma_f32_16x16x32_bf16 v[160:163], a[80:83], a[0:3], -4.0
    ds_read_b128 a[140:143], v241 offset:512
    v_lshlrev_b32 v238, 16, v233
    v_mfma_f32_16x16x32_bf16 v[160:163], a[84:87], a[4:7], v[160:163]
    v_and_b32 v239, 0xffff0000, v233
    v_mul_f32 v238, s40, v238
    v_mfma_f32_16x16x32_bf16 v[160:163], a[88:91], a[8:11], v[160:163]
    v_mul_f32 v239, s40, v239
    v_cvt_pk_bf16_f32 v233, v238, v239
    v_mfma_f32_16x16x32_bf16 v[160:163], a[92:95], a[12:15], v[160:163]
    v_lshlrev_b32 v248, 16, v234
    v_and_b32 v249, 0xffff0000, v234
    v_mfma_f32_16x16x32_bf16 v[164:167], a[96:99], a[12:15], -4.0
    v_mul_f32 v248, s40, v248
    v_mul_f32 v249, s40, v249
    v_mfma_f32_16x16x32_bf16 v[164:167], a[100:103], a[8:11], v[164:167]
    v_cvt_pk_bf16_f32 v234, v248, v249
    v_lshlrev_b32 v250, 16, v235
    v_mfma_f32_16x16x32_bf16 v[164:167], a[104:107], a[4:7], v[164:167]
    v_exp_f32 v160, v160
    v_mfma_f32_16x16x32_bf16 v[164:167], a[108:111], a[0:3], v[164:167]
    v_exp_f32 v161, v161
    v_mfma_f32_16x16x32_bf16 v[168:171], a[112:115], a[0:3], -4.0
    v_exp_f32 v162, v162
    v_mfma_f32_16x16x32_bf16 v[168:171], a[116:119], a[4:7], v[168:171]
    s_waitcnt lgkmcnt(0)
    v_exp_f32 v163, v163
    v_mfma_f32_16x16x32_bf16 v[168:171], a[120:123], a[8:11], v[168:171]
    v_cvt_pk_bf16_f32 v176, v160, v161
    v_cvt_pk_bf16_f32 v177, v162, v163
    v_mfma_f32_16x16x32_bf16 v[168:171], a[124:127], a[12:15], v[168:171]
    v_exp_f32 v164, v164
    v_mfma_f32_16x16x32_bf16 v[172:175], a[128:131], a[12:15], -4.0
    v_exp_f32 v165, v165
    v_mfma_f32_16x16x32_bf16 v[172:175], a[132:135], a[8:11], v[172:175]
    v_exp_f32 v166, v166
    v_mfma_f32_16x16x32_bf16 v[172:175], a[136:139], a[4:7], v[172:175]
    v_exp_f32 v167, v167
    v_mfma_f32_16x16x32_bf16 v[172:175], a[140:143], a[0:3], v[172:175]
    v_cvt_pk_bf16_f32 v178, v164, v165
    v_cvt_pk_bf16_f32 v179, v166, v167
    v_mfma_f32_16x16x32_bf16 v[128:131], v[192:195], a[144:147], v[128:131]
    ds_read_b64_tr_b16 a[144:145], v242 offset:0
    ds_read_b64_tr_b16 a[146:147], v242 offset:512
    v_mfma_f32_16x16x32_bf16 v[128:131], v[196:199], a[176:179], v[128:131]
    v_exp_f32 v168, v168
    v_mfma_f32_16x16x32_bf16 v[132:135], v[192:195], a[148:151], v[132:135]
    ds_read_b64_tr_b16 a[176:177], v243 offset:0
    ds_read_b64_tr_b16 a[178:179], v243 offset:512
    v_mfma_f32_16x16x32_bf16 v[132:135], v[196:199], a[180:183], v[132:135]
    v_exp_f32 v169, v169
    v_mfma_f32_16x16x32_bf16 v[136:139], v[192:195], a[152:155], v[136:139]
    ds_read_b64_tr_b16 a[148:149], v242 offset:16
    ds_read_b64_tr_b16 a[150:151], v242 offset:528
    v_mfma_f32_16x16x32_bf16 v[136:139], v[196:199], a[184:187], v[136:139]
    v_exp_f32 v170, v170
    v_mfma_f32_16x16x32_bf16 v[140:143], v[192:195], a[156:159], v[140:143]
    ds_read_b64_tr_b16 a[180:181], v243 offset:16
    ds_read_b64_tr_b16 a[182:183], v243 offset:528
    v_mfma_f32_16x16x32_bf16 v[140:143], v[196:199], a[188:191], v[140:143]
    v_exp_f32 v171, v171
    v_mfma_f32_16x16x32_bf16 v[144:147], v[192:195], a[160:163], v[144:147]
    ds_read_b64_tr_b16 a[152:153], v242 offset:32
    ds_read_b64_tr_b16 a[154:155], v242 offset:544
    v_mfma_f32_16x16x32_bf16 v[144:147], v[196:199], a[192:195], v[144:147]
    v_exp_f32 v172, v172
    v_mfma_f32_16x16x32_bf16 v[148:151], v[192:195], a[164:167], v[148:151]
    ds_read_b64_tr_b16 a[184:185], v243 offset:32
    ds_read_b64_tr_b16 a[186:187], v243 offset:544
    v_mfma_f32_16x16x32_bf16 v[148:151], v[196:199], a[196:199], v[148:151]
    v_exp_f32 v173, v173
    v_mfma_f32_16x16x32_bf16 v[152:155], v[192:195], a[168:171], v[152:155]
    ds_read_b64_tr_b16 a[156:157], v242 offset:48
    ds_read_b64_tr_b16 a[158:159], v242 offset:560
    v_mfma_f32_16x16x32_bf16 v[152:155], v[196:199], a[200:203], v[152:155]
    v_exp_f32 v174, v174
    v_mfma_f32_16x16x32_bf16 v[156:159], v[192:195], a[172:175], v[156:159]
    ds_read_b64_tr_b16 a[188:189], v243 offset:48
    ds_read_b64_tr_b16 a[190:191], v243 offset:560
    v_mfma_f32_16x16x32_bf16 v[156:159], v[196:199], a[204:207], v[156:159]
    v_exp_f32 v175, v175
    v_smfmac_f32_16x16x64_bf16 a[224:227], a[228:231], v[192:199], v247
    s_cbranch_scc1 L_loop0r1
    s_cbranch_vccnz L_midr1
L_transr1:
    v_mfma_f32_16x16x32_bf16 v[160:163], a[80:83], a[16:19], -4.0
    ds_read_b64_tr_b16 a[160:161], v242 offset:128
    ds_read_b64_tr_b16 a[162:163], v242 offset:640
    v_mfma_f32_16x16x32_bf16 v[160:163], a[84:87], a[20:23], v[160:163]
    v_cvt_pk_bf16_f32 v180, v168, v169
    v_cvt_pk_bf16_f32 v181, v170, v171
    v_mfma_f32_16x16x32_bf16 v[160:163], a[88:91], a[24:27], v[160:163]
    s_add_u32 m0, s28, 7616
    ds_read_b64_tr_b16 a[192:193], v243 offset:128
    ds_read_b64_tr_b16 a[194:195], v243 offset:640
    v_mfma_f32_16x16x32_bf16 v[160:163], a[92:95], a[28:31], v[160:163]
    global_load_lds_dwordx4 v244, s[56:57] offset:0 nt
    v_cvt_pk_bf16_f32 v182, v172, v173
    v_cvt_pk_bf16_f32 v183, v174, v175
    v_mfma_f32_16x16x32_bf16 v[164:167], a[96:99], a[28:31], -4.0
    s_add_u32 m0, s28, 7680
    ds_read_b64_tr_b16 a[164:165], v242 offset:144
    ds_read_b64_tr_b16 a[166:167], v242 offset:656
    v_mfma_f32_16x16x32_bf16 v[164:167], a[100:103], a[24:27], v[164:167]
    global_load_lds_dwordx4 v244, s[56:57] offset:1024 nt
    v_mfma_f32_16x16x32_bf16 v[164:167], a[104:107], a[20:23], v[164:167]
    ds_read_b64_tr_b16 a[196:197], v243 offset:144
    ds_read_b64_tr_b16 a[198:199], v243 offset:656
    v_mfma_f32_16x16x32_bf16 v[164:167], a[108:111], a[16:19], v[164:167]
    s_mov_b32 s64, 960
    v_exp_f32 v160, v160
    v_mfma_f32_16x16x32_bf16 v[168:171], a[112:115], a[16:19], -4.0
    ds_read_b64_tr_b16 a[168:169], v242 offset:160
    ds_read_b64_tr_b16 a[170:171], v242 offset:672
    v_mfma_f32_16x16x32_bf16 v[168:171], a[116:119], a[20:23], v[168:171]
    v_exp_f32 v161, v161
    v_mfma_f32_16x16x32_bf16 v[168:171], a[120:123], a[24:27], v[168:171]
    ds_read_b64_tr_b16 a[200:201], v243 offset:160
    ds_read_b64_tr_b16 a[202:203], v243 offset:672
    v_mfma_f32_16x16x32_bf16 v[168:171], a[124:127], a[28:31], v[168:171]
    v_exp_f32 v162, v162
    v_mfma_f32_16x16x32_bf16 v[172:175], a[128:131], a[28:31], -4.0
    ds_read_b64_tr_b16 a[172:173], v242 offset:176
    ds_read_b64_tr_b16 a[174:175], v242 offset:688
    v_mfma_f32_16x16x32_bf16 v[172:175], a[132:135], a[24:27], v[172:175]
    v_exp_f32 v163, v163
    v_mfma_f32_16x16x32_bf16 v[172:175], a[136:139], a[20:23], v[172:175]
    ds_read_b64_tr_b16 a[204:205], v243 offset:176
    ds_read_b64_tr_b16 a[206:207], v243 offset:688
    v_mfma_f32_16x16x32_bf16 v[172:175], a[140:143], a[16:19], v[172:175]
    s_waitcnt lgkmcnt(8)
    v_cvt_pk_bf16_f32 v184, v160, v161
    v_cvt_pk_bf16_f32 v185, v162, v163
    v_mfma_f32_16x16x32_bf16 v[0:3], v[176:179], a[144:147], v[0:3]
    v_exp_f32 v164, v164
    v_mfma_f32_16x16x32_bf16 v[0:3], v[180:183], a[176:179], v[0:3]
    v_exp_f32 v165, v165
    v_mfma_f32_16x16x32_bf16 v[4:7], v[176:179], a[148:151], v[4:7]
    v_exp_f32 v166, v166
    v_mfma_f32_16x16x32_bf16 v[4:7], v[180:183], a[180:183], v[4:7]
    v_exp_f32 v167, v167
    v_mfma_f32_16x16x32_bf16 v[8:11], v[176:179], a[152:155], v[8:11]
    v_cvt_pk_bf16_f32 v186, v164, v165
    v_cvt_pk_bf16_f32 v187, v166, v167
    v_mfma_f32_16x16x32_bf16 v[8:11], v[180:183], a[184:187], v[8:11]
    v_exp_f32 v168, v168
    v_mfma_f32_16x16x32_bf16 v[12:15], v[176:179], a[156:159], v[12:15]
    v_exp_f32 v172, v172
    v_mfma_f32_16x16x32_bf16 v[12:15], v[180:183], a[188:191], v[12:15]
    v_exp_f32 v169, v169
    v_mfma_f32_16x16x32_bf16 v[16:19], v[176:179], a[160:163], v[16:19]
    v_exp_f32 v173, v173
    v_mfma_f32_16x16x32_bf16 v[16:19], v[180:183], a[192:195], v[16:19]
    v_exp_f32 v170, v170
    v_mfma_f32_16x16x32_bf16 v[20:23], v[176:179], a[164:167], v[20:23]
    v_exp_f32 v174, v174
    v_mfma_f32_16x16x32_bf16 v[20:23], v[180:183], a[196:199], v[20:23]
    s_waitcnt lgkmcnt(0)
    v_exp_f32 v171, v171
    v_mfma_f32_16x16x32_bf16 v[24:27], v[176:179], a[168:171], v[24:27]
    v_exp_f32 v175, v175
    v_mfma_f32_16x16x32_bf16 v[24:27], v[180:183], a[200:203], v[24:27]
    v_cvt_pk_bf16_f32 v188, v168, v169
    v_cvt_pk_bf16_f32 v189, v170, v171
    v_mfma_f32_16x16x32_bf16 v[28:31], v[176:179], a[172:175], v[28:31]
L_pad1_4:
    s_cbranch_execz L_ret1
    v_cvt_pk_bf16_f32 v190, v172, v173
    v_cvt_pk_bf16_f32 v191, v174, v175
    v_mfma_f32_16x16x32_bf16 v[28:31], v[180:183], a[204:207], v[28:31]
    s_waitcnt vmcnt(11)
    ds_read_b128 v[232:235], v245 offset:1088
    ds_read_b128 v[236:239], v245 offset:1152
    v_smfmac_f32_16x16x64_bf16 a[208:211], a[228:231], v[176:183], v247
    s_barrier
    v_mfma_f32_16x16x32_bf16 v[160:163], a[80:83], a[32:35], -4.0
    s_add_u32 m0, s26, 0
    v_add_u32 v240, s27, v240
    v_mfma_f32_16x16x32_bf16 v[160:163], a[84:87], a[36:39], v[160:163]
    global_load_lds_dwordx4 v244, s[52:53] offset:0
    v_mfma_f32_16x16x32_bf16 v[160:163], a[88:91], a[40:43], v[160:163]
    s_add_u32 m0, s26, 32
    v_add_u32 v241, s27, v241
    v_mfma_f32_16x16x32_bf16 v[160:163], a[92:95], a[44:47], v[160:163]
    global_load_lds_dwordx4 v244, s[52:53] offset:1024
    v_mfma_f32_16x16x32_bf16 v[164:167], a[96:99], a[44:47], -4.0
    s_add_u32 m0, s26, 64
    v_add_u32 v242, s27, v242
    v_mfma_f32_16x16x32_bf16 v[164:167], a[100:103], a[40:43], v[164:167]
    global_load_lds_dwordx4 v244, s[52:53] offset:2048
    v_mfma_f32_16x16x32_bf16 v[164:167], a[104:107], a[36:39], v[164:167]
    s_add_u32 m0, s26, 96
    v_exp_f32 v160, v160
    v_mfma_f32_16x16x32_bf16 v[164:167], a[108:111], a[32:35], v[164:167]
    global_load_lds_dwordx4 v244, s[52:53] offset:3072
    v_exp_f32 v161, v161
    v_accvgpr_read_b32 v248, a208
    v_accvgpr_read_b32 v249, a209
    v_add_f32 v248, v248, v249
    v_subrev_u32 v249, s42, v248
    v_rcp_f32 v248, v248
    v_cmp_le_u32 vcc, s43, v249
    v_mov_b32 v251, v248
    v_mov_b32_dpp v251, v248 row_ror:12 row_mask:0x2 bank_mask:0xf
    v_mov_b32_dpp v251, v248 row_ror:8 row_mask:0x4 bank_mask:0xf
    v_mov_b32_dpp v251, v248 row_ror:4 row_mask:0x8 bank_mask:0xf
    v_accvgpr_write_b32 a208, 0
    v_accvgpr_write_b32 a209, 0
    v_mov_b32_dpp v248, v251 row_newbcast:0 row_mask:0xf bank_mask:0xf
    v_mov_b32_dpp v249, v251 row_newbcast:1 row_mask:0xf bank_mask:0xf
    v_mov_b32_dpp v250, v251 row_newbcast:2 row_mask:0xf bank_mask:0xf
    v_mov_b32_dpp v251, v251 row_newbcast:3 row_mask:0xf bank_mask:0xf
    v_pk_mul_f32 v[0:1], v[0:1], v[248:249]
    v_pk_mul_f32 v[2:3], v[2:3], v[250:251]
    v_pk_mul_f32 v[4:5], v[4:5], v[248:249]
    v_pk_mul_f32 v[6:7], v[6:7], v[250:251]
    v_pk_mul_f32 v[8:9], v[8:9], v[248:249]
    v_pk_mul_f32 v[10:11], v[10:11], v[250:251]
    v_pk_mul_f32 v[12:13], v[12:13], v[248:249]
    v_pk_mul_f32 v[14:15], v[14:15], v[250:251]
    v_pk_mul_f32 v[16:17], v[16:17], v[248:249]
    v_pk_mul_f32 v[18:19], v[18:19], v[250:251]
    v_pk_mul_f32 v[20:21], v[20:21], v[248:249]
    v_pk_mul_f32 v[22:23], v[22:23], v[250:251]
    v_pk_mul_f32 v[24:25], v[24:25], v[248:249]
    v_pk_mul_f32 v[26:27], v[26:27], v[250:251]
    v_pk_mul_f32 v[28:29], v[28:29], v[248:249]
    v_pk_mul_f32 v[30:31], v[30:31], v[250:251]
    v_cvt_pk_bf16_f32 v0, v0, v4
    v_cvt_pk_bf16_f32 v4, v1, v5
    v_cvt_pk_bf16_f32 v1, v8, v12
    v_cvt_pk_bf16_f32 v5, v9, v13
    v_mfma_f32_16x16x32_bf16 v[32:35], v[184:187], a[144:147], v[32:35]
    s_add_u32 m0, s26, 16896
    v_exp_f32 v162, v162
    v_mfma_f32_16x16x32_bf16 v[32:35], v[188:191], a[176:179], v[32:35]
    s_waitcnt lgkmcnt(0)
    s_or_b64 s[44:45], s[44:45], vcc
    global_load_lds_dwordx4 v244, s[54:55] offset:0
    v_exp_f32 v163, v163
    v_lshlrev_b32 v248, 16, v232
    v_and_b32 v249, 0xffff0000, v232
    v_lshlrev_b32 v250, 16, v233
    v_and_b32 v251, 0xffff0000, v233
    v_pk_mul_f32 v[248:249], v[248:249], s[40:41]
    v_pk_mul_f32 v[250:251], v[250:251], s[40:41]
    v_cvt_pk_bf16_f32 v232, v248, v249
    v_cvt_pk_bf16_f32 v233, v250, v251
    v_accvgpr_write_b32 a32, v232
    v_accvgpr_write_b32 a33, v233
    v_lshlrev_b32 v248, 16, v234
    v_and_b32 v249, 0xffff0000, v234
    v_lshlrev_b32 v250, 16, v235
    v_and_b32 v251, 0xffff0000, v235
    v_pk_mul_f32 v[248:249], v[248:249], s[40:41]
    v_pk_mul_f32 v[250:251], v[250:251], s[40:41]
    v_cvt_pk_bf16_f32 v234, v248, v249
    v_cvt_pk_bf16_f32 v235, v250, v251
    v_accvgpr_write_b32 a34, v234
    v_accvgpr_write_b32 a35, v235
    v_mfma_f32_16x16x32_bf16 v[36:39], v[184:187], a[148:151], v[36:39]
    s_add_u32 m0, s26, 16912
    ds_read_b128 v[232:235], v245 offset:1216
    v_cvt_pk_bf16_f32 v176, v160, v161
    v_cvt_pk_bf16_f32 v177, v162, v163
    v_lshlrev_b32 v248, 16, v236
    v_and_b32 v249, 0xffff0000, v236
    v_lshlrev_b32 v250, 16, v237
    v_and_b32 v251, 0xffff0000, v237
    v_pk_mul_f32 v[248:249], v[248:249], s[40:41]
    v_pk_mul_f32 v[250:251], v[250:251], s[40:41]
    v_cvt_pk_bf16_f32 v236, v248, v249
    v_cvt_pk_bf16_f32 v237, v250, v251
    v_accvgpr_write_b32 a36, v236
    v_accvgpr_write_b32 a37, v237
    v_lshlrev_b32 v248, 16, v238
    v_and_b32 v249, 0xffff0000, v238
    v_lshlrev_b32 v250, 16, v239
    v_and_b32 v251, 0xffff0000, v239
    v_pk_mul_f32 v[248:249], v[248:249], s[40:41]
    v_pk_mul_f32 v[250:251], v[250:251], s[40:41]
    v_cvt_pk_bf16_f32 v238, v248, v249
    v_cvt_pk_bf16_f32 v239, v250, v251
    v_accvgpr_write_b32 a38, v238
    v_accvgpr_write_b32 a39, v239
    v_mfma_f32_16x16x32_bf16 v[36:39], v[188:191], a[180:183], v[36:39]
    ds_read_b128 v[236:239], v245 offset:1280
    global_load_lds_dwordx4 v244, s[54:55] offset:1024
    v_exp_f32 v164, v164
    v_mfma_f32_16x16x32_bf16 v[40:43], v[184:187], a[152:155], v[40:43]
    s_add_u32 m0, s26, 16928
    ds_write_b64 v246, v[0:1] offset:1088
    v_exp_f32 v165, v165
    v_cvt_pk_bf16_f32 v2, v2, v6
    v_cvt_pk_bf16_f32 v6, v3, v7
    v_mfma_f32_16x16x32_bf16 v[40:43], v[188:191], a[184:187], v[40:43]
    s_waitcnt lgkmcnt(2)
    global_load_lds_dwordx4 v244, s[54:55] offset:2048
    ds_write_b64 v246, v[4:5] offset:2176
    v_exp_f32 v166, v166
    v_lshlrev_b32 v248, 16, v232
    v_and_b32 v249, 0xffff0000, v232
    v_lshlrev_b32 v250, 16, v233
    v_and_b32 v251, 0xffff0000, v233
    v_pk_mul_f32 v[248:249], v[248:249], s[40:41]
    v_pk_mul_f32 v[250:251], v[250:251], s[40:41]
    v_cvt_pk_bf16_f32 v232, v248, v249
    v_cvt_pk_bf16_f32 v233, v250, v251
    v_accvgpr_write_b32 a40, v232
    v_accvgpr_write_b32 a41, v233
    v_lshlrev_b32 v248, 16, v234
    v_and_b32 v249, 0xffff0000, v234
    v_lshlrev_b32 v250, 16, v235
    v_and_b32 v251, 0xffff0000, v235
    v_pk_mul_f32 v[248:249], v[248:249], s[40:41]
    v_pk_mul_f32 v[250:251], v[250:251], s[40:41]
    v_cvt_pk_bf16_f32 v234, v248, v249
    v_cvt_pk_bf16_f32 v235, v250, v251
    v_accvgpr_write_b32 a42, v234
    v_accvgpr_write_b32 a43, v235
    v_cvt_pk_bf16_f32 v3, v10, v14
    v_cvt_pk_bf16_f32 v7, v11, v15
    v_mfma_f32_16x16x32_bf16 v[44:47], v[184:187], a[156:159], v[44:47]
    s_add_u32 m0, s26, 16944
    ds_write_b64 v246, v[2:3] offset:3264
    v_exp_f32 v167, v167
    v_cvt_pk_bf16_f32 v16, v16, v20
    v_cvt_pk_bf16_f32 v20, v17, v21
    v_mfma_f32_16x16x32_bf16 v[44:47], v[188:191], a[188:191], v[44:47]
    s_waitcnt lgkmcnt(3)
    global_load_lds_dwordx4 v244, s[54:55] offset:3072
    ds_write_b64 v246, v[6:7] offset:4352
    v_cvt_pk_bf16_f32 v178, v164, v165
    v_cvt_pk_bf16_f32 v179, v166, v167
    v_lshlrev_b32 v248, 16, v236
    v_and_b32 v249, 0xffff0000, v236
    v_lshlrev_b32 v250, 16, v237
    v_and_b32 v251, 0xffff0000, v237
    v_pk_mul_f32 v[248:249], v[248:249], s[40:41]
    v_pk_mul_f32 v[250:251], v[250:251], s[40:41]
    v_cvt_pk_bf16_f32 v236, v248, v249
    v_cvt_pk_bf16_f32 v237, v250, v251
    v_accvgpr_write_b32 a44, v236
    v_accvgpr_write_b32 a45, v237
    v_lshlrev_b32 v248, 16, v238
    v_and_b32 v249, 0xffff0000, v238
    v_lshlrev_b32 v250, 16, v239
    v_and_b32 v251, 0xffff0000, v239
    v_pk_mul_f32 v[248:249], v[248:249], s[40:41]
    v_pk_mul_f32 v[250:251], v[250:251], s[40:41]
    v_cvt_pk_bf16_f32 v238, v248, v249
    v_cvt_pk_bf16_f32 v239, v250, v251
    v_accvgpr_write_b32 a46, v238
    v_accvgpr_write_b32 a47, v239
    v_cvt_pk_bf16_f32 v17, v24, v28
    v_cvt_pk_bf16_f32 v21, v25, v29
    v_mfma_f32_16x16x32_bf16 v[48:51], v[184:187], a[160:163], v[48:51]
    ds_write_b64 v246, v[16:17] offset:1216
    v_add_u32 v243, s27, v243
    v_cvt_pk_bf16_f32 v18, v18, v22
    v_cvt_pk_bf16_f32 v22, v19, v23
    v_mfma_f32_16x16x32_bf16 v[48:51], v[188:191], a[192:195], v[48:51]
    s_add_u32 s24, s24, 16384
    ds_write_b64 v246, v[20:21] offset:2304
    v_mfma_f32_16x16x32_bf16 v[52:55], v[184:187], a[164:167], v[52:55]
    s_and_b32 s24, s24, 0x3ffff
    v_cvt_pk_bf16_f32 v19, v26, v30
    v_cvt_pk_bf16_f32 v23, v27, v31
    v_mfma_f32_16x16x32_bf16 v[52:55], v[188:191], a[196:199], v[52:55]
    s_add_u32 s65, s25, s24
    ds_write_b64 v246, v[18:19] offset:3392
    v_mfma_f32_16x16x32_bf16 v[56:59], v[184:187], a[168:171], v[56:59]
    s_add_u32 s52, s8, s65
    s_addc_u32 s53, s9, 0
    ds_write_b64 v246, v[22:23] offset:4480
    v_mfma_f32_16x16x32_bf16 v[56:59], v[188:191], a[200:203], v[56:59]
    s_add_u32 s54, s12, s65
    s_addc_u32 s55, s13, 0
    v_mfma_f32_16x16x32_bf16 v[60:63], v[184:187], a[172:175], v[60:63]
    s_add_u32 s26, s26, s27
    ds_read_b64_tr_b16 v[0:1], v252 offset:1088
    ds_read_b64_tr_b16 v[2:3], v252 offset:1120
    v_mfma_f32_16x16x32_bf16 v[60:63], v[188:191], a[204:207], v[60:63]
    s_cmp_eq_u32 s26, s48
    s_cselect_b32 s27, s58, s59
    ds_read_b64_tr_b16 v[4:5], v252 offset:2176
    ds_read_b64_tr_b16 v[6:7], v252 offset:2208
    v_smfmac_f32_16x16x64_bf16 a[212:215], a[228:231], v[184:191], v247
    ds_read_b64_tr_b16 v[8:9], v252 offset:3264
    ds_read_b64_tr_b16 v[10:11], v252 offset:3296
    v_mfma_f32_16x16x32_bf16 v[160:163], a[80:83], a[48:51], -4.0
    ds_read_b64_tr_b16 v[12:13], v252 offset:4352
    ds_read_b64_tr_b16 v[14:15], v252 offset:4384
    v_mfma_f32_16x16x32_bf16 v[160:163], a[84:87], a[52:55], v[160:163]
    v_mfma_f32_16x16x32_bf16 v[160:163], a[88:91], a[56:59], v[160:163]
    v_accvgpr_read_b32 v248, a212
    v_accvgpr_read_b32 v249, a213
    v_add_f32 v248, v248, v249
    v_subrev_u32 v249, s42, v248
    v_rcp_f32 v248, v248
    v_cmp_le_u32 vcc, s43, v249
    v_mov_b32 v251, v248
    v_mov_b32_dpp v251, v248 row_ror:12 row_mask:0x2 bank_mask:0xf
    v_mov_b32_dpp v251, v248 row_ror:8 row_mask:0x4 bank_mask:0xf
    v_mov_b32_dpp v251, v248 row_ror:4 row_mask:0x8 bank_mask:0xf
    v_accvgpr_write_b32 a212, 0
    v_accvgpr_write_b32 a213, 0
    v_mov_b32_dpp v248, v251 row_newbcast:0 row_mask:0xf bank_mask:0xf
    v_mov_b32_dpp v249, v251 row_newbcast:1 row_mask:0xf bank_mask:0xf
    v_mov_b32_dpp v250, v251 row_newbcast:2 row_mask:0xf bank_mask:0xf
    v_mov_b32_dpp v251, v251 row_newbcast:3 row_mask:0xf bank_mask:0xf
    v_pk_mul_f32 v[32:33], v[32:33], v[248:249]
    v_pk_mul_f32 v[34:35], v[34:35], v[250:251]
    v_pk_mul_f32 v[36:37], v[36:37], v[248:249]
    v_pk_mul_f32 v[38:39], v[38:39], v[250:251]
    v_pk_mul_f32 v[40:41], v[40:41], v[248:249]
    v_pk_mul_f32 v[42:43], v[42:43], v[250:251]
    v_pk_mul_f32 v[44:45], v[44:45], v[248:249]
    v_pk_mul_f32 v[46:47], v[46:47], v[250:251]
    v_pk_mul_f32 v[48:49], v[48:49], v[248:249]
    v_pk_mul_f32 v[50:51], v[50:51], v[250:251]
    v_pk_mul_f32 v[52:53], v[52:53], v[248:249]
    v_pk_mul_f32 v[54:55], v[54:55], v[250:251]
    v_pk_mul_f32 v[56:57], v[56:57], v[248:249]
    v_pk_mul_f32 v[58:59], v[58:59], v[250:251]
    v_pk_mul_f32 v[60:61], v[60:61], v[248:249]
    v_pk_mul_f32 v[62:63], v[62:63], v[250:251]
    v_mfma_f32_16x16x32_bf16 v[160:163], a[92:95], a[60:63], v[160:163]
    s_or_b64 s[44:45], s[44:45], vcc
    v_cvt_pk_bf16_f32 v32, v32, v36
    v_cvt_pk_bf16_f32 v36, v33, v37
    v_mfma_f32_16x16x32_bf16 v[164:167], a[96:99], a[60:63], -4.0
    v_cvt_pk_bf16_f32 v33, v40, v44
    v_cvt_pk_bf16_f32 v37, v41, v45
    v_mfma_f32_16x16x32_bf16 v[164:167], a[100:103], a[56:59], v[164:167]
    v_mfma_f32_16x16x32_bf16 v[164:167], a[104:107], a[52:55], v[164:167]
    v_exp_f32 v160, v160
    v_mfma_f32_16x16x32_bf16 v[164:167], a[108:111], a[48:51], v[164:167]
    v_exp_f32 v161, v161
    v_mfma_f32_16x16x32_bf16 v[168:171], a[112:115], a[48:51], -4.0
    v_exp_f32 v162, v162
    v_mfma_f32_16x16x32_bf16 v[168:171], a[116:119], a[52:55], v[168:171]
    v_exp_f32 v163, v163
    v_mfma_f32_16x16x32_bf16 v[168:171], a[120:123], a[56:59], v[168:171]
    v_cvt_pk_bf16_f32 v184, v160, v161
    v_cvt_pk_bf16_f32 v185, v162, v163
    v_mfma_f32_16x16x32_bf16 v[168:171], a[124:127], a[60:63], v[168:171]
    v_exp_f32 v164, v164
    v_mfma_f32_16x16x32_bf16 v[172:175], a[128:131], a[60:63], -4.0
    v_exp_f32 v165, v165
    v_mfma_f32_16x16x32_bf16 v[172:175], a[132:135], a[56:59], v[172:175]
    v_exp_f32 v166, v166
    v_mfma_f32_16x16x32_bf16 v[172:175], a[136:139], a[52:55], v[172:175]
    v_exp_f32 v167, v167
    v_mfma_f32_16x16x32_bf16 v[172:175], a[140:143], a[48:51], v[172:175]
    v_cvt_pk_bf16_f32 v186, v164, v165
    v_cvt_pk_bf16_f32 v187, v166, v167
    v_mfma_f32_16x16x32_bf16 v[64:67], v[176:179], a[144:147], v[64:67]
    ds_read_b128 a[48:51], v245 offset:9792
    v_exp_f32 v168, v168
    v_mfma_f32_16x16x32_bf16 v[68:71], v[176:179], a[148:151], v[68:71]
    ds_read_b128 a[52:55], v245 offset:9856
    v_exp_f32 v169, v169
    v_mfma_f32_16x16x32_bf16 v[72:75], v[176:179], a[152:155], v[72:75]
    ds_read_b128 a[56:59], v245 offset:9920
    v_exp_f32 v170, v170
    v_mfma_f32_16x16x32_bf16 v[76:79], v[176:179], a[156:159], v[76:79]
    v_exp_f32 v171, v171
    v_mfma_f32_16x16x32_bf16 v[80:83], v[176:179], a[160:163], v[80:83]
    v_cvt_pk_bf16_f32 v188, v168, v169
    v_cvt_pk_bf16_f32 v189, v170, v171
    v_mfma_f32_16x16x32_bf16 v[84:87], v[176:179], a[164:167], v[84:87]
    v_exp_f32 v172, v172
    v_mfma_f32_16x16x32_bf16 v[88:91], v[176:179], a[168:171], v[88:91]
    v_exp_f32 v173, v173
    v_mfma_f32_16x16x32_bf16 v[92:95], v[176:179], a[172:175], v[92:95]
    ds_read_b128 a[60:63], v245 offset:9984
    v_cvt_pk_bf16_f32 v190, v172, v173
    v_mfma_f32_16x16x32_bf16 a[216:219], a[232:235], v[176:179], a[216:219]
    v_mfma_f32_16x16x32_bf16 v[160:163], a[80:83], a[64:67], -4.0
    v_exp_f32 v174, v174
    v_mfma_f32_16x16x32_bf16 v[160:163], a[84:87], a[68:71], v[160:163]
    v_exp_f32 v175, v175
    v_mfma_f32_16x16x32_bf16 v[160:163], a[88:91], a[72:75], v[160:163]
    ds_read_b128 a[80:83], v240 offset:0
    v_cvt_pk_bf16_f32 v191, v174, v175
    v_mfma_f32_16x16x32_bf16 v[160:163], a[92:95], a[76:79], v[160:163]
    ds_read_b128 a[84:87], v240 offset:64
    v_mfma_f32_16x16x32_bf16 v[164:167], a[96:99], a[76:79], -4.0
    ds_read_b128 a[88:91], v240 offset:128
    v_mfma_f32_16x16x32_bf16 v[164:167], a[100:103], a[72:75], v[164:167]
    ds_read_b128 a[92:95], v240 offset:192
    v_mfma_f32_16x16x32_bf16 v[164:167], a[104:107], a[68:71], v[164:167]
    v_exp_f32 v160, v160
    v_mfma_f32_16x16x32_bf16 v[164:167], a[108:111], a[64:67], v[164:167]
    s_waitcnt lgkmcnt(4)
    buffer_store_dwordx4 v[0:3], v244, s[16:19], s30 offen offset:0
    v_exp_f32 v161, v161
    v_mfma_f32_16x16x32_bf16 v[168:171], a[112:115], a[64:67], -4.0
    ds_read_b128 a[96:99], v240 offset:704
    v_cvt_pk_bf16_f32 v192, v160, v161
    v_mfma_f32_16x16x32_bf16 v[168:171], a[116:119], a[68:71], v[168:171]
    v_exp_f32 v162, v162
    v_mfma_f32_16x16x32_bf16 v[168:171], a[120:123], a[72:75], v[168:171]
    v_exp_f32 v163, v163
    v_mfma_f32_16x16x32_bf16 v[168:171], a[124:127], a[76:79], v[168:171]
    ds_read_b128 a[100:103], v240 offset:640
    buffer_store_dwordx4 v[4:7], v244, s[16:19], s30 offen offset:1024
    v_cvt_pk_bf16_f32 v193, v162, v163
    v_mfma_f32_16x16x32_bf16 v[172:175], a[128:131], a[76:79], -4.0
    v_exp_f32 v164, v164
    v_mfma_f32_16x16x32_bf16 v[172:175], a[132:135], a[72:75], v[172:175]
    ds_write_b64 v246, v[32:33] offset:1088
    v_exp_f32 v165, v165
    v_cvt_pk_bf16_f32 v34, v34, v38
    v_cvt_pk_bf16_f32 v38, v35, v39
    v_mfma_f32_16x16x32_bf16 v[172:175], a[136:139], a[68:71], v[172:175]
    ds_read_b128 a[104:107], v240 offset:576
    ds_write_b64 v246, v[36:37] offset:2176
    v_cvt_pk_bf16_f32 v194, v164, v165
    v_cvt_pk_bf16_f32 v35, v42, v46
    v_cvt_pk_bf16_f32 v39, v43, v47
    v_mfma_f32_16x16x32_bf16 v[172:175], a[140:143], a[64:67], v[172:175]
    buffer_store_dwordx4 v[8:11], v244, s[16:19], s30 offen offset:2048
    ds_write_b64 v246, v[34:35] offset:3264
    v_exp_f32 v166, v166
    v_cvt_pk_bf16_f32 v48, v48, v52
    v_cvt_pk_bf16_f32 v52, v49, v53
    v_mfma_f32_16x16x32_bf16 v[96:99], v[184:187], a[144:147], v[96:99]
    ds_write_b64 v246, v[38:39] offset:4352
    v_exp_f32 v167, v167
    v_cvt_pk_bf16_f32 v49, v56, v60
    v_cvt_pk_bf16_f32 v53, v57, v61
    v_mfma_f32_16x16x32_bf16 v[96:99], v[188:191], a[176:179], v[96:99]
    ds_read_b128 a[108:111], v240 offset:512
    ds_write_b64 v246, v[48:49] offset:1216
    v_cvt_pk_bf16_f32 v195, v166, v167
    v_accvgpr_read_b32 v255, a216
    v_accvgpr_read_b32 v253, a217
    v_add_f32 v255, v255, v253
    v_add_u32 v253, s28, v244
    v_cvt_pk_bf16_f32 v50, v50, v54
    v_cvt_pk_bf16_f32 v54, v51, v55
    v_mfma_f32_16x16x32_bf16 v[100:103], v[184:187], a[148:151], v[100:103]
    ds_write_b32 v253, v255 offset:14144
    v_exp_f32 v168, v168
    s_cmp_lg_u32 s29, 0
    v_mfma_f32_16x16x32_bf16 v[100:103], v[188:191], a[180:183], v[100:103]
    s_cbranch_scc1 L_parr1a0o
    ds_write_b128 v253, v[80:83] offset:9792
    v_exp_f32 v169, v169
    v_mfma_f32_16x16x32_bf16 v[104:107], v[184:187], a[152:155], v[104:107]
    ds_read_b128 a[112:115], v241 offset:0
    v_cvt_pk_bf16_f32 v196, v168, v169
    v_mfma_f32_16x16x32_bf16 v[104:107], v[188:191], a[184:187], v[104:107]
    ds_write_b128 v253, v[84:87] offset:10816
    v_exp_f32 v170, v170
    v_mfma_f32_16x16x32_bf16 v[108:111], v[184:187], a[156:159], v[108:111]
    v_exp_f32 v171, v171
    v_mfma_f32_16x16x32_bf16 v[108:111], v[188:191], a[188:191], v[108:111]
    ds_read_b128 a[116:119], v241 offset:64
    ds_write_b128 v253, v[88:91] offset:11840
    v_cvt_pk_bf16_f32 v197, v170, v171
    v_mfma_f32_16x16x32_bf16 v[112:115], v[184:187], a[160:163], v[112:115]
    v_exp_f32 v172, v172
    v_mfma_f32_16x16x32_bf16 v[112:115], v[188:191], a[192:195], v[112:115]
    ds_write_b128 v253, v[92:95] offset:12864
    v_exp_f32 v173, v173
    v_mfma_f32_16x16x32_bf16 v[116:119], v[184:187], a[164:167], v[116:119]
    s_branch L_parr1a0e
L_parr1a0o:
    ds_write_b128 v253, v[64:67] offset:9792
    v_exp_f32 v169, v169
    v_mfma_f32_16x16x32_bf16 v[104:107], v[184:187], a[152:155], v[104:107]
    ds_read_b128 a[112:115], v241 offset:0
    v_cvt_pk_bf16_f32 v196, v168, v169
    v_mfma_f32_16x16x32_bf16 v[104:107], v[188:191], a[184:187], v[104:107]
    ds_write_b128 v253, v[68:71] offset:10816
    v_exp_f32 v170, v170
    v_mfma_f32_16x16x32_bf16 v[108:111], v[184:187], a[156:159], v[108:111]
    v_exp_f32 v171, v171
    v_mfma_f32_16x16x32_bf16 v[108:111], v[188:191], a[188:191], v[108:111]
    ds_read_b128 a[116:119], v241 offset:64
    ds_write_b128 v253, v[72:75] offset:11840
    v_cvt_pk_bf16_f32 v197, v170, v171
    v_mfma_f32_16x16x32_bf16 v[112:115], v[184:187], a[160:163], v[112:115]
    v_exp_f32 v172, v172
    v_mfma_f32_16x16x32_bf16 v[112:115], v[188:191], a[192:195], v[112:115]
    ds_write_b128 v253, v[76:79] offset:12864
    v_exp_f32 v173, v173
    v_mfma_f32_16x16x32_bf16 v[116:119], v[184:187], a[164:167], v[116:119]
L_parr1a0e:
    ds_read_b128 a[120:123], v241 offset:128
    v_cvt_pk_bf16_f32 v198, v172, v173
    v_add_u32 v253, s3, v253
    v_mfma_f32_16x16x32_bf16 v[116:119], v[188:191], a[196:199], v[116:119]
    buffer_store_dwordx4 v[12:15], v244, s[16:19], s30 offen offset:3072
    ds_write_b64 v246, v[52:53] offset:2304
    v_exp_f32 v174, v174
    v_cvt_pk_bf16_f32 v51, v58, v62
    v_cvt_pk_bf16_f32 v55, v59, v63
    v_mfma_f32_16x16x32_bf16 v[120:123], v[184:187], a[168:171], v[120:123]
    ds_write_b64 v246, v[50:51] offset:3392
    v_exp_f32 v175, v175
    v_mfma_f32_16x16x32_bf16 v[120:123], v[188:191], a[200:203], v[120:123]
    ds_read_b128 a[124:127], v241 offset:192
    ds_write_b64 v246, v[54:55] offset:4480
    v_cvt_pk_bf16_f32 v199, v174, v175
    v_mfma_f32_16x16x32_bf16 v[124:127], v[184:187], a[172:175], v[124:127]
    ds_read_b128 a[128:131], v241 offset:704
    v_mfma_f32_16x16x32_bf16 v[124:127], v[188:191], a[204:207], v[124:127]
    ds_read_b128 a[132:135], v241 offset:640
    ds_read_b64_tr_b16 v[32:33], v252 offset:1088
    ds_read_b64_tr_b16 v[34:35], v252 offset:1120
    v_smfmac_f32_16x16x64_bf16 a[220:223], a[228:231], v[184:191], v247
    s_waitcnt lgkmcnt(10)
    ds_read_b128 a[136:139], v241 offset:576
    ds_read_b64_tr_b16 v[36:37], v252 offset:2176
    ds_read_b64_tr_b16 v[38:39], v252 offset:2208
    v_mfma_f32_16x16x32_bf16 v[160:163], a[80:83], v[200:203], -4.0
    ds_read_b128 a[140:143], v241 offset:512
    ds_read_b64_tr_b16 v[40:41], v252 offset:3264
    ds_read_b64_tr_b16 v[42:43], v252 offset:3296
    v_mfma_f32_16x16x32_bf16 v[160:163], a[84:87], v[204:207], v[160:163]
    ds_read_b64_tr_b16 v[44:45], v252 offset:4352
    ds_read_b64_tr_b16 v[46:47], v252 offset:4384
    v_mfma_f32_16x16x32_bf16 v[160:163], a[88:91], v[208:211], v[160:163]
    v_accvgpr_read_b32 v248, a220
    v_accvgpr_read_b32 v249, a221
    v_add_f32 v248, v248, v249
    v_subrev_u32 v249, s42, v248
    v_rcp_f32 v248, v248
    v_cmp_le_u32 vcc, s43, v249
    v_mov_b32 v251, v248
    v_mov_b32_dpp v251, v248 row_ror:12 row_mask:0x2 bank_mask:0xf
    v_mov_b32_dpp v251, v248 row_ror:8 row_mask:0x4 bank_mask:0xf
    v_mov_b32_dpp v251, v248 row_ror:4 row_mask:0x8 bank_mask:0xf
    v_accvgpr_write_b32 a220, 0
    v_accvgpr_write_b32 a221, 0
    v_mov_b32_dpp v248, v251 row_newbcast:0 row_mask:0xf bank_mask:0xf
    v_mov_b32_dpp v249, v251 row_newbcast:1 row_mask:0xf bank_mask:0xf
    v_mov_b32_dpp v250, v251 row_newbcast:2 row_mask:0xf bank_mask:0xf
    v_mov_b32_dpp v251, v251 row_newbcast:3 row_mask:0xf bank_mask:0xf
    v_pk_mul_f32 v[96:97], v[96:97], v[248:249]
    v_pk_mul_f32 v[98:99], v[98:99], v[250:251]
    v_pk_mul_f32 v[100:101], v[100:101], v[248:249]
    v_pk_mul_f32 v[102:103], v[102:103], v[250:251]
    v_pk_mul_f32 v[104:105], v[104:105], v[248:249]
    v_pk_mul_f32 v[106:107], v[106:107], v[250:251]
    v_pk_mul_f32 v[108:109], v[108:109], v[248:249]
    v_pk_mul_f32 v[110:111], v[110:111], v[250:251]
    v_pk_mul_f32 v[112:113], v[112:113], v[248:249]
    v_pk_mul_f32 v[114:115], v[114:115], v[250:251]
    v_pk_mul_f32 v[116:117], v[116:117], v[248:249]
    v_pk_mul_f32 v[118:119], v[118:119], v[250:251]
    v_pk_mul_f32 v[120:121], v[120:121], v[248:249]
    v_pk_mul_f32 v[122:123], v[122:123], v[250:251]
    v_pk_mul_f32 v[124:125], v[124:125], v[248:249]
    v_pk_mul_f32 v[126:127], v[126:127], v[250:251]
    v_cvt_pk_bf16_f32 v96, v96, v100
    v_cvt_pk_bf16_f32 v100, v97, v101
    v_cvt_pk_bf16_f32 v97, v104, v108
    v_cvt_pk_bf16_f32 v101, v105, v109
    v_mfma_f32_16x16x32_bf16 v[160:163], a[92:95], v[212:215], v[160:163]
    s_or_b64 s[44:45], s[44:45], vcc
    ds_write_b64 v246, v[96:97] offset:1088
    v_cvt_pk_bf16_f32 v98, v98, v102
    v_cvt_pk_bf16_f32 v102, v99, v103
    v_mfma_f32_16x16x32_bf16 v[164:167], a[96:99], v[212:215], -4.0
    ds_write_b64 v246, v[100:101] offset:2176
    v_cvt_pk_bf16_f32 v99, v106, v110
    v_cvt_pk_bf16_f32 v103, v107, v111
    v_mfma_f32_16x16x32_bf16 v[164:167], a[100:103], v[208:211], v[164:167]
    ds_write_b64 v246, v[98:99] offset:3264
    v_cvt_pk_bf16_f32 v112, v112, v116
    v_cvt_pk_bf16_f32 v116, v113, v117
    v_mfma_f32_16x16x32_bf16 v[164:167], a[104:107], v[204:207], v[164:167]
    ds_write_b64 v246, v[102:103] offset:4352
    v_exp_f32 v160, v160
    v_cvt_pk_bf16_f32 v113, v120, v124
    v_cvt_pk_bf16_f32 v117, v121, v125
    v_mfma_f32_16x16x32_bf16 v[164:167], a[108:111], v[200:203], v[164:167]
    s_waitcnt lgkmcnt(12)
    buffer_store_dwordx4 v[32:35], v244, s[16:19], s31 offen offset:0
    ds_write_b64 v246, v[112:113] offset:1216
    v_exp_f32 v161, v161
    v_cvt_pk_bf16_f32 v114, v114, v118
    v_cvt_pk_bf16_f32 v118, v115, v119
    v_mfma_f32_16x16x32_bf16 v[168:171], a[112:115], v[200:203], -4.0
    ds_write_b64 v246, v[116:117] offset:2304
    v_exp_f32 v162, v162
    v_cvt_pk_bf16_f32 v115, v122, v126
    v_cvt_pk_bf16_f32 v119, v123, v127
    v_mfma_f32_16x16x32_bf16 v[168:171], a[116:119], v[204:207], v[168:171]
    ds_write_b64 v246, v[114:115] offset:3392
    v_exp_f32 v163, v163
    v_mfma_f32_16x16x32_bf16 v[168:171], a[120:123], v[208:211], v[168:171]
    ds_write_b64 v246, v[118:119] offset:4480
    v_cvt_pk_bf16_f32 v176, v160, v161
    v_cvt_pk_bf16_f32 v177, v162, v163
    v_mfma_f32_16x16x32_bf16 v[168:171], a[124:127], v[212:215], v[168:171]
    s_waitcnt lgkmcnt(8)
    buffer_store_dwordx4 v[36:39], v244, s[16:19], s31 offen offset:1024
    v_exp_f32 v164, v164
    v_mfma_f32_16x16x32_bf16 v[172:175], a[128:131], v[212:215], -4.0
    ds_read_b64_tr_b16 v[96:97], v252 offset:1088
    ds_read_b64_tr_b16 v[98:99], v252 offset:1120
    v_exp_f32 v165, v165
    v_mfma_f32_16x16x32_bf16 v[172:175], a[132:135], v[208:211], v[172:175]
    ds_read_b64_tr_b16 v[100:101], v252 offset:2176
    ds_read_b64_tr_b16 v[102:103], v252 offset:2208
    v_exp_f32 v166, v166
    v_mfma_f32_16x16x32_bf16 v[172:175], a[136:139], v[204:207], v[172:175]
    ds_read_b64_tr_b16 v[104:105], v252 offset:3264
    ds_read_b64_tr_b16 v[106:107], v252 offset:3296
    v_exp_f32 v167, v167
    v_mfma_f32_16x16x32_bf16 v[172:175], a[140:143], v[200:203], v[172:175]
    buffer_store_dwordx4 v[40:43], v244, s[16:19], s31 offen offset:2048
    v_cvt_pk_bf16_f32 v178, v164, v165
    v_cvt_pk_bf16_f32 v179, v166, v167
    v_mfma_f32_16x16x32_bf16 v[128:131], v[192:195], a[144:147], v[128:131]
    ds_read_b64_tr_b16 a[144:145], v242 offset:0
    ds_read_b64_tr_b16 a[146:147], v242 offset:512
    ds_read_b64_tr_b16 v[108:109], v252 offset:4352
    ds_read_b64_tr_b16 v[110:111], v252 offset:4384
    v_mfma_f32_16x16x32_bf16 v[128:131], v[196:199], a[176:179], v[128:131]
    v_exp_f32 v168, v168
    v_mfma_f32_16x16x32_bf16 v[132:135], v[192:195], a[148:151], v[132:135]
    ds_read_b64_tr_b16 a[176:177], v243 offset:0
    ds_read_b64_tr_b16 a[178:179], v243 offset:512
    v_mfma_f32_16x16x32_bf16 v[132:135], v[196:199], a[180:183], v[132:135]
    buffer_store_dwordx4 v[44:47], v244, s[16:19], s31 offen offset:3072
    v_exp_f32 v169, v169
    v_mfma_f32_16x16x32_bf16 v[136:139], v[192:195], a[152:155], v[136:139]
    ds_read_b64_tr_b16 a[148:149], v242 offset:16
    ds_read_b64_tr_b16 a[150:151], v242 offset:528
    v_mfma_f32_16x16x32_bf16 v[136:139], v[196:199], a[184:187], v[136:139]
    v_exp_f32 v170, v170
    v_mfma_f32_16x16x32_bf16 v[140:143], v[192:195], a[156:159], v[140:143]
L_pad1_5:
    s_cbranch_execz L_ret1
    ds_read_b64_tr_b16 a[180:181], v243 offset:16
    ds_read_b64_tr_b16 a[182:183], v243 offset:528
    v_mfma_f32_16x16x32_bf16 v[140:143], v[196:199], a[188:191], v[140:143]
    s_waitcnt lgkmcnt(10)
    buffer_store_dwordx4 v[96:99], v244, s[16:19], s33 offen offset:0
    v_exp_f32 v171, v171
    v_mfma_f32_16x16x32_bf16 v[144:147], v[192:195], a[160:163], v[144:147]
    ds_read_b64_tr_b16 a[152:153], v242 offset:32
    ds_read_b64_tr_b16 a[154:155], v242 offset:544
    v_mfma_f32_16x16x32_bf16 v[144:147], v[196:199], a[192:195], v[144:147]
    v_exp_f32 v172, v172
    v_mfma_f32_16x16x32_bf16 v[148:151], v[192:195], a[164:167], v[148:151]
    ds_read_b64_tr_b16 a[184:185], v243 offset:32
    ds_read_b64_tr_b16 a[186:187], v243 offset:544
    v_mfma_f32_16x16x32_bf16 v[148:151], v[196:199], a[196:199], v[148:151]
    buffer_store_dwordx4 v[100:103], v244, s[16:19], s33 offen offset:1024
    v_exp_f32 v173, v173
    v_mfma_f32_16x16x32_bf16 v[152:155], v[192:195], a[168:171], v[152:155]
    ds_read_b64_tr_b16 a[156:157], v242 offset:48
    ds_read_b64_tr_b16 a[158:159], v242 offset:560
    v_mfma_f32_16x16x32_bf16 v[152:155], v[196:199], a[200:203], v[152:155]
    v_exp_f32 v174, v174
    v_mfma_f32_16x16x32_bf16 v[156:159], v[192:195], a[172:175], v[156:159]
    ds_read_b64_tr_b16 a[188:189], v243 offset:48
    ds_read_b64_tr_b16 a[190:191], v243 offset:560
    v_mfma_f32_16x16x32_bf16 v[156:159], v[196:199], a[204:207], v[156:159]
    v_exp_f32 v175, v175
    v_smfmac_f32_16x16x64_bf16 a[224:227], a[228:231], v[192:199], v247
    buffer_store_dwordx4 v[104:107], v244, s[16:19], s33 offen offset:2048
    v_mfma_f32_16x16x32_bf16 v[160:163], a[80:83], v[216:219], -4.0
    ds_read_b64_tr_b16 a[160:161], v242 offset:128
    ds_read_b64_tr_b16 a[162:163], v242 offset:640
    v_mfma_f32_16x16x32_bf16 v[160:163], a[84:87], v[220:223], v[160:163]
    v_cvt_pk_bf16_f32 v180, v168, v169
    v_cvt_pk_bf16_f32 v181, v170, v171
    v_mfma_f32_16x16x32_bf16 v[160:163], a[88:91], v[224:227], v[160:163]
    ds_read_b64_tr_b16 a[192:193], v243 offset:128
    ds_read_b64_tr_b16 a[194:195], v243 offset:640
    v_accvgpr_read_b32 v248, a224
    v_accvgpr_read_b32 v249, a225
    v_add_f32 v248, v248, v249
    v_subrev_u32 v249, s42, v248
    v_rcp_f32 v248, v248
    v_cmp_le_u32 vcc, s43, v249
    v_mov_b32 v251, v248
    v_mov_b32_dpp v251, v248 row_ror:12 row_mask:0x2 bank_mask:0xf
    v_mov_b32_dpp v251, v248 row_ror:8 row_mask:0x4 bank_mask:0xf
    v_mov_b32_dpp v251, v248 row_ror:4 row_mask:0x8 bank_mask:0xf
    v_accvgpr_write_b32 a224, 0
    v_accvgpr_write_b32 a225, 0
    v_mov_b32_dpp v248, v251 row_newbcast:0 row_mask:0xf bank_mask:0xf
    v_mov_b32_dpp v249, v251 row_newbcast:1 row_mask:0xf bank_mask:0xf
    v_mov_b32_dpp v250, v251 row_newbcast:2 row_mask:0xf bank_mask:0xf
    v_mov_b32_dpp v251, v251 row_newbcast:3 row_mask:0xf bank_mask:0xf
    v_pk_mul_f32 v[128:129], v[128:129], v[248:249]
    v_pk_mul_f32 v[130:131], v[130:131], v[250:251]
    v_pk_mul_f32 v[132:133], v[132:133], v[248:249]
    v_pk_mul_f32 v[134:135], v[134:135], v[250:251]
    v_pk_mul_f32 v[136:137], v[136:137], v[248:249]
    v_pk_mul_f32 v[138:139], v[138:139], v[250:251]
    v_pk_mul_f32 v[140:141], v[140:141], v[248:249]
    v_pk_mul_f32 v[142:143], v[142:143], v[250:251]
    v_pk_mul_f32 v[144:145], v[144:145], v[248:249]
    v_pk_mul_f32 v[146:147], v[146:147], v[250:251]
    v_pk_mul_f32 v[148:149], v[148:149], v[248:249]
    v_pk_mul_f32 v[150:151], v[150:151], v[250:251]
    v_pk_mul_f32 v[152:153], v[152:153], v[248:249]
    v_pk_mul_f32 v[154:155], v[154:155], v[250:251]
    v_pk_mul_f32 v[156:157], v[156:157], v[248:249]
    v_pk_mul_f32 v[158:159], v[158:159], v[250:251]
    v_cvt_pk_bf16_f32 v128, v128, v132
    v_cvt_pk_bf16_f32 v132, v129, v133
    v_cvt_pk_bf16_f32 v129, v136, v140
    v_cvt_pk_bf16_f32 v133, v137, v141
    v_mfma_f32_16x16x32_bf16 v[160:163], a[92:95], v[228:231], v[160:163]
    s_waitcnt lgkmcnt(8)
    s_or_b64 s[44:45], s[44:45], vcc
    buffer_store_dwordx4 v[108:111], v244, s[16:19], s33 offen offset:3072
    v_cvt_pk_bf16_f32 v182, v172, v173
    v_cvt_pk_bf16_f32 v183, v174, v175
    v_mfma_f32_16x16x32_bf16 v[164:167], a[96:99], v[228:231], -4.0
    ds_read_b64_tr_b16 a[164:165], v242 offset:144
    ds_read_b64_tr_b16 a[166:167], v242 offset:656
    ds_write_b64 v246, v[128:129] offset:1088
    v_cvt_pk_bf16_f32 v130, v130, v134
    v_cvt_pk_bf16_f32 v134, v131, v135
    v_mfma_f32_16x16x32_bf16 v[164:167], a[100:103], v[224:227], v[164:167]
    ds_write_b64 v246, v[132:133] offset:2176
    v_cvt_pk_bf16_f32 v131, v138, v142
    v_cvt_pk_bf16_f32 v135, v139, v143
    v_mfma_f32_16x16x32_bf16 v[164:167], a[104:107], v[220:223], v[164:167]
    ds_read_b64_tr_b16 a[196:197], v243 offset:144
    ds_read_b64_tr_b16 a[198:199], v243 offset:656
    ds_write_b64 v246, v[130:131] offset:3264
    v_cvt_pk_bf16_f32 v144, v144, v148
    v_cvt_pk_bf16_f32 v148, v145, v149
    v_mfma_f32_16x16x32_bf16 v[164:167], a[108:111], v[216:219], v[164:167]
    ds_write_b64 v246, v[134:135] offset:4352
    v_exp_f32 v160, v160
    v_cvt_pk_bf16_f32 v145, v152, v156
    v_cvt_pk_bf16_f32 v149, v153, v157
    v_mfma_f32_16x16x32_bf16 v[168:171], a[112:115], v[216:219], -4.0
    ds_read_b64_tr_b16 a[168:169], v242 offset:160
    ds_read_b64_tr_b16 a[170:171], v242 offset:672
    ds_write_b64 v246, v[144:145] offset:1216
    v_cvt_pk_bf16_f32 v146, v146, v150
    v_cvt_pk_bf16_f32 v150, v147, v151
    v_mfma_f32_16x16x32_bf16 v[168:171], a[116:119], v[220:223], v[168:171]
    ds_write_b64 v246, v[148:149] offset:2304
    v_exp_f32 v161, v161
    v_cvt_pk_bf16_f32 v147, v154, v158
    v_cvt_pk_bf16_f32 v151, v155, v159
    v_mfma_f32_16x16x32_bf16 v[168:171], a[120:123], v[224:227], v[168:171]
    ds_read_b64_tr_b16 a[200:201], v243 offset:160
    ds_read_b64_tr_b16 a[202:203], v243 offset:672
    ds_write_b64 v246, v[146:147] offset:3392
    v_mfma_f32_16x16x32_bf16 v[168:171], a[124:127], v[228:231], v[168:171]
    ds_write_b64 v246, v[150:151] offset:4480
    v_exp_f32 v162, v162
    v_mfma_f32_16x16x32_bf16 v[172:175], a[128:131], v[228:231], -4.0
    ds_read_b64_tr_b16 a[172:173], v242 offset:176
    ds_read_b64_tr_b16 a[174:175], v242 offset:688
    v_mfma_f32_16x16x32_bf16 v[172:175], a[132:135], v[224:227], v[172:175]
    ds_read_b64_tr_b16 v[128:129], v252 offset:1088
    ds_read_b64_tr_b16 v[130:131], v252 offset:1120
    v_exp_f32 v163, v163
    v_mfma_f32_16x16x32_bf16 v[172:175], a[136:139], v[220:223], v[172:175]
    ds_read_b64_tr_b16 a[204:205], v243 offset:176
    ds_read_b64_tr_b16 a[206:207], v243 offset:688
    ds_read_b64_tr_b16 v[132:133], v252 offset:2176
    ds_read_b64_tr_b16 v[134:135], v252 offset:2208
    v_mfma_f32_16x16x32_bf16 v[172:175], a[140:143], v[216:219], v[172:175]
    ds_read_b64_tr_b16 v[136:137], v252 offset:3264
    ds_read_b64_tr_b16 v[138:139], v252 offset:3296
    v_cvt_pk_bf16_f32 v184, v160, v161
    v_cvt_pk_bf16_f32 v185, v162, v163
    v_mfma_f32_16x16x32_bf16 v[0:3], v[176:179], a[144:147], 0
    ds_read_b64_tr_b16 v[140:141], v252 offset:4352
    ds_read_b64_tr_b16 v[142:143], v252 offset:4384
    v_exp_f32 v164, v164
    v_mfma_f32_16x16x32_bf16 v[0:3], v[180:183], a[176:179], v[0:3]
    v_exp_f32 v165, v165
    v_mfma_f32_16x16x32_bf16 v[4:7], v[176:179], a[148:151], 0
    v_exp_f32 v166, v166
    v_mfma_f32_16x16x32_bf16 v[4:7], v[180:183], a[180:183], v[4:7]
    v_exp_f32 v167, v167
    v_mfma_f32_16x16x32_bf16 v[8:11], v[176:179], a[152:155], 0
    v_cvt_pk_bf16_f32 v186, v164, v165
    v_cvt_pk_bf16_f32 v187, v166, v167
    v_mfma_f32_16x16x32_bf16 v[8:11], v[180:183], a[184:187], v[8:11]
    s_waitcnt lgkmcnt(10)
    v_exp_f32 v168, v168
    v_mfma_f32_16x16x32_bf16 v[12:15], v[176:179], a[156:159], 0
    s_waitcnt lgkmcnt(8)
    buffer_store_dwordx4 v[128:131], v244, s[16:19], s34 offen offset:0
    v_exp_f32 v169, v169
    v_mfma_f32_16x16x32_bf16 v[12:15], v[180:183], a[188:191], v[12:15]
    v_exp_f32 v170, v170
    v_mfma_f32_16x16x32_bf16 v[16:19], v[176:179], a[160:163], 0
    v_exp_f32 v171, v171
    v_mfma_f32_16x16x32_bf16 v[16:19], v[180:183], a[192:195], v[16:19]
    v_cvt_pk_bf16_f32 v188, v168, v169
    v_cvt_pk_bf16_f32 v189, v170, v171
    v_mfma_f32_16x16x32_bf16 v[20:23], v[176:179], a[164:167], 0
    s_waitcnt lgkmcnt(0)
    buffer_store_dwordx4 v[132:135], v244, s[16:19], s34 offen offset:1024
    v_exp_f32 v172, v172
    v_mfma_f32_16x16x32_bf16 v[20:23], v[180:183], a[196:199], v[20:23]
    v_exp_f32 v173, v173
    v_mfma_f32_16x16x32_bf16 v[24:27], v[176:179], a[168:171], 0
    v_exp_f32 v174, v174
    v_mfma_f32_16x16x32_bf16 v[24:27], v[180:183], a[200:203], v[24:27]
    v_exp_f32 v175, v175
    v_mfma_f32_16x16x32_bf16 v[28:31], v[176:179], a[172:175], 0
    buffer_store_dwordx4 v[136:139], v244, s[16:19], s34 offen offset:2048
    v_cvt_pk_bf16_f32 v190, v172, v173
    v_cvt_pk_bf16_f32 v191, v174, v175
    v_mfma_f32_16x16x32_bf16 v[28:31], v[180:183], a[204:207], v[28:31]
    s_waitcnt vmcnt(25)
    s_waitcnt lgkmcnt(15)
    v_smfmac_f32_16x16x64_bf16 a[208:211], a[228:231], v[176:183], v247
    s_barrier
    v_mfma_f32_16x16x32_bf16 v[160:163], a[80:83], a[32:35], -4.0
    s_add_u32 m0, s26, 0
    v_add_u32 v240, s27, v240
    v_mfma_f32_16x16x32_bf16 v[160:163], a[84:87], a[36:39], v[160:163]
    global_load_lds_dwordx4 v244, s[52:53] offset:0
    v_mfma_f32_16x16x32_bf16 v[160:163], a[88:91], a[40:43], v[160:163]
    s_add_u32 m0, s26, 32
    v_add_u32 v241, s27, v241
    v_mfma_f32_16x16x32_bf16 v[160:163], a[92:95], a[44:47], v[160:163]
    global_load_lds_dwordx4 v244, s[52:53] offset:1024
    v_mfma_f32_16x16x32_bf16 v[164:167], a[96:99], a[44:47], -4.0
    s_add_u32 m0, s26, 64
    v_add_u32 v242, s27, v242
    v_mfma_f32_16x16x32_bf16 v[164:167], a[100:103], a[40:43], v[164:167]
    global_load_lds_dwordx4 v244, s[52:53] offset:2048
    v_mfma_f32_16x16x32_bf16 v[164:167], a[104:107], a[36:39], v[164:167]
    s_add_u32 m0, s26, 96
    v_exp_f32 v160, v160
    v_mfma_f32_16x16x32_bf16 v[164:167], a[108:111], a[32:35], v[164:167]
    global_load_lds_dwordx4 v244, s[52:53] offset:3072
    v_exp_f32 v161, v161
    v_mfma_f32_16x16x32_bf16 v[168:171], a[112:115], a[32:35], -4.0
    s_add_u32 m0, s26, 16896
    v_exp_f32 v162, v162
    v_mfma_f32_16x16x32_bf16 v[168:171], a[116:119], a[36:39], v[168:171]
    global_load_lds_dwordx4 v244, s[54:55] offset:0
    v_exp_f32 v163, v163
    v_mfma_f32_16x16x32_bf16 v[168:171], a[120:123], a[40:43], v[168:171]
    s_add_u32 m0, s26, 16912
    v_cvt_pk_bf16_f32 v176, v160, v161
    v_cvt_pk_bf16_f32 v177, v162, v163
    v_mfma_f32_16x16x32_bf16 v[168:171], a[124:127], a[44:47], v[168:171]
    global_load_lds_dwordx4 v244, s[54:55] offset:1024
    v_exp_f32 v164, v164
    v_mfma_f32_16x16x32_bf16 v[172:175], a[128:131], a[44:47], -4.0
    s_add_u32 m0, s26, 16928
    v_exp_f32 v165, v165
    v_mfma_f32_16x16x32_bf16 v[172:175], a[132:135], a[40:43], v[172:175]
    global_load_lds_dwordx4 v244, s[54:55] offset:2048
    v_exp_f32 v166, v166
    v_mfma_f32_16x16x32_bf16 v[172:175], a[136:139], a[36:39], v[172:175]
    s_add_u32 m0, s26, 16944
    v_exp_f32 v167, v167
    v_mfma_f32_16x16x32_bf16 v[172:175], a[140:143], a[32:35], v[172:175]
    global_load_lds_dwordx4 v244, s[54:55] offset:3072
    v_cvt_pk_bf16_f32 v178, v164, v165
    v_cvt_pk_bf16_f32 v179, v166, v167
    v_mfma_f32_16x16x32_bf16 v[32:35], v[184:187], a[144:147], 0
    v_exp_f32 v168, v168
    s_cmp_lg_u32 s29, 0
    v_mfma_f32_16x16x32_bf16 v[32:35], v[188:191], a[176:179], v[32:35]
    s_cbranch_scc1 L_parr1a1o
    ds_read_b128 v[80:83], v253 offset:9792
    v_exp_f32 v169, v169
    v_mfma_f32_16x16x32_bf16 v[36:39], v[184:187], a[148:151], 0
    ds_read_b128 v[84:87], v253 offset:10816
    v_exp_f32 v170, v170
    v_mfma_f32_16x16x32_bf16 v[36:39], v[188:191], a[180:183], v[36:39]
    ds_read_b128 v[88:91], v253 offset:11840
    v_exp_f32 v171, v171
    v_mfma_f32_16x16x32_bf16 v[40:43], v[184:187], a[152:155], 0
    ds_read_b128 v[92:95], v253 offset:12864
    v_cvt_pk_bf16_f32 v180, v168, v169
    v_cvt_pk_bf16_f32 v181, v170, v171
    v_mfma_f32_16x16x32_bf16 v[40:43], v[188:191], a[184:187], v[40:43]
    s_branch L_parr1a1e
L_parr1a1o:
    ds_read_b128 v[64:67], v253 offset:9792
    v_exp_f32 v169, v169
    v_mfma_f32_16x16x32_bf16 v[36:39], v[184:187], a[148:151], 0
    ds_read_b128 v[68:71], v253 offset:10816
    v_exp_f32 v170, v170
    v_mfma_f32_16x16x32_bf16 v[36:39], v[188:191], a[180:183], v[36:39]
    ds_read_b128 v[72:75], v253 offset:11840
    v_exp_f32 v171, v171
    v_mfma_f32_16x16x32_bf16 v[40:43], v[184:187], a[152:155], 0
    ds_read_b128 v[76:79], v253 offset:12864
    v_cvt_pk_bf16_f32 v180, v168, v169
    v_cvt_pk_bf16_f32 v181, v170, v171
    v_mfma_f32_16x16x32_bf16 v[40:43], v[188:191], a[184:187], v[40:43]
L_parr1a1e:
    ds_read_b32 v253, v253 offset:14144
    v_exp_f32 v172, v172
    v_mfma_f32_16x16x32_bf16 v[44:47], v[184:187], a[156:159], 0
    v_exp_f32 v173, v173
    v_mfma_f32_16x16x32_bf16 v[44:47], v[188:191], a[188:191], v[44:47]
    v_exp_f32 v174, v174
    v_mfma_f32_16x16x32_bf16 v[48:51], v[184:187], a[160:163], 0
    v_exp_f32 v175, v175
    v_mfma_f32_16x16x32_bf16 v[48:51], v[188:191], a[192:195], v[48:51]
    v_cvt_pk_bf16_f32 v182, v172, v173
    v_cvt_pk_bf16_f32 v183, v174, v175
    v_mfma_f32_16x16x32_bf16 v[52:55], v[184:187], a[164:167], 0
    s_waitcnt lgkmcnt(0)
    v_add_u32 v243, s27, v243
    v_add_f32 v248, v255, v253
    v_subrev_u32 v249, s42, v248
    v_rcp_f32 v248, v248
    v_cmp_le_u32 vcc, s43, v249
    v_mov_b32 v251, v248
    v_mov_b32_dpp v251, v248 row_ror:12 row_mask:0x2 bank_mask:0xf
    v_mov_b32_dpp v251, v248 row_ror:8 row_mask:0x4 bank_mask:0xf
    v_mov_b32_dpp v251, v248 row_ror:4 row_mask:0x8 bank_mask:0xf
    v_accvgpr_write_b32 a216, 0
    v_accvgpr_write_b32 a217, 0
    v_bfe_u32 v253, v244, 5, 1
    v_mad_u32_u24 v253, v253, s64, v252
    v_and_b32 v255, 0x80, v244
    v_mad_u32_u24 v255, v255, 7, v244
    v_lshl_add_u32 v255, s29, 7, v255
    v_mov_b32_dpp v248, v251 row_newbcast:0 row_mask:0xf bank_mask:0xf
    v_mov_b32_dpp v249, v251 row_newbcast:1 row_mask:0xf bank_mask:0xf
    v_mov_b32_dpp v250, v251 row_newbcast:2 row_mask:0xf bank_mask:0xf
    v_mov_b32_dpp v251, v251 row_newbcast:3 row_mask:0xf bank_mask:0xf
    v_pk_add_f32 v[64:65], v[64:65], v[80:81]
    v_pk_add_f32 v[66:67], v[66:67], v[82:83]
    v_pk_add_f32 v[68:69], v[68:69], v[84:85]
    v_pk_add_f32 v[70:71], v[70:71], v[86:87]
    v_pk_add_f32 v[72:73], v[72:73], v[88:89]
    v_pk_add_f32 v[74:75], v[74:75], v[90:91]
    v_pk_add_f32 v[76:77], v[76:77], v[92:93]
    v_pk_add_f32 v[78:79], v[78:79], v[94:95]
    v_pk_mul_f32 v[64:65], v[64:65], v[248:249]
    v_pk_mul_f32 v[66:67], v[66:67], v[250:251]
    v_pk_mul_f32 v[68:69], v[68:69], v[248:249]
    v_pk_mul_f32 v[70:71], v[70:71], v[250:251]
    v_pk_mul_f32 v[72:73], v[72:73], v[248:249]
    v_pk_mul_f32 v[74:75], v[74:75], v[250:251]
    v_pk_mul_f32 v[76:77], v[76:77], v[248:249]
    v_pk_mul_f32 v[78:79], v[78:79], v[250:251]
    v_cvt_pk_bf16_f32 v64, v64, v68
    v_cvt_pk_bf16_f32 v68, v65, v69
    v_cvt_pk_bf16_f32 v65, v72, v76
    v_cvt_pk_bf16_f32 v69, v73, v77
    v_mfma_f32_16x16x32_bf16 v[52:55], v[188:191], a[196:199], v[52:55]
    s_or_b64 s[44:45], s[44:45], vcc
    ds_write_b64 v246, v[64:65] offset:1088
    v_cvt_pk_bf16_f32 v66, v66, v70
    v_cvt_pk_bf16_f32 v70, v67, v71
    v_mfma_f32_16x16x32_bf16 v[56:59], v[184:187], a[168:171], 0
    s_add_u32 s24, s24, 16384
    ds_write_b64 v246, v[68:69] offset:2176
    v_cvt_pk_bf16_f32 v67, v74, v78
    v_cvt_pk_bf16_f32 v71, v75, v79
    v_mfma_f32_16x16x32_bf16 v[56:59], v[188:191], a[200:203], v[56:59]
    s_waitcnt vmcnt(31)
    ds_read_b128 v[232:235], v245 offset:5440
    ds_write_b64 v246, v[66:67] offset:3264
    v_mfma_f32_16x16x32_bf16 v[60:63], v[184:187], a[172:175], 0
    s_and_b32 s24, s24, 0x3ffff
    ds_read_b128 v[236:239], v245 offset:5504
    ds_write_b64 v246, v[70:71] offset:4352
    v_mfma_f32_16x16x32_bf16 v[60:63], v[188:191], a[204:207], v[60:63]
    s_add_u32 s65, s25, s24
    v_smfmac_f32_16x16x64_bf16 a[212:215], a[228:231], v[184:191], v247
    s_add_u32 s52, s8, s65
    s_addc_u32 s53, s9, 0
    ds_read_b64_tr_b16 v[64:65], v253 offset:1088
    ds_read_b64_tr_b16 v[66:67], v253 offset:1120
    v_mfma_f32_16x16x32_bf16 v[160:163], a[80:83], a[48:51], -4.0
    s_add_u32 s54, s12, s65
    s_addc_u32 s55, s13, 0
    ds_read_b64_tr_b16 v[68:69], v253 offset:3264
    ds_read_b64_tr_b16 v[70:71], v253 offset:3296
    v_mfma_f32_16x16x32_bf16 v[160:163], a[84:87], a[52:55], v[160:163]
    s_add_u32 s26, s26, s27
    v_mfma_f32_16x16x32_bf16 v[160:163], a[88:91], a[56:59], v[160:163]
    s_cmp_eq_u32 s26, s48
    s_cselect_b32 s27, s58, s59
    v_mfma_f32_16x16x32_bf16 v[160:163], a[92:95], a[60:63], v[160:163]
    s_mov_b32 s23, 15
    v_mfma_f32_16x16x32_bf16 v[164:167], a[96:99], a[60:63], -4.0
    s_mov_b32 s22, 16384
    v_mfma_f32_16x16x32_bf16 v[164:167], a[100:103], a[56:59], v[164:167]
    v_mfma_f32_16x16x32_bf16 v[164:167], a[104:107], a[52:55], v[164:167]
    s_waitcnt lgkmcnt(2)
    buffer_store_dwordx4 v[64:67], v255, s[16:19], s32 offen offset:0
    v_exp_f32 v160, v160
    v_mfma_f32_16x16x32_bf16 v[164:167], a[108:111], a[48:51], v[164:167]
    v_exp_f32 v161, v161
    v_lshlrev_b32 v248, 16, v232
    v_and_b32 v249, 0xffff0000, v232
    v_lshlrev_b32 v250, 16, v233
    v_and_b32 v251, 0xffff0000, v233
    v_pk_mul_f32 v[248:249], v[248:249], s[40:41]
    v_pk_mul_f32 v[250:251], v[250:251], s[40:41]
    v_cvt_pk_bf16_f32 v232, v248, v249
    v_cvt_pk_bf16_f32 v233, v250, v251
    v_accvgpr_write_b32 a64, v232
    v_accvgpr_write_b32 a65, v233
    v_lshlrev_b32 v248, 16, v234
    v_and_b32 v249, 0xffff0000, v234
    v_lshlrev_b32 v250, 16, v235
    v_and_b32 v251, 0xffff0000, v235
    v_pk_mul_f32 v[248:249], v[248:249], s[40:41]
    v_pk_mul_f32 v[250:251], v[250:251], s[40:41]
    v_cvt_pk_bf16_f32 v234, v248, v249
    v_cvt_pk_bf16_f32 v235, v250, v251
    v_accvgpr_write_b32 a66, v234
    v_accvgpr_write_b32 a67, v235
    v_mfma_f32_16x16x32_bf16 v[168:171], a[112:115], a[48:51], -4.0
    ds_read_b128 v[232:235], v245 offset:5568
    v_exp_f32 v162, v162
    v_mfma_f32_16x16x32_bf16 v[168:171], a[116:119], a[52:55], v[168:171]
    v_exp_f32 v163, v163
    v_mfma_f32_16x16x32_bf16 v[168:171], a[120:123], a[56:59], v[168:171]
    s_waitcnt lgkmcnt(1)
    buffer_store_dwordx4 v[68:71], v255, s[16:19], s32 offen offset:2048
    v_cvt_pk_bf16_f32 v184, v160, v161
    v_cvt_pk_bf16_f32 v185, v162, v163
    v_mfma_f32_16x16x32_bf16 v[168:171], a[124:127], a[60:63], v[168:171]
    v_exp_f32 v164, v164
    v_mfma_f32_16x16x32_bf16 v[172:175], a[128:131], a[60:63], -4.0
    v_exp_f32 v165, v165
    v_mfma_f32_16x16x32_bf16 v[172:175], a[132:135], a[56:59], v[172:175]
    v_exp_f32 v166, v166
    v_mfma_f32_16x16x32_bf16 v[172:175], a[136:139], a[52:55], v[172:175]
    v_exp_f32 v167, v167
    v_mfma_f32_16x16x32_bf16 v[172:175], a[140:143], a[48:51], v[172:175]
    v_cvt_pk_bf16_f32 v186, v164, v165
    v_cvt_pk_bf16_f32 v187, v166, v167
    v_mfma_f32_16x16x32_bf16 v[64:67], v[176:179], a[144:147], 0
    v_exp_f32 v168, v168
    v_mfma_f32_16x16x32_bf16 v[64:67], v[180:183], a[176:179], v[64:67]
    v_exp_f32 v169, v169
    v_mfma_f32_16x16x32_bf16 v[68:71], v[176:179], a[148:151], 0
    v_exp_f32 v170, v170
    v_mfma_f32_16x16x32_bf16 v[68:71], v[180:183], a[180:183], v[68:71]
    v_exp_f32 v171, v171
    v_mfma_f32_16x16x32_bf16 v[72:75], v[176:179], a[152:155], 0
    v_cvt_pk_bf16_f32 v188, v168, v169
    v_cvt_pk_bf16_f32 v189, v170, v171
    v_mfma_f32_16x16x32_bf16 v[72:75], v[180:183], a[184:187], v[72:75]
    v_exp_f32 v172, v172
    v_mfma_f32_16x16x32_bf16 v[76:79], v[176:179], a[156:159], 0
    v_exp_f32 v173, v173
    v_mfma_f32_16x16x32_bf16 v[76:79], v[180:183], a[188:191], v[76:79]
    v_exp_f32 v174, v174
    v_mfma_f32_16x16x32_bf16 v[80:83], v[176:179], a[160:163], 0
    v_exp_f32 v175, v175
    v_mfma_f32_16x16x32_bf16 v[80:83], v[180:183], a[192:195], v[80:83]
    v_cvt_pk_bf16_f32 v190, v172, v173
    v_cvt_pk_bf16_f32 v191, v174, v175
    v_mfma_f32_16x16x32_bf16 v[84:87], v[176:179], a[164:167], 0
    v_lshlrev_b32 v248, 16, v236
    v_and_b32 v249, 0xffff0000, v236
    v_lshlrev_b32 v250, 16, v237
    v_and_b32 v251, 0xffff0000, v237
    v_pk_mul_f32 v[248:249], v[248:249], s[40:41]
    v_pk_mul_f32 v[250:251], v[250:251], s[40:41]
    v_cvt_pk_bf16_f32 v236, v248, v249
    v_cvt_pk_bf16_f32 v237, v250, v251
    v_accvgpr_write_b32 a68, v236
    v_accvgpr_write_b32 a69, v237
    v_lshlrev_b32 v248, 16, v238
    v_and_b32 v249, 0xffff0000, v238
    v_lshlrev_b32 v250, 16, v239
    v_and_b32 v251, 0xffff0000, v239
    v_pk_mul_f32 v[248:249], v[248:249], s[40:41]
    v_pk_mul_f32 v[250:251], v[250:251], s[40:41]
    v_cvt_pk_bf16_f32 v238, v248, v249
    v_cvt_pk_bf16_f32 v239, v250, v251
    v_accvgpr_write_b32 a70, v238
    v_accvgpr_write_b32 a71, v239
    v_mfma_f32_16x16x32_bf16 v[84:87], v[180:183], a[196:199], v[84:87]
    ds_read_b128 v[236:239], v245 offset:5632
    v_mfma_f32_16x16x32_bf16 v[88:91], v[176:179], a[168:171], 0
    v_mfma_f32_16x16x32_bf16 v[88:91], v[180:183], a[200:203], v[88:91]
    s_waitcnt lgkmcnt(1)
    v_lshlrev_b32 v248, 16, v232
    v_and_b32 v249, 0xffff0000, v232
    v_lshlrev_b32 v250, 16, v233
    v_and_b32 v251, 0xffff0000, v233
    v_pk_mul_f32 v[248:249], v[248:249], s[40:41]
    v_pk_mul_f32 v[250:251], v[250:251], s[40:41]
    v_cvt_pk_bf16_f32 v232, v248, v249
    v_cvt_pk_bf16_f32 v233, v250, v251
    v_accvgpr_write_b32 a72, v232
    v_accvgpr_write_b32 a73, v233
    v_lshlrev_b32 v248, 16, v234
    v_and_b32 v249, 0xffff0000, v234
    v_lshlrev_b32 v250, 16, v235
    v_and_b32 v251, 0xffff0000, v235
    v_pk_mul_f32 v[248:249], v[248:249], s[40:41]
    v_pk_mul_f32 v[250:251], v[250:251], s[40:41]
    v_cvt_pk_bf16_f32 v234, v248, v249
    v_cvt_pk_bf16_f32 v235, v250, v251
    v_accvgpr_write_b32 a74, v234
    v_accvgpr_write_b32 a75, v235
    v_mfma_f32_16x16x32_bf16 v[92:95], v[176:179], a[172:175], 0
    s_waitcnt lgkmcnt(0)
    v_lshlrev_b32 v248, 16, v236
    v_and_b32 v249, 0xffff0000, v236
    v_lshlrev_b32 v250, 16, v237
    v_and_b32 v251, 0xffff0000, v237
    v_pk_mul_f32 v[248:249], v[248:249], s[40:41]
    v_pk_mul_f32 v[250:251], v[250:251], s[40:41]
    v_cvt_pk_bf16_f32 v236, v248, v249
    v_cvt_pk_bf16_f32 v237, v250, v251
    v_accvgpr_write_b32 a76, v236
    v_accvgpr_write_b32 a77, v237
    v_lshlrev_b32 v248, 16, v238
    v_and_b32 v249, 0xffff0000, v238
    v_lshlrev_b32 v250, 16, v239
    v_and_b32 v251, 0xffff0000, v239
    v_pk_mul_f32 v[248:249], v[248:249], s[40:41]
    v_pk_mul_f32 v[250:251], v[250:251], s[40:41]
    v_cvt_pk_bf16_f32 v238, v248, v249
    v_cvt_pk_bf16_f32 v239, v250, v251
    v_accvgpr_write_b32 a78, v238
    v_accvgpr_write_b32 a79, v239
    v_mfma_f32_16x16x32_bf16 v[92:95], v[180:183], a[204:207], v[92:95]
    v_smfmac_f32_16x16x64_bf16 a[216:219], a[228:231], v[176:183], v247
    v_mfma_f32_16x16x32_bf16 v[160:163], a[80:83], a[64:67], -4.0
    ds_read_b128 a[80:83], v240 offset:0
    v_mfma_f32_16x16x32_bf16 v[160:163], a[84:87], a[68:71], v[160:163]
    ds_read_b128 a[84:87], v240 offset:64
    v_mfma_f32_16x16x32_bf16 v[160:163], a[88:91], a[72:75], v[160:163]
    ds_read_b128 a[88:91], v240 offset:128
    v_mfma_f32_16x16x32_bf16 v[160:163], a[92:95], a[76:79], v[160:163]
    ds_read_b128 a[92:95], v240 offset:192
    v_mfma_f32_16x16x32_bf16 v[164:167], a[96:99], a[76:79], -4.0
    ds_read_b128 a[96:99], v240 offset:704
    v_mfma_f32_16x16x32_bf16 v[164:167], a[100:103], a[72:75], v[164:167]
    ds_read_b128 a[100:103], v240 offset:640
    v_mfma_f32_16x16x32_bf16 v[164:167], a[104:107], a[68:71], v[164:167]
    v_exp_f32_e64 v160, v160
    v_mfma_f32_16x16x32_bf16 v[164:167], a[108:111], a[64:67], v[164:167]
    v_exp_f32_e64 v161, v161
    v_mfma_f32_16x16x32_bf16 v[168:171], a[112:115], a[64:67], -4.0
    ds_read_b128 a[104:107], v240 offset:576
    v_cvt_pk_bf16_f32 v192, v160, v161
    v_mfma_f32_16x16x32_bf16 v[168:171], a[116:119], a[68:71], v[168:171]
    v_exp_f32_e64 v162, v162
    v_mfma_f32_16x16x32_bf16 v[168:171], a[120:123], a[72:75], v[168:171]
    v_exp_f32_e64 v163, v163
    v_mfma_f32_16x16x32_bf16 v[168:171], a[124:127], a[76:79], v[168:171]
    ds_read_b128 a[108:111], v240 offset:512
    v_cvt_pk_bf16_f32 v193, v162, v163
    v_mfma_f32_16x16x32_bf16 v[172:175], a[128:131], a[76:79], -4.0
    v_exp_f32_e64 v164, v164
    v_mfma_f32_16x16x32_bf16 v[172:175], a[132:135], a[72:75], v[172:175]
    v_exp_f32_e64 v165, v165
    v_mfma_f32_16x16x32_bf16 v[172:175], a[136:139], a[68:71], v[172:175]
    ds_read_b128 a[112:115], v241 offset:0
    v_cvt_pk_bf16_f32 v194, v164, v165
    v_mfma_f32_16x16x32_bf16 v[172:175], a[140:143], a[64:67], v[172:175]
    v_exp_f32_e64 v166, v166
    v_mfma_f32_16x16x32_bf16 v[96:99], v[184:187], a[144:147], 0
    v_exp_f32 v167, v167
    v_mfma_f32_16x16x32_bf16 v[96:99], v[188:191], a[176:179], v[96:99]
    ds_read_b128 a[116:119], v241 offset:64
    v_cvt_pk_bf16_f32 v195, v166, v167
    v_mfma_f32_16x16x32_bf16 v[100:103], v[184:187], a[148:151], 0
    v_exp_f32 v168, v168
    v_mfma_f32_16x16x32_bf16 v[100:103], v[188:191], a[180:183], v[100:103]
    v_exp_f32 v169, v169
    v_mfma_f32_16x16x32_bf16 v[104:107], v[184:187], a[152:155], 0
    ds_read_b128 a[120:123], v241 offset:128
    v_cvt_pk_bf16_f32 v196, v168, v169
    v_mfma_f32_16x16x32_bf16 v[104:107], v[188:191], a[184:187], v[104:107]
    v_exp_f32 v170, v170
    v_mfma_f32_16x16x32_bf16 v[108:111], v[184:187], a[156:159], 0
    v_exp_f32 v171, v171
    v_mfma_f32_16x16x32_bf16 v[108:111], v[188:191], a[188:191], v[108:111]
    ds_read_b128 a[124:127], v241 offset:192
    v_cvt_pk_bf16_f32 v197, v170, v171
    v_mfma_f32_16x16x32_bf16 v[112:115], v[184:187], a[160:163], 0
    v_exp_f32 v172, v172
    v_mfma_f32_16x16x32_bf16 v[112:115], v[188:191], a[192:195], v[112:115]
    v_exp_f32 v173, v173
    v_mfma_f32_16x16x32_bf16 v[116:119], v[184:187], a[164:167], 0
    ds_read_b128 a[128:131], v241 offset:704
    buffer_store_dwordx4 v[140:143], v244, s[16:19], s34 offen offset:3072
    v_cvt_pk_bf16_f32 v198, v172, v173
    v_mfma_f32_16x16x32_bf16 v[116:119], v[188:191], a[196:199], v[116:119]
    v_exp_f32 v174, v174
    v_mfma_f32_16x16x32_bf16 v[120:123], v[184:187], a[168:171], 0
    v_exp_f32 v175, v175
    v_mfma_f32_16x16x32_bf16 v[120:123], v[188:191], a[200:203], v[120:123]
    ds_read_b128 a[132:135], v241 offset:640
    v_cvt_pk_bf16_f32 v199, v174, v175
    v_mfma_f32_16x16x32_bf16 v[124:127], v[184:187], a[172:175], 0
    ds_read_b128 a[136:139], v241 offset:576
    v_mfma_f32_16x16x32_bf16 v[124:127], v[188:191], a[204:207], v[124:127]
    ds_read_b128 a[140:143], v241 offset:512
    v_smfmac_f32_16x16x64_bf16 a[220:223], a[228:231], v[184:191], v247
    s_waitcnt lgkmcnt(4)
    v_mfma_f32_16x16x32_bf16 v[160:163], a[80:83], v[200:203], -4.0
    v_mfma_f32_16x16x32_bf16 v[160:163], a[84:87], v[204:207], v[160:163]
    v_mfma_f32_16x16x32_bf16 v[160:163], a[88:91], v[208:211], v[160:163]
    v_mfma_f32_16x16x32_bf16 v[160:163], a[92:95], v[212:215], v[160:163]
    v_mfma_f32_16x16x32_bf16 v[164:167], a[96:99], v[212:215], -4.0
    v_mfma_f32_16x16x32_bf16 v[164:167], a[100:103], v[208:211], v[164:167]
L_pad1_6:
    s_cbranch_execz L_ret1
    v_mfma_f32_16x16x32_bf16 v[164:167], a[104:107], v[204:207], v[164:167]
    v_exp_f32 v160, v160
    v_mfma_f32_16x16x32_bf16 v[164:167], a[108:111], v[200:203], v[164:167]
    v_exp_f32 v161, v161
    v_mfma_f32_16x16x32_bf16 v[168:171], a[112:115], v[200:203], -4.0
    v_exp_f32 v162, v162
    v_mfma_f32_16x16x32_bf16 v[168:171], a[116:119], v[204:207], v[168:171]
    v_exp_f32 v163, v163
    v_mfma_f32_16x16x32_bf16 v[168:171], a[120:123], v[208:211], v[168:171]
    v_cvt_pk_bf16_f32 v176, v160, v161
    v_cvt_pk_bf16_f32 v177, v162, v163
    v_mfma_f32_16x16x32_bf16 v[168:171], a[124:127], v[212:215], v[168:171]
    s_waitcnt lgkmcnt(0)
    v_exp_f32 v164, v164
    v_mfma_f32_16x16x32_bf16 v[172:175], a[128:131], v[212:215], -4.0
    v_exp_f32 v165, v165
    v_mfma_f32_16x16x32_bf16 v[172:175], a[132:135], v[208:211], v[172:175]
    v_exp_f32 v166, v166
    v_mfma_f32_16x16x32_bf16 v[172:175], a[136:139], v[204:207], v[172:175]
    v_exp_f32 v167, v167
    v_mfma_f32_16x16x32_bf16 v[172:175], a[140:143], v[200:203], v[172:175]
    v_cvt_pk_bf16_f32 v178, v164, v165
    v_cvt_pk_bf16_f32 v179, v166, v167
    v_mfma_f32_16x16x32_bf16 v[128:131], v[192:195], a[144:147], 0
    ds_read_b64_tr_b16 a[144:145], v242 offset:0
    ds_read_b64_tr_b16 a[146:147], v242 offset:512
    v_mfma_f32_16x16x32_bf16 v[128:131], v[196:199], a[176:179], v[128:131]
    v_exp_f32 v168, v168
    v_mfma_f32_16x16x32_bf16 v[132:135], v[192:195], a[148:151], 0
    ds_read_b64_tr_b16 a[176:177], v243 offset:0
    ds_read_b64_tr_b16 a[178:179], v243 offset:512
    v_mfma_f32_16x16x32_bf16 v[132:135], v[196:199], a[180:183], v[132:135]
    v_exp_f32 v169, v169
    v_mfma_f32_16x16x32_bf16 v[136:139], v[192:195], a[152:155], 0
    ds_read_b64_tr_b16 a[148:149], v242 offset:16
    ds_read_b64_tr_b16 a[150:151], v242 offset:528
    v_mfma_f32_16x16x32_bf16 v[136:139], v[196:199], a[184:187], v[136:139]
    v_exp_f32 v170, v170
    v_mfma_f32_16x16x32_bf16 v[140:143], v[192:195], a[156:159], 0
    ds_read_b64_tr_b16 a[180:181], v243 offset:16
    ds_read_b64_tr_b16 a[182:183], v243 offset:528
    v_mfma_f32_16x16x32_bf16 v[140:143], v[196:199], a[188:191], v[140:143]
    v_exp_f32 v171, v171
    v_mfma_f32_16x16x32_bf16 v[144:147], v[192:195], a[160:163], 0
    ds_read_b64_tr_b16 a[152:153], v242 offset:32
    ds_read_b64_tr_b16 a[154:155], v242 offset:544
    v_mfma_f32_16x16x32_bf16 v[144:147], v[196:199], a[192:195], v[144:147]
    v_exp_f32 v172, v172
    v_mfma_f32_16x16x32_bf16 v[148:151], v[192:195], a[164:167], 0
    ds_read_b64_tr_b16 a[184:185], v243 offset:32
    ds_read_b64_tr_b16 a[186:187], v243 offset:544
    v_mfma_f32_16x16x32_bf16 v[148:151], v[196:199], a[196:199], v[148:151]
    v_exp_f32 v173, v173
    v_mfma_f32_16x16x32_bf16 v[152:155], v[192:195], a[168:171], 0
    ds_read_b64_tr_b16 a[156:157], v242 offset:48
    ds_read_b64_tr_b16 a[158:159], v242 offset:560
    v_mfma_f32_16x16x32_bf16 v[152:155], v[196:199], a[200:203], v[152:155]
    v_exp_f32 v174, v174
    v_mfma_f32_16x16x32_bf16 v[156:159], v[192:195], a[172:175], 0
    ds_read_b64_tr_b16 a[188:189], v243 offset:48
    ds_read_b64_tr_b16 a[190:191], v243 offset:560
    v_mfma_f32_16x16x32_bf16 v[156:159], v[196:199], a[204:207], v[156:159]
    v_exp_f32 v175, v175
    v_smfmac_f32_16x16x64_bf16 a[224:227], a[228:231], v[192:199], v247
L_loop1r1:
    v_mfma_f32_16x16x32_bf16 v[160:163], a[80:83], v[216:219], -4.0
    ds_read_b64_tr_b16 a[160:161], v242 offset:128
    ds_read_b64_tr_b16 a[162:163], v242 offset:640
    v_mfma_f32_16x16x32_bf16 v[160:163], a[84:87], v[220:223], v[160:163]
    v_cvt_pk_bf16_f32 v180, v168, v169
    v_cvt_pk_bf16_f32 v181, v170, v171
    v_mfma_f32_16x16x32_bf16 v[160:163], a[88:91], v[224:227], v[160:163]
    ds_read_b64_tr_b16 a[192:193], v243 offset:128
    ds_read_b64_tr_b16 a[194:195], v243 offset:640
    v_mfma_f32_16x16x32_bf16 v[160:163], a[92:95], v[228:231], v[160:163]
    v_cvt_pk_bf16_f32 v182, v172, v173
    v_cvt_pk_bf16_f32 v183, v174, v175
    v_mfma_f32_16x16x32_bf16 v[164:167], a[96:99], v[228:231], -4.0
    ds_read_b64_tr_b16 a[164:165], v242 offset:144
    ds_read_b64_tr_b16 a[166:167], v242 offset:656
    v_mfma_f32_16x16x32_bf16 v[164:167], a[100:103], v[224:227], v[164:167]
    v_mfma_f32_16x16x32_bf16 v[164:167], a[104:107], v[220:223], v[164:167]
    ds_read_b64_tr_b16 a[196:197], v243 offset:144
    ds_read_b64_tr_b16 a[198:199], v243 offset:656
    v_mfma_f32_16x16x32_bf16 v[164:167], a[108:111], v[216:219], v[164:167]
    v_exp_f32 v160, v160
    v_mfma_f32_16x16x32_bf16 v[168:171], a[112:115], v[216:219], -4.0
    ds_read_b64_tr_b16 a[168:169], v242 offset:160
    ds_read_b64_tr_b16 a[170:171], v242 offset:672
    v_mfma_f32_16x16x32_bf16 v[168:171], a[116:119], v[220:223], v[168:171]
    v_exp_f32 v161, v161
    v_mfma_f32_16x16x32_bf16 v[168:171], a[120:123], v[224:227], v[168:171]
    ds_read_b64_tr_b16 a[200:201], v243 offset:160
    ds_read_b64_tr_b16 a[202:203], v243 offset:672
    v_mfma_f32_16x16x32_bf16 v[168:171], a[124:127], v[228:231], v[168:171]
    v_exp_f32 v162, v162
    v_mfma_f32_16x16x32_bf16 v[172:175], a[128:131], v[228:231], -4.0
    ds_read_b64_tr_b16 a[172:173], v242 offset:176
    ds_read_b64_tr_b16 a[174:175], v242 offset:688
    v_mfma_f32_16x16x32_bf16 v[172:175], a[132:135], v[224:227], v[172:175]
    v_exp_f32 v163, v163
    v_mfma_f32_16x16x32_bf16 v[172:175], a[136:139], v[220:223], v[172:175]
    ds_read_b64_tr_b16 a[204:205], v243 offset:176
    ds_read_b64_tr_b16 a[206:207], v243 offset:688
    v_mfma_f32_16x16x32_bf16 v[172:175], a[140:143], v[216:219], v[172:175]
    s_waitcnt lgkmcnt(8)
    v_cvt_pk_bf16_f32 v184, v160, v161
    v_cvt_pk_bf16_f32 v185, v162, v163
    v_mfma_f32_16x16x32_bf16 v[0:3], v[176:179], a[144:147], v[0:3]
    v_exp_f32 v164, v164
    v_mfma_f32_16x16x32_bf16 v[0:3], v[180:183], a[176:179], v[0:3]
    v_exp_f32 v165, v165
    v_mfma_f32_16x16x32_bf16 v[4:7], v[176:179], a[148:151], v[4:7]
    v_exp_f32 v166, v166
    v_mfma_f32_16x16x32_bf16 v[4:7], v[180:183], a[180:183], v[4:7]
    v_exp_f32 v167, v167
    v_mfma_f32_16x16x32_bf16 v[8:11], v[176:179], a[152:155], v[8:11]
    v_cvt_pk_bf16_f32 v186, v164, v165
    v_cvt_pk_bf16_f32 v187, v166, v167
    v_mfma_f32_16x16x32_bf16 v[8:11], v[180:183], a[184:187], v[8:11]
    v_exp_f32 v168, v168
    v_mfma_f32_16x16x32_bf16 v[12:15], v[176:179], a[156:159], v[12:15]
    v_exp_f32 v169, v169
    v_mfma_f32_16x16x32_bf16 v[12:15], v[180:183], a[188:191], v[12:15]
    v_exp_f32 v170, v170
    v_mfma_f32_16x16x32_bf16 v[16:19], v[176:179], a[160:163], v[16:19]
    v_exp_f32 v171, v171
    v_mfma_f32_16x16x32_bf16 v[16:19], v[180:183], a[192:195], v[16:19]
    v_cvt_pk_bf16_f32 v188, v168, v169
    v_cvt_pk_bf16_f32 v189, v170, v171
    v_mfma_f32_16x16x32_bf16 v[20:23], v[176:179], a[164:167], v[20:23]
    v_exp_f32 v172, v172
    v_mfma_f32_16x16x32_bf16 v[20:23], v[180:183], a[196:199], v[20:23]
    s_waitcnt lgkmcnt(0)
    v_exp_f32 v173, v173
    v_mfma_f32_16x16x32_bf16 v[24:27], v[176:179], a[168:171], v[24:27]
    v_exp_f32 v174, v174
    v_mfma_f32_16x16x32_bf16 v[24:27], v[180:183], a[200:203], v[24:27]
    v_exp_f32 v175, v175
    v_mfma_f32_16x16x32_bf16 v[28:31], v[176:179], a[172:175], v[28:31]
    v_cvt_pk_bf16_f32 v190, v172, v173
    v_cvt_pk_bf16_f32 v191, v174, v175
    v_mfma_f32_16x16x32_bf16 v[28:31], v[180:183], a[204:207], v[28:31]
    s_waitcnt vmcnt(8)
    v_smfmac_f32_16x16x64_bf16 a[208:211], a[228:231], v[176:183], v247
    s_barrier
    v_mfma_f32_16x16x32_bf16 v[160:163], a[80:83], a[32:35], -4.0
    s_add_u32 m0, s26, 0
    v_add_u32 v240, s27, v240
    v_mfma_f32_16x16x32_bf16 v[160:163], a[84:87], a[36:39], v[160:163]
    global_load_lds_dwordx4 v244, s[52:53] offset:0
    v_mfma_f32_16x16x32_bf16 v[160:163], a[88:91], a[40:43], v[160:163]
    s_add_u32 m0, s26, 32
    v_add_u32 v241, s27, v241
    v_mfma_f32_16x16x32_bf16 v[160:163], a[92:95], a[44:47], v[160:163]
    global_load_lds_dwordx4 v244, s[52:53] offset:1024
    v_mfma_f32_16x16x32_bf16 v[164:167], a[96:99], a[44:47], -4.0
    s_add_u32 m0, s26, 64
    v_add_u32 v242, s27, v242
    v_mfma_f32_16x16x32_bf16 v[164:167], a[100:103], a[40:43], v[164:167]
    global_load_lds_dwordx4 v244, s[52:53] offset:2048
    v_mfma_f32_16x16x32_bf16 v[164:167], a[104:107], a[36:39], v[164:167]
    v_exp_f32 v160, v160
    v_mfma_f32_16x16x32_bf16 v[164:167], a[108:111], a[32:35], v[164:167]
    v_exp_f32 v161, v161
    v_mfma_f32_16x16x32_bf16 v[168:171], a[112:115], a[32:35], -4.0
    v_exp_f32 v162, v162
    v_mfma_f32_16x16x32_bf16 v[168:171], a[116:119], a[36:39], v[168:171]
    v_exp_f32 v163, v163
    v_mfma_f32_16x16x32_bf16 v[168:171], a[120:123], a[40:43], v[168:171]
    v_cvt_pk_bf16_f32 v176, v160, v161
    v_cvt_pk_bf16_f32 v177, v162, v163
    v_mfma_f32_16x16x32_bf16 v[168:171], a[124:127], a[44:47], v[168:171]
    v_exp_f32 v164, v164
    v_mfma_f32_16x16x32_bf16 v[172:175], a[128:131], a[44:47], -4.0
    v_exp_f32 v165, v165
    v_mfma_f32_16x16x32_bf16 v[172:175], a[132:135], a[40:43], v[172:175]
    v_exp_f32 v166, v166
    v_mfma_f32_16x16x32_bf16 v[172:175], a[136:139], a[36:39], v[172:175]
    v_exp_f32 v167, v167
    v_mfma_f32_16x16x32_bf16 v[172:175], a[140:143], a[32:35], v[172:175]
    v_cvt_pk_bf16_f32 v178, v164, v165
    v_cvt_pk_bf16_f32 v179, v166, v167
    v_mfma_f32_16x16x32_bf16 v[32:35], v[184:187], a[144:147], v[32:35]
    v_exp_f32 v168, v168
    v_mfma_f32_16x16x32_bf16 v[32:35], v[188:191], a[176:179], v[32:35]
    v_exp_f32 v169, v169
    v_mfma_f32_16x16x32_bf16 v[36:39], v[184:187], a[148:151], v[36:39]
    v_exp_f32 v170, v170
    v_mfma_f32_16x16x32_bf16 v[36:39], v[188:191], a[180:183], v[36:39]
    v_exp_f32 v171, v171
    v_mfma_f32_16x16x32_bf16 v[40:43], v[184:187], a[152:155], v[40:43]
    v_cvt_pk_bf16_f32 v180, v168, v169
    v_cvt_pk_bf16_f32 v181, v170, v171
    v_mfma_f32_16x16x32_bf16 v[40:43], v[188:191], a[184:187], v[40:43]
    v_exp_f32 v172, v172
    v_mfma_f32_16x16x32_bf16 v[44:47], v[184:187], a[156:159], v[44:47]
    v_exp_f32 v173, v173
    v_mfma_f32_16x16x32_bf16 v[44:47], v[188:191], a[188:191], v[44:47]
    v_exp_f32 v174, v174
    v_mfma_f32_16x16x32_bf16 v[48:51], v[184:187], a[160:163], v[48:51]
    v_exp_f32 v175, v175
    v_mfma_f32_16x16x32_bf16 v[48:51], v[188:191], a[192:195], v[48:51]
    v_cvt_pk_bf16_f32 v182, v172, v173
    v_cvt_pk_bf16_f32 v183, v174, v175
    v_mfma_f32_16x16x32_bf16 v[52:55], v[184:187], a[164:167], v[52:55]
    v_add_u32 v243, s27, v243
    v_mfma_f32_16x16x32_bf16 v[52:55], v[188:191], a[196:199], v[52:55]
    v_mfma_f32_16x16x32_bf16 v[56:59], v[184:187], a[168:171], v[56:59]
    v_mfma_f32_16x16x32_bf16 v[56:59], v[188:191], a[200:203], v[56:59]
    v_mfma_f32_16x16x32_bf16 v[60:63], v[184:187], a[172:175], v[60:63]
    v_mfma_f32_16x16x32_bf16 v[60:63], v[188:191], a[204:207], v[60:63]
    s_add_u32 m0, s26, 96
    v_smfmac_f32_16x16x64_bf16 a[212:215], a[228:231], v[184:191], v247
    global_load_lds_dwordx4 v244, s[52:53] offset:3072
    v_mfma_f32_16x16x32_bf16 v[160:163], a[80:83], a[48:51], -4.0
    s_add_u32 m0, s26, 16896
    v_mfma_f32_16x16x32_bf16 v[160:163], a[84:87], a[52:55], v[160:163]
    global_load_lds_dwordx4 v244, s[54:55] offset:0
    v_mfma_f32_16x16x32_bf16 v[160:163], a[88:91], a[56:59], v[160:163]
    s_add_u32 m0, s26, 16912
    v_mfma_f32_16x16x32_bf16 v[160:163], a[92:95], a[60:63], v[160:163]
    global_load_lds_dwordx4 v244, s[54:55] offset:1024
    v_mfma_f32_16x16x32_bf16 v[164:167], a[96:99], a[60:63], -4.0
    s_add_u32 m0, s26, 16928
    v_mfma_f32_16x16x32_bf16 v[164:167], a[100:103], a[56:59], v[164:167]
    global_load_lds_dwordx4 v244, s[54:55] offset:2048
    v_mfma_f32_16x16x32_bf16 v[164:167], a[104:107], a[52:55], v[164:167]
    v_exp_f32 v160, v160
    v_mfma_f32_16x16x32_bf16 v[164:167], a[108:111], a[48:51], v[164:167]
    v_exp_f32 v161, v161
    v_mfma_f32_16x16x32_bf16 v[168:171], a[112:115], a[48:51], -4.0
    v_exp_f32 v162, v162
    v_mfma_f32_16x16x32_bf16 v[168:171], a[116:119], a[52:55], v[168:171]
    v_exp_f32 v163, v163
    v_mfma_f32_16x16x32_bf16 v[168:171], a[120:123], a[56:59], v[168:171]
    v_cvt_pk_bf16_f32 v184, v160, v161
    v_cvt_pk_bf16_f32 v185, v162, v163
    v_mfma_f32_16x16x32_bf16 v[168:171], a[124:127], a[60:63], v[168:171]
    v_exp_f32 v164, v164
    v_mfma_f32_16x16x32_bf16 v[172:175], a[128:131], a[60:63], -4.0
    v_exp_f32 v165, v165
    v_mfma_f32_16x16x32_bf16 v[172:175], a[132:135], a[56:59], v[172:175]
    v_exp_f32 v166, v166
    v_mfma_f32_16x16x32_bf16 v[172:175], a[136:139], a[52:55], v[172:175]
    v_exp_f32 v167, v167
    v_mfma_f32_16x16x32_bf16 v[172:175], a[140:143], a[48:51], v[172:175]
    v_cvt_pk_bf16_f32 v186, v164, v165
    v_cvt_pk_bf16_f32 v187, v166, v167
    v_mfma_f32_16x16x32_bf16 v[64:67], v[176:179], a[144:147], v[64:67]
    v_exp_f32 v168, v168
    v_mfma_f32_16x16x32_bf16 v[64:67], v[180:183], a[176:179], v[64:67]
    v_exp_f32 v169, v169
    v_mfma_f32_16x16x32_bf16 v[68:71], v[176:179], a[148:151], v[68:71]
    v_exp_f32 v170, v170
    v_mfma_f32_16x16x32_bf16 v[68:71], v[180:183], a[180:183], v[68:71]
    v_exp_f32 v171, v171
    v_mfma_f32_16x16x32_bf16 v[72:75], v[176:179], a[152:155], v[72:75]
    v_cvt_pk_bf16_f32 v188, v168, v169
    v_cvt_pk_bf16_f32 v189, v170, v171
    v_mfma_f32_16x16x32_bf16 v[72:75], v[180:183], a[184:187], v[72:75]
    v_exp_f32 v172, v172
    v_mfma_f32_16x16x32_bf16 v[76:79], v[176:179], a[156:159], v[76:79]
    v_exp_f32 v173, v173
    v_mfma_f32_16x16x32_bf16 v[76:79], v[180:183], a[188:191], v[76:79]
    v_exp_f32 v174, v174
    v_mfma_f32_16x16x32_bf16 v[80:83], v[176:179], a[160:163], v[80:83]
    v_exp_f32 v175, v175
    v_mfma_f32_16x16x32_bf16 v[80:83], v[180:183], a[192:195], v[80:83]
    v_cvt_pk_bf16_f32 v190, v172, v173
    v_cvt_pk_bf16_f32 v191, v174, v175
    v_mfma_f32_16x16x32_bf16 v[84:87], v[176:179], a[164:167], v[84:87]
    v_mfma_f32_16x16x32_bf16 v[84:87], v[180:183], a[196:199], v[84:87]
    v_mfma_f32_16x16x32_bf16 v[88:91], v[176:179], a[168:171], v[88:91]
    v_mfma_f32_16x16x32_bf16 v[88:91], v[180:183], a[200:203], v[88:91]
    v_mfma_f32_16x16x32_bf16 v[92:95], v[176:179], a[172:175], v[92:95]
    v_mfma_f32_16x16x32_bf16 v[92:95], v[180:183], a[204:207], v[92:95]
    s_add_u32 m0, s26, 16944
    v_smfmac_f32_16x16x64_bf16 a[216:219], a[228:231], v[176:183], v247
    global_load_lds_dwordx4 v244, s[54:55] offset:3072
    v_mfma_f32_16x16x32_bf16 v[160:163], a[80:83], a[64:67], -4.0
    s_add_u32 s24, s24, s22
    ds_read_b128 a[80:83], v240 offset:0
    v_mfma_f32_16x16x32_bf16 v[160:163], a[84:87], a[68:71], v[160:163]
    s_and_b32 s24, s24, 0x3ffff
    ds_read_b128 a[84:87], v240 offset:64
    v_mfma_f32_16x16x32_bf16 v[160:163], a[88:91], a[72:75], v[160:163]
    s_cmp_eq_u32 s23, 4
    ds_read_b128 a[88:91], v240 offset:128
    v_mfma_f32_16x16x32_bf16 v[160:163], a[92:95], a[76:79], v[160:163]
    s_cselect_b32 s24, 0, s24
    ds_read_b128 a[92:95], v240 offset:192
    v_mfma_f32_16x16x32_bf16 v[164:167], a[96:99], a[76:79], -4.0
    s_cselect_b32 s22, 0, s22
    ds_read_b128 a[96:99], v240 offset:704
    v_mfma_f32_16x16x32_bf16 v[164:167], a[100:103], a[72:75], v[164:167]
    s_add_u32 s65, s25, s24
    ds_read_b128 a[100:103], v240 offset:640
    v_mfma_f32_16x16x32_bf16 v[164:167], a[104:107], a[68:71], v[164:167]
    s_add_u32 s52, s8, s65
    v_exp_f32 v160, v160
    v_mfma_f32_16x16x32_bf16 v[164:167], a[108:111], a[64:67], v[164:167]
    s_addc_u32 s53, s9, 0
    v_exp_f32 v161, v161
    v_mfma_f32_16x16x32_bf16 v[168:171], a[112:115], a[64:67], -4.0
    s_add_u32 s54, s12, s65
    ds_read_b128 a[104:107], v240 offset:576
    v_cvt_pk_bf16_f32 v192, v160, v161
    v_mfma_f32_16x16x32_bf16 v[168:171], a[116:119], a[68:71], v[168:171]
    s_addc_u32 s55, s13, 0
    v_exp_f32 v162, v162
    v_mfma_f32_16x16x32_bf16 v[168:171], a[120:123], a[72:75], v[168:171]
    s_add_u32 s26, s26, s27
    v_exp_f32 v163, v163
    v_mfma_f32_16x16x32_bf16 v[168:171], a[124:127], a[76:79], v[168:171]
    s_cmp_eq_u32 s26, s48
    ds_read_b128 a[108:111], v240 offset:512
    v_cvt_pk_bf16_f32 v193, v162, v163
    v_mfma_f32_16x16x32_bf16 v[172:175], a[128:131], a[76:79], -4.0
    s_cselect_b32 s27, s58, s59
    v_exp_f32 v164, v164
    v_mfma_f32_16x16x32_bf16 v[172:175], a[132:135], a[72:75], v[172:175]
    s_sub_u32 s23, s23, 1
    v_exp_f32 v165, v165
    v_mfma_f32_16x16x32_bf16 v[172:175], a[136:139], a[68:71], v[172:175]
    s_cmp_lg_u32 s23, 1
    ds_read_b128 a[112:115], v241 offset:0
    v_cvt_pk_bf16_f32 v194, v164, v165
    v_mfma_f32_16x16x32_bf16 v[172:175], a[140:143], a[64:67], v[172:175]
    v_exp_f32 v166, v166
    v_mfma_f32_16x16x32_bf16 v[96:99], v[184:187], a[144:147], v[96:99]
    v_exp_f32 v167, v167
    v_mfma_f32_16x16x32_bf16 v[96:99], v[188:191], a[176:179], v[96:99]
    ds_read_b128 a[116:119], v241 offset:64
    v_cvt_pk_bf16_f32 v195, v166, v167
    v_mfma_f32_16x16x32_bf16 v[100:103], v[184:187], a[148:151], v[100:103]
    v_exp_f32 v168, v168
    v_mfma_f32_16x16x32_bf16 v[100:103], v[188:191], a[180:183], v[100:103]
    v_exp_f32 v169, v169
    v_mfma_f32_16x16x32_bf16 v[104:107], v[184:187], a[152:155], v[104:107]
    ds_read_b128 a[120:123], v241 offset:128
    v_cvt_pk_bf16_f32 v196, v168, v169
    v_mfma_f32_16x16x32_bf16 v[104:107], v[188:191], a[184:187], v[104:107]
    v_exp_f32 v170, v170
    v_mfma_f32_16x16x32_bf16 v[108:111], v[184:187], a[156:159], v[108:111]
    v_exp_f32 v171, v171
    v_mfma_f32_16x16x32_bf16 v[108:111], v[188:191], a[188:191], v[108:111]
    ds_read_b128 a[124:127], v241 offset:192
    v_cvt_pk_bf16_f32 v197, v170, v171
    v_mfma_f32_16x16x32_bf16 v[112:115], v[184:187], a[160:163], v[112:115]
    v_exp_f32 v172, v172
    v_mfma_f32_16x16x32_bf16 v[112:115], v[188:191], a[192:195], v[112:115]
    v_exp_f32 v173, v173
    v_mfma_f32_16x16x32_bf16 v[116:119], v[184:187], a[164:167], v[116:119]
    ds_read_b128 a[128:131], v241 offset:704
    v_cvt_pk_bf16_f32 v198, v172, v173
    v_mfma_f32_16x16x32_bf16 v[116:119], v[188:191], a[196:199], v[116:119]
    v_exp_f32 v174, v174
    v_mfma_f32_16x16x32_bf16 v[120:123], v[184:187], a[168:171], v[120:123]
    v_exp_f32 v175, v175
    v_mfma_f32_16x16x32_bf16 v[120:123], v[188:191], a[200:203], v[120:123]
    ds_read_b128 a[132:135], v241 offset:640
    v_cvt_pk_bf16_f32 v199, v174, v175
    v_mfma_f32_16x16x32_bf16 v[124:127], v[184:187], a[172:175], v[124:127]
    ds_read_b128 a[136:139], v241 offset:576
    v_mfma_f32_16x16x32_bf16 v[124:127], v[188:191], a[204:207], v[124:127]
    ds_read_b128 a[140:143], v241 offset:512
    v_smfmac_f32_16x16x64_bf16 a[220:223], a[228:231], v[184:191], v247
    s_waitcnt lgkmcnt(4)
    v_mfma_f32_16x16x32_bf16 v[160:163], a[80:83], v[200:203], -4.0
    v_mfma_f32_16x16x32_bf16 v[160:163], a[84:87], v[204:207], v[160:163]
    v_mfma_f32_16x16x32_bf16 v[160:163], a[88:91], v[208:211], v[160:163]
    v_mfma_f32_16x16x32_bf16 v[160:163], a[92:95], v[212:215], v[160:163]
    v_mfma_f32_16x16x32_bf16 v[164:167], a[96:99], v[212:215], -4.0
    v_mfma_f32_16x16x32_bf16 v[164:167], a[100:103], v[208:211], v[164:167]
    v_mfma_f32_16x16x32_bf16 v[164:167], a[104:107], v[204:207], v[164:167]
    v_exp_f32 v160, v160
    v_mfma_f32_16x16x32_bf16 v[164:167], a[108:111], v[200:203], v[164:167]
    v_exp_f32 v161, v161
    v_mfma_f32_16x16x32_bf16 v[168:171], a[112:115], v[200:203], -4.0
    v_exp_f32 v162, v162
    v_mfma_f32_16x16x32_bf16 v[168:171], a[116:119], v[204:207], v[168:171]
    v_exp_f32 v163, v163
    v_mfma_f32_16x16x32_bf16 v[168:171], a[120:123], v[208:211], v[168:171]
    v_cvt_pk_bf16_f32 v176, v160, v161
    v_cvt_pk_bf16_f32 v177, v162, v163
    v_mfma_f32_16x16x32_bf16 v[168:171], a[124:127], v[212:215], v[168:171]
    s_waitcnt lgkmcnt(0)
    v_exp_f32 v164, v164
    v_mfma_f32_16x16x32_bf16 v[172:175], a[128:131], v[212:215], -4.0
    v_exp_f32 v165, v165
    v_mfma_f32_16x16x32_bf16 v[172:175], a[132:135], v[208:211], v[172:175]
    v_exp_f32 v166, v166
    v_mfma_f32_16x16x32_bf16 v[172:175], a[136:139], v[204:207], v[172:175]
    v_exp_f32 v167, v167
    v_mfma_f32_16x16x32_bf16 v[172:175], a[140:143], v[200:203], v[172:175]
    v_cvt_pk_bf16_f32 v178, v164, v165
    v_cvt_pk_bf16_f32 v179, v166, v167
    v_mfma_f32_16x16x32_bf16 v[128:131], v[192:195], a[144:147], v[128:131]
    ds_read_b64_tr_b16 a[144:145], v242 offset:0
    ds_read_b64_tr_b16 a[146:147], v242 offset:512
    v_mfma_f32_16x16x32_bf16 v[128:131], v[196:199], a[176:179], v[128:131]
    v_exp_f32 v168, v168
    v_mfma_f32_16x16x32_bf16 v[132:135], v[192:195], a[148:151], v[132:135]
    ds_read_b64_tr_b16 a[176:177], v243 offset:0
    ds_read_b64_tr_b16 a[178:179], v243 offset:512
    v_mfma_f32_16x16x32_bf16 v[132:135], v[196:199], a[180:183], v[132:135]
    v_exp_f32 v169, v169
    v_mfma_f32_16x16x32_bf16 v[136:139], v[192:195], a[152:155], v[136:139]
    ds_read_b64_tr_b16 a[148:149], v242 offset:16
    ds_read_b64_tr_b16 a[150:151], v242 offset:528
    v_mfma_f32_16x16x32_bf16 v[136:139], v[196:199], a[184:187], v[136:139]
    v_exp_f32 v170, v170
    v_mfma_f32_16x16x32_bf16 v[140:143], v[192:195], a[156:159], v[140:143]
    ds_read_b64_tr_b16 a[180:181], v243 offset:16
    ds_read_b64_tr_b16 a[182:183], v243 offset:528
    v_mfma_f32_16x16x32_bf16 v[140:143], v[196:199], a[188:191], v[140:143]
    v_exp_f32 v171, v171
    v_mfma_f32_16x16x32_bf16 v[144:147], v[192:195], a[160:163], v[144:147]
    ds_read_b64_tr_b16 a[152:153], v242 offset:32
    ds_read_b64_tr_b16 a[154:155], v242 offset:544
    v_mfma_f32_16x16x32_bf16 v[144:147], v[196:199], a[192:195], v[144:147]
    v_exp_f32 v172, v172
    v_mfma_f32_16x16x32_bf16 v[148:151], v[192:195], a[164:167], v[148:151]
    ds_read_b64_tr_b16 a[184:185], v243 offset:32
    ds_read_b64_tr_b16 a[186:187], v243 offset:544
    v_mfma_f32_16x16x32_bf16 v[148:151], v[196:199], a[196:199], v[148:151]
    v_exp_f32 v173, v173
    v_mfma_f32_16x16x32_bf16 v[152:155], v[192:195], a[168:171], v[152:155]
    ds_read_b64_tr_b16 a[156:157], v242 offset:48
    ds_read_b64_tr_b16 a[158:159], v242 offset:560
    v_mfma_f32_16x16x32_bf16 v[152:155], v[196:199], a[200:203], v[152:155]
    v_exp_f32 v174, v174
    v_mfma_f32_16x16x32_bf16 v[156:159], v[192:195], a[172:175], v[156:159]
    ds_read_b64_tr_b16 a[188:189], v243 offset:48
    ds_read_b64_tr_b16 a[190:191], v243 offset:560
    v_mfma_f32_16x16x32_bf16 v[156:159], v[196:199], a[204:207], v[156:159]
    v_exp_f32 v175, v175
    v_smfmac_f32_16x16x64_bf16 a[224:227], a[228:231], v[192:199], v247
    s_cbranch_scc1 L_loop1r1
L_lastr1:
    v_mfma_f32_16x16x32_bf16 v[160:163], a[80:83], v[216:219], -4.0
    ds_read_b64_tr_b16 a[160:161], v242 offset:128
    ds_read_b64_tr_b16 a[162:163], v242 offset:640
    v_mfma_f32_16x16x32_bf16 v[160:163], a[84:87], v[220:223], v[160:163]
    v_cvt_pk_bf16_f32 v180, v168, v169
    v_cvt_pk_bf16_f32 v181, v170, v171
    v_mfma_f32_16x16x32_bf16 v[160:163], a[88:91], v[224:227], v[160:163]
    ds_read_b64_tr_b16 a[192:193], v243 offset:128
    ds_read_b64_tr_b16 a[194:195], v243 offset:640
    v_mfma_f32_16x16x32_bf16 v[160:163], a[92:95], v[228:231], v[160:163]
    v_cvt_pk_bf16_f32 v182, v172, v173
    v_cvt_pk_bf16_f32 v183, v174, v175
    v_mfma_f32_16x16x32_bf16 v[164:167], a[96:99], v[228:231], -4.0
    ds_read_b64_tr_b16 a[164:165], v242 offset:144
    ds_read_b64_tr_b16 a[166:167], v242 offset:656
    v_mfma_f32_16x16x32_bf16 v[164:167], a[100:103], v[224:227], v[164:167]
    v_mfma_f32_16x16x32_bf16 v[164:167], a[104:107], v[220:223], v[164:167]
    ds_read_b64_tr_b16 a[196:197], v243 offset:144
    ds_read_b64_tr_b16 a[198:199], v243 offset:656
    v_mfma_f32_16x16x32_bf16 v[164:167], a[108:111], v[216:219], v[164:167]
    v_exp_f32 v160, v160
    v_mfma_f32_16x16x32_bf16 v[168:171], a[112:115], v[216:219], -4.0
    ds_read_b64_tr_b16 a[168:169], v242 offset:160
    ds_read_b64_tr_b16 a[170:171], v242 offset:672
    v_mfma_f32_16x16x32_bf16 v[168:171], a[116:119], v[220:223], v[168:171]
    v_exp_f32 v161, v161
    v_mfma_f32_16x16x32_bf16 v[168:171], a[120:123], v[224:227], v[168:171]
    ds_read_b64_tr_b16 a[200:201], v243 offset:160
    ds_read_b64_tr_b16 a[202:203], v243 offset:672
    v_mfma_f32_16x16x32_bf16 v[168:171], a[124:127], v[228:231], v[168:171]
    v_exp_f32 v162, v162
    v_mfma_f32_16x16x32_bf16 v[172:175], a[128:131], v[228:231], -4.0
    ds_read_b64_tr_b16 a[172:173], v242 offset:176
    ds_read_b64_tr_b16 a[174:175], v242 offset:688
    v_mfma_f32_16x16x32_bf16 v[172:175], a[132:135], v[224:227], v[172:175]
    v_exp_f32 v163, v163
    v_mfma_f32_16x16x32_bf16 v[172:175], a[136:139], v[220:223], v[172:175]
    ds_read_b64_tr_b16 a[204:205], v243 offset:176
    ds_read_b64_tr_b16 a[206:207], v243 offset:688
    v_mfma_f32_16x16x32_bf16 v[172:175], a[140:143], v[216:219], v[172:175]
    s_waitcnt lgkmcnt(8)
    v_cvt_pk_bf16_f32 v184, v160, v161
    v_cvt_pk_bf16_f32 v185, v162, v163
    v_mfma_f32_16x16x32_bf16 v[0:3], v[176:179], a[144:147], v[0:3]
    v_exp_f32 v164, v164
    v_mfma_f32_16x16x32_bf16 v[0:3], v[180:183], a[176:179], v[0:3]
    v_exp_f32 v165, v165
    v_smfmac_f32_16x16x64_bf16 a[208:211], a[228:231], v[176:183], v247
    v_mfma_f32_16x16x32_bf16 v[4:7], v[176:179], a[148:151], v[4:7]
    v_exp_f32 v166, v166
    v_mfma_f32_16x16x32_bf16 v[4:7], v[180:183], a[180:183], v[4:7]
    v_exp_f32 v167, v167
    v_mfma_f32_16x16x32_bf16 v[8:11], v[176:179], a[152:155], v[8:11]
    v_cvt_pk_bf16_f32 v186, v164, v165
    v_cvt_pk_bf16_f32 v187, v166, v167
    v_mfma_f32_16x16x32_bf16 v[8:11], v[180:183], a[184:187], v[8:11]
    v_exp_f32 v168, v168
    v_mfma_f32_16x16x32_bf16 v[12:15], v[176:179], a[156:159], v[12:15]
    v_exp_f32 v169, v169
    v_mfma_f32_16x16x32_bf16 v[12:15], v[180:183], a[188:191], v[12:15]
    v_exp_f32 v170, v170
    v_mfma_f32_16x16x32_bf16 v[16:19], v[176:179], a[160:163], v[16:19]
    v_exp_f32 v171, v171
    v_mfma_f32_16x16x32_bf16 v[16:19], v[180:183], a[192:195], v[16:19]
    v_cvt_pk_bf16_f32 v188, v168, v169
    v_cvt_pk_bf16_f32 v189, v170, v171
    v_mfma_f32_16x16x32_bf16 v[20:23], v[176:179], a[164:167], v[20:23]
    v_exp_f32 v172, v172
    v_mfma_f32_16x16x32_bf16 v[20:23], v[180:183], a[196:199], v[20:23]
    s_waitcnt lgkmcnt(0)
    v_exp_f32 v173, v173
    v_mfma_f32_16x16x32_bf16 v[24:27], v[176:179], a[168:171], v[24:27]
    v_exp_f32 v174, v174
    v_mfma_f32_16x16x32_bf16 v[24:27], v[180:183], a[200:203], v[24:27]
    v_exp_f32 v175, v175
    v_mfma_f32_16x16x32_bf16 v[28:31], v[176:179], a[172:175], v[28:31]
    v_cvt_pk_bf16_f32 v190, v172, v173
    v_cvt_pk_bf16_f32 v191, v174, v175
    v_mfma_f32_16x16x32_bf16 v[28:31], v[180:183], a[204:207], v[28:31]
    v_accvgpr_read_b32 v248, a208
    v_accvgpr_read_b32 v249, a209
    v_mfma_f32_16x16x32_bf16 v[160:163], a[80:83], a[32:35], -4.0
    v_add_f32 v248, v248, v249
    v_subrev_u32 v249, s42, v248
    v_mfma_f32_16x16x32_bf16 v[160:163], a[84:87], a[36:39], v[160:163]
    v_rcp_f32 v248, v248
    v_mfma_f32_16x16x32_bf16 v[160:163], a[88:91], a[40:43], v[160:163]
    v_cmp_le_u32 vcc, s43, v249
    v_mov_b32 v251, v248
    v_mov_b32_dpp v251, v248 row_ror:12 row_mask:0x2 bank_mask:0xf
    v_mov_b32_dpp v251, v248 row_ror:8 row_mask:0x4 bank_mask:0xf
    v_mov_b32_dpp v251, v248 row_ror:4 row_mask:0x8 bank_mask:0xf
    s_nop 1
    v_mov_b32_dpp v248, v251 row_newbcast:0 row_mask:0xf bank_mask:0xf
    v_mov_b32_dpp v249, v251 row_newbcast:1 row_mask:0xf bank_mask:0xf
    v_mov_b32_dpp v250, v251 row_newbcast:2 row_mask:0xf bank_mask:0xf
    v_mov_b32_dpp v251, v251 row_newbcast:3 row_mask:0xf bank_mask:0xf
    v_pk_mul_f32 v[0:1], v[0:1], v[248:249]
    v_pk_mul_f32 v[2:3], v[2:3], v[250:251]
    v_pk_mul_f32 v[4:5], v[4:5], v[248:249]
    v_pk_mul_f32 v[6:7], v[6:7], v[250:251]
    v_pk_mul_f32 v[8:9], v[8:9], v[248:249]
    v_pk_mul_f32 v[10:11], v[10:11], v[250:251]
    v_pk_mul_f32 v[12:13], v[12:13], v[248:249]
    v_pk_mul_f32 v[14:15], v[14:15], v[250:251]
    v_pk_mul_f32 v[16:17], v[16:17], v[248:249]
    v_pk_mul_f32 v[18:19], v[18:19], v[250:251]
    v_pk_mul_f32 v[20:21], v[20:21], v[248:249]
    v_pk_mul_f32 v[22:23], v[22:23], v[250:251]
    v_pk_mul_f32 v[24:25], v[24:25], v[248:249]
    v_pk_mul_f32 v[26:27], v[26:27], v[250:251]
    v_pk_mul_f32 v[28:29], v[28:29], v[248:249]
    v_pk_mul_f32 v[30:31], v[30:31], v[250:251]
    v_cvt_pk_bf16_f32 v0, v0, v4
    v_cvt_pk_bf16_f32 v4, v1, v5
    v_cvt_pk_bf16_f32 v1, v8, v12
    v_cvt_pk_bf16_f32 v5, v9, v13
    v_mfma_f32_16x16x32_bf16 v[160:163], a[92:95], a[44:47], v[160:163]
    s_or_b64 s[46:47], s[46:47], vcc
    ds_write_b64 v246, v[0:1] offset:5440
    v_cvt_pk_bf16_f32 v16, v16, v20
    v_cvt_pk_bf16_f32 v20, v17, v21
    v_mfma_f32_16x16x32_bf16 v[164:167], a[96:99], a[44:47], -4.0
    ds_write_b64 v246, v[4:5] offset:6528
    v_cvt_pk_bf16_f32 v17, v24, v28
    v_cvt_pk_bf16_f32 v21, v25, v29
    v_mfma_f32_16x16x32_bf16 v[164:167], a[100:103], a[40:43], v[164:167]
    ds_write_b64 v246, v[16:17] offset:5568
    v_cvt_pk_bf16_f32 v2, v2, v6
    v_cvt_pk_bf16_f32 v6, v3, v7
    v_mfma_f32_16x16x32_bf16 v[164:167], a[104:107], a[36:39], v[164:167]
    ds_write_b64 v246, v[20:21] offset:6656
    v_exp_f32 v160, v160
    v_cvt_pk_bf16_f32 v3, v10, v14
    v_cvt_pk_bf16_f32 v7, v11, v15
    v_mfma_f32_16x16x32_bf16 v[164:167], a[108:111], a[32:35], v[164:167]
    ds_read_b64_tr_b16 v[216:217], v252 offset:5440
    ds_read_b64_tr_b16 v[218:219], v252 offset:5472
    v_exp_f32 v161, v161
    v_cvt_pk_bf16_f32 v18, v18, v22
    v_cvt_pk_bf16_f32 v22, v19, v23
    v_mfma_f32_16x16x32_bf16 v[168:171], a[112:115], a[32:35], -4.0
    ds_read_b64_tr_b16 v[220:221], v252 offset:6528
    ds_read_b64_tr_b16 v[222:223], v252 offset:6560
    v_exp_f32 v162, v162
    v_cvt_pk_bf16_f32 v19, v26, v30
    v_cvt_pk_bf16_f32 v23, v27, v31
    v_mfma_f32_16x16x32_bf16 v[168:171], a[116:119], a[36:39], v[168:171]
    ds_write_b64 v246, v[2:3] offset:7616
    v_exp_f32 v163, v163
    v_mfma_f32_16x16x32_bf16 v[168:171], a[120:123], a[40:43], v[168:171]
L_pad1_7:
    s_cbranch_execz L_ret1
    ds_write_b64 v246, v[6:7] offset:8704
    v_cvt_pk_bf16_f32 v176, v160, v161
    v_cvt_pk_bf16_f32 v177, v162, v163
    v_mfma_f32_16x16x32_bf16 v[168:171], a[124:127], a[44:47], v[168:171]
    ds_write_b64 v246, v[18:19] offset:7744
    v_exp_f32 v164, v164
    v_mfma_f32_16x16x32_bf16 v[172:175], a[128:131], a[44:47], -4.0
    ds_write_b64 v246, v[22:23] offset:8832
    v_exp_f32 v165, v165
    v_mfma_f32_16x16x32_bf16 v[172:175], a[132:135], a[40:43], v[172:175]
    s_waitcnt lgkmcnt(6)
    buffer_store_dwordx4 v[216:219], v244, s[16:19], s35 offen offset:0 nt
    v_exp_f32 v166, v166
    v_mfma_f32_16x16x32_bf16 v[172:175], a[136:139], a[36:39], v[172:175]
    ds_read_b64_tr_b16 v[224:225], v252 offset:7616
    ds_read_b64_tr_b16 v[226:227], v252 offset:7648
    v_exp_f32 v167, v167
    v_mfma_f32_16x16x32_bf16 v[172:175], a[140:143], a[32:35], v[172:175]
    ds_read_b64_tr_b16 v[228:229], v252 offset:8704
    ds_read_b64_tr_b16 v[230:231], v252 offset:8736
    v_cvt_pk_bf16_f32 v178, v164, v165
    v_cvt_pk_bf16_f32 v179, v166, v167
    v_mfma_f32_16x16x32_bf16 v[32:35], v[184:187], a[144:147], v[32:35]
    v_exp_f32 v168, v168
    v_mfma_f32_16x16x32_bf16 v[32:35], v[188:191], a[176:179], v[32:35]
    v_exp_f32 v169, v169
    v_smfmac_f32_16x16x64_bf16 a[212:215], a[228:231], v[184:191], v247
    s_waitcnt lgkmcnt(7)
    buffer_store_dwordx4 v[220:223], v244, s[16:19], s35 offen offset:1024 nt
    v_mfma_f32_16x16x32_bf16 v[36:39], v[184:187], a[148:151], v[36:39]
    v_exp_f32 v170, v170
    v_mfma_f32_16x16x32_bf16 v[36:39], v[188:191], a[180:183], v[36:39]
    v_exp_f32 v171, v171
    v_mfma_f32_16x16x32_bf16 v[40:43], v[184:187], a[152:155], v[40:43]
    s_waitcnt lgkmcnt(2)
    buffer_store_dwordx4 v[224:227], v244, s[16:19], s35 offen offset:2048 nt
    v_cvt_pk_bf16_f32 v180, v168, v169
    v_cvt_pk_bf16_f32 v181, v170, v171
    v_mfma_f32_16x16x32_bf16 v[40:43], v[188:191], a[184:187], v[40:43]
    v_exp_f32 v172, v172
    v_mfma_f32_16x16x32_bf16 v[44:47], v[184:187], a[156:159], v[44:47]
    v_exp_f32 v173, v173
    v_mfma_f32_16x16x32_bf16 v[44:47], v[188:191], a[188:191], v[44:47]
    s_waitcnt lgkmcnt(0)
    buffer_store_dwordx4 v[228:231], v244, s[16:19], s35 offen offset:3072 nt
    v_exp_f32 v174, v174
    v_mfma_f32_16x16x32_bf16 v[48:51], v[184:187], a[160:163], v[48:51]
    v_exp_f32 v175, v175
    v_mfma_f32_16x16x32_bf16 v[48:51], v[188:191], a[192:195], v[48:51]
    v_cvt_pk_bf16_f32 v182, v172, v173
    v_cvt_pk_bf16_f32 v183, v174, v175
    v_mfma_f32_16x16x32_bf16 v[52:55], v[184:187], a[164:167], v[52:55]
    v_accvgpr_read_b32 v248, a212
    v_accvgpr_read_b32 v249, a213
    v_mfma_f32_16x16x32_bf16 v[52:55], v[188:191], a[196:199], v[52:55]
    v_add_f32 v248, v248, v249
    v_subrev_u32 v249, s42, v248
    v_mfma_f32_16x16x32_bf16 v[56:59], v[184:187], a[168:171], v[56:59]
    v_rcp_f32 v248, v248
    v_mfma_f32_16x16x32_bf16 v[56:59], v[188:191], a[200:203], v[56:59]
    v_cmp_le_u32 vcc, s43, v249
    v_mov_b32 v251, v248
    v_mfma_f32_16x16x32_bf16 v[60:63], v[184:187], a[172:175], v[60:63]
    v_mov_b32_dpp v251, v248 row_ror:12 row_mask:0x2 bank_mask:0xf
    v_mov_b32_dpp v251, v248 row_ror:8 row_mask:0x4 bank_mask:0xf
    v_mfma_f32_16x16x32_bf16 v[60:63], v[188:191], a[204:207], v[60:63]
    s_or_b64 s[46:47], s[46:47], vcc
    v_mov_b32_dpp v251, v248 row_ror:4 row_mask:0x8 bank_mask:0xf
    v_mfma_f32_16x16x32_bf16 v[160:163], a[80:83], a[48:51], -4.0
    v_mfma_f32_16x16x32_bf16 v[160:163], a[84:87], a[52:55], v[160:163]
    v_mfma_f32_16x16x32_bf16 v[160:163], a[88:91], a[56:59], v[160:163]
    v_mov_b32_dpp v248, v251 row_newbcast:0 row_mask:0xf bank_mask:0xf
    v_mov_b32_dpp v249, v251 row_newbcast:1 row_mask:0xf bank_mask:0xf
    v_mov_b32_dpp v250, v251 row_newbcast:2 row_mask:0xf bank_mask:0xf
    v_mov_b32_dpp v251, v251 row_newbcast:3 row_mask:0xf bank_mask:0xf
    v_pk_mul_f32 v[32:33], v[32:33], v[248:249]
    v_pk_mul_f32 v[34:35], v[34:35], v[250:251]
    v_pk_mul_f32 v[36:37], v[36:37], v[248:249]
    v_pk_mul_f32 v[38:39], v[38:39], v[250:251]
    v_pk_mul_f32 v[40:41], v[40:41], v[248:249]
    v_pk_mul_f32 v[42:43], v[42:43], v[250:251]
    v_pk_mul_f32 v[44:45], v[44:45], v[248:249]
    v_pk_mul_f32 v[46:47], v[46:47], v[250:251]
    v_pk_mul_f32 v[48:49], v[48:49], v[248:249]
    v_pk_mul_f32 v[50:51], v[50:51], v[250:251]
    v_pk_mul_f32 v[52:53], v[52:53], v[248:249]
    v_pk_mul_f32 v[54:55], v[54:55], v[250:251]
    v_pk_mul_f32 v[56:57], v[56:57], v[248:249]
    v_pk_mul_f32 v[58:59], v[58:59], v[250:251]
    v_pk_mul_f32 v[60:61], v[60:61], v[248:249]
    v_pk_mul_f32 v[62:63], v[62:63], v[250:251]
    v_cvt_pk_bf16_f32 v32, v32, v36
    v_cvt_pk_bf16_f32 v36, v33, v37
    v_cvt_pk_bf16_f32 v33, v40, v44
    v_cvt_pk_bf16_f32 v37, v41, v45
    v_mfma_f32_16x16x32_bf16 v[160:163], a[92:95], a[60:63], v[160:163]
    ds_write_b64 v246, v[32:33] offset:1088
    v_cvt_pk_bf16_f32 v48, v48, v52
    v_cvt_pk_bf16_f32 v52, v49, v53
    v_mfma_f32_16x16x32_bf16 v[164:167], a[96:99], a[60:63], -4.0
    ds_write_b64 v246, v[36:37] offset:2176
    v_cvt_pk_bf16_f32 v49, v56, v60
    v_cvt_pk_bf16_f32 v53, v57, v61
    v_mfma_f32_16x16x32_bf16 v[164:167], a[100:103], a[56:59], v[164:167]
    ds_write_b64 v246, v[48:49] offset:1216
    v_cvt_pk_bf16_f32 v34, v34, v38
    v_cvt_pk_bf16_f32 v38, v35, v39
    v_mfma_f32_16x16x32_bf16 v[164:167], a[104:107], a[52:55], v[164:167]
    ds_write_b64 v246, v[52:53] offset:2304
    v_exp_f32 v160, v160
    v_cvt_pk_bf16_f32 v35, v42, v46
    v_cvt_pk_bf16_f32 v39, v43, v47
    v_mfma_f32_16x16x32_bf16 v[164:167], a[108:111], a[48:51], v[164:167]
    ds_read_b64_tr_b16 v[200:201], v252 offset:1088
    ds_read_b64_tr_b16 v[202:203], v252 offset:1120
    v_exp_f32 v161, v161
    v_cvt_pk_bf16_f32 v50, v50, v54
    v_cvt_pk_bf16_f32 v54, v51, v55
    v_mfma_f32_16x16x32_bf16 v[168:171], a[112:115], a[48:51], -4.0
    ds_read_b64_tr_b16 v[204:205], v252 offset:2176
    ds_read_b64_tr_b16 v[206:207], v252 offset:2208
    v_exp_f32 v162, v162
    v_cvt_pk_bf16_f32 v51, v58, v62
    v_cvt_pk_bf16_f32 v55, v59, v63
    v_mfma_f32_16x16x32_bf16 v[168:171], a[116:119], a[52:55], v[168:171]
    ds_write_b64 v246, v[34:35] offset:3264
    v_exp_f32 v163, v163
    v_mfma_f32_16x16x32_bf16 v[168:171], a[120:123], a[56:59], v[168:171]
    ds_write_b64 v246, v[38:39] offset:4352
    v_cvt_pk_bf16_f32 v184, v160, v161
    v_cvt_pk_bf16_f32 v185, v162, v163
    v_mfma_f32_16x16x32_bf16 v[168:171], a[124:127], a[60:63], v[168:171]
    ds_write_b64 v246, v[50:51] offset:3392
    v_exp_f32 v164, v164
    v_mfma_f32_16x16x32_bf16 v[172:175], a[128:131], a[60:63], -4.0
    ds_write_b64 v246, v[54:55] offset:4480
    v_exp_f32 v165, v165
    v_mfma_f32_16x16x32_bf16 v[172:175], a[132:135], a[56:59], v[172:175]
    s_waitcnt lgkmcnt(6)
    buffer_store_dwordx4 v[200:203], v244, s[16:19], s36 offen offset:0 nt
    v_exp_f32 v166, v166
    v_mfma_f32_16x16x32_bf16 v[172:175], a[136:139], a[52:55], v[172:175]
    ds_read_b64_tr_b16 v[208:209], v252 offset:3264
    ds_read_b64_tr_b16 v[210:211], v252 offset:3296
    v_exp_f32 v167, v167
    v_mfma_f32_16x16x32_bf16 v[172:175], a[140:143], a[48:51], v[172:175]
    ds_read_b64_tr_b16 v[212:213], v252 offset:4352
    ds_read_b64_tr_b16 v[214:215], v252 offset:4384
    v_cvt_pk_bf16_f32 v186, v164, v165
    v_cvt_pk_bf16_f32 v187, v166, v167
    v_mfma_f32_16x16x32_bf16 v[64:67], v[176:179], a[144:147], v[64:67]
    v_exp_f32 v168, v168
    v_mfma_f32_16x16x32_bf16 v[64:67], v[180:183], a[176:179], v[64:67]
    v_exp_f32 v169, v169
    v_smfmac_f32_16x16x64_bf16 a[216:219], a[228:231], v[176:183], v247
    s_waitcnt lgkmcnt(7)
    buffer_store_dwordx4 v[204:207], v244, s[16:19], s36 offen offset:1024 nt
    v_mfma_f32_16x16x32_bf16 v[68:71], v[176:179], a[148:151], v[68:71]
    v_exp_f32 v170, v170
    v_mfma_f32_16x16x32_bf16 v[68:71], v[180:183], a[180:183], v[68:71]
    v_exp_f32 v171, v171
    v_mfma_f32_16x16x32_bf16 v[72:75], v[176:179], a[152:155], v[72:75]
    s_waitcnt lgkmcnt(2)
    buffer_store_dwordx4 v[208:211], v244, s[16:19], s36 offen offset:2048 nt
    v_cvt_pk_bf16_f32 v188, v168, v169
    v_cvt_pk_bf16_f32 v189, v170, v171
    v_mfma_f32_16x16x32_bf16 v[72:75], v[180:183], a[184:187], v[72:75]
    v_exp_f32 v172, v172
    v_mfma_f32_16x16x32_bf16 v[76:79], v[176:179], a[156:159], v[76:79]
    v_exp_f32 v173, v173
    v_mfma_f32_16x16x32_bf16 v[76:79], v[180:183], a[188:191], v[76:79]
    s_waitcnt lgkmcnt(0)
    buffer_store_dwordx4 v[212:215], v244, s[16:19], s36 offen offset:3072 nt
    v_exp_f32 v174, v174
    v_mfma_f32_16x16x32_bf16 v[80:83], v[176:179], a[160:163], v[80:83]
    v_exp_f32 v175, v175
    v_mfma_f32_16x16x32_bf16 v[80:83], v[180:183], a[192:195], v[80:83]
    v_cvt_pk_bf16_f32 v190, v172, v173
    v_cvt_pk_bf16_f32 v191, v174, v175
    v_mfma_f32_16x16x32_bf16 v[84:87], v[176:179], a[164:167], v[84:87]
    v_accvgpr_read_b32 v248, a216
    v_accvgpr_read_b32 v249, a217
    v_mfma_f32_16x16x32_bf16 v[84:87], v[180:183], a[196:199], v[84:87]
    v_add_f32 v248, v248, v249
    v_subrev_u32 v249, s42, v248
    v_mfma_f32_16x16x32_bf16 v[88:91], v[176:179], a[168:171], v[88:91]
    v_rcp_f32 v248, v248
    v_mfma_f32_16x16x32_bf16 v[88:91], v[180:183], a[200:203], v[88:91]
    v_cmp_le_u32 vcc, s43, v249
    v_mov_b32 v251, v248
    v_mfma_f32_16x16x32_bf16 v[92:95], v[176:179], a[172:175], v[92:95]
    v_mov_b32_dpp v251, v248 row_ror:12 row_mask:0x2 bank_mask:0xf
    v_mov_b32_dpp v251, v248 row_ror:8 row_mask:0x4 bank_mask:0xf
    v_mfma_f32_16x16x32_bf16 v[92:95], v[180:183], a[204:207], v[92:95]
    s_or_b64 s[46:47], s[46:47], vcc
    v_mov_b32_dpp v251, v248 row_ror:4 row_mask:0x8 bank_mask:0xf
    v_mfma_f32_16x16x32_bf16 v[160:163], a[80:83], a[64:67], -4.0
    v_mfma_f32_16x16x32_bf16 v[160:163], a[84:87], a[68:71], v[160:163]
    v_mfma_f32_16x16x32_bf16 v[160:163], a[88:91], a[72:75], v[160:163]
    v_mov_b32_dpp v248, v251 row_newbcast:0 row_mask:0xf bank_mask:0xf
    v_mov_b32_dpp v249, v251 row_newbcast:1 row_mask:0xf bank_mask:0xf
    v_mov_b32_dpp v250, v251 row_newbcast:2 row_mask:0xf bank_mask:0xf
    v_mov_b32_dpp v251, v251 row_newbcast:3 row_mask:0xf bank_mask:0xf
    v_pk_mul_f32 v[64:65], v[64:65], v[248:249]
    v_pk_mul_f32 v[66:67], v[66:67], v[250:251]
    v_pk_mul_f32 v[68:69], v[68:69], v[248:249]
    v_pk_mul_f32 v[70:71], v[70:71], v[250:251]
    v_pk_mul_f32 v[72:73], v[72:73], v[248:249]
    v_pk_mul_f32 v[74:75], v[74:75], v[250:251]
    v_pk_mul_f32 v[76:77], v[76:77], v[248:249]
    v_pk_mul_f32 v[78:79], v[78:79], v[250:251]
    v_pk_mul_f32 v[80:81], v[80:81], v[248:249]
    v_pk_mul_f32 v[82:83], v[82:83], v[250:251]
    v_pk_mul_f32 v[84:85], v[84:85], v[248:249]
    v_pk_mul_f32 v[86:87], v[86:87], v[250:251]
    v_pk_mul_f32 v[88:89], v[88:89], v[248:249]
    v_pk_mul_f32 v[90:91], v[90:91], v[250:251]
    v_pk_mul_f32 v[92:93], v[92:93], v[248:249]
    v_pk_mul_f32 v[94:95], v[94:95], v[250:251]
    v_cvt_pk_bf16_f32 v64, v64, v68
    v_cvt_pk_bf16_f32 v68, v65, v69
    v_cvt_pk_bf16_f32 v65, v72, v76
    v_cvt_pk_bf16_f32 v69, v73, v77
    v_mfma_f32_16x16x32_bf16 v[160:163], a[92:95], a[76:79], v[160:163]
    ds_write_b64 v246, v[64:65] offset:9792
    v_cvt_pk_bf16_f32 v80, v80, v84
    v_cvt_pk_bf16_f32 v84, v81, v85
    v_mfma_f32_16x16x32_bf16 v[164:167], a[96:99], a[76:79], -4.0
    ds_write_b64 v246, v[68:69] offset:10880
    v_cvt_pk_bf16_f32 v81, v88, v92
    v_cvt_pk_bf16_f32 v85, v89, v93
    v_mfma_f32_16x16x32_bf16 v[164:167], a[100:103], a[72:75], v[164:167]
    ds_write_b64 v246, v[80:81] offset:9920
    v_cvt_pk_bf16_f32 v66, v66, v70
    v_cvt_pk_bf16_f32 v70, v67, v71
    v_mfma_f32_16x16x32_bf16 v[164:167], a[104:107], a[68:71], v[164:167]
    ds_write_b64 v246, v[84:85] offset:11008
    v_exp_f32 v160, v160
    v_cvt_pk_bf16_f32 v67, v74, v78
    v_cvt_pk_bf16_f32 v71, v75, v79
    v_mfma_f32_16x16x32_bf16 v[164:167], a[108:111], a[64:67], v[164:167]
    ds_read_b64_tr_b16 v[216:217], v252 offset:9792
    ds_read_b64_tr_b16 v[218:219], v252 offset:9824
    v_exp_f32 v161, v161
    v_cvt_pk_bf16_f32 v82, v82, v86
    v_cvt_pk_bf16_f32 v86, v83, v87
    v_mfma_f32_16x16x32_bf16 v[168:171], a[112:115], a[64:67], -4.0
    ds_read_b64_tr_b16 v[220:221], v252 offset:10880
    ds_read_b64_tr_b16 v[222:223], v252 offset:10912
    v_exp_f32 v162, v162
    v_cvt_pk_bf16_f32 v83, v90, v94
    v_cvt_pk_bf16_f32 v87, v91, v95
    v_mfma_f32_16x16x32_bf16 v[168:171], a[116:119], a[68:71], v[168:171]
    ds_write_b64 v246, v[66:67] offset:11968
    v_exp_f32 v163, v163
    v_mfma_f32_16x16x32_bf16 v[168:171], a[120:123], a[72:75], v[168:171]
    ds_write_b64 v246, v[70:71] offset:13056
    v_cvt_pk_bf16_f32 v192, v160, v161
    v_mfma_f32_16x16x32_bf16 v[168:171], a[124:127], a[76:79], v[168:171]
    ds_write_b64 v246, v[82:83] offset:12096
    v_cvt_pk_bf16_f32 v193, v162, v163
    v_mfma_f32_16x16x32_bf16 v[172:175], a[128:131], a[76:79], -4.0
    ds_write_b64 v246, v[86:87] offset:13184
    v_exp_f32 v164, v164
    v_mfma_f32_16x16x32_bf16 v[172:175], a[132:135], a[72:75], v[172:175]
    s_waitcnt lgkmcnt(6)
    buffer_store_dwordx4 v[216:219], v244, s[16:19], s37 offen offset:0 nt
    v_exp_f32 v165, v165
    v_mfma_f32_16x16x32_bf16 v[172:175], a[136:139], a[68:71], v[172:175]
    v_exp_f32 v166, v166
    v_mfma_f32_16x16x32_bf16 v[172:175], a[140:143], a[64:67], v[172:175]
    v_exp_f32 v167, v167
    v_mfma_f32_16x16x32_bf16 v[96:99], v[184:187], a[144:147], v[96:99]
    ds_read_b64_tr_b16 v[224:225], v252 offset:11968
    ds_read_b64_tr_b16 v[226:227], v252 offset:12000
    v_cvt_pk_bf16_f32 v194, v164, v165
    v_mfma_f32_16x16x32_bf16 v[96:99], v[188:191], a[176:179], v[96:99]
    ds_read_b64_tr_b16 v[228:229], v252 offset:13056
    ds_read_b64_tr_b16 v[230:231], v252 offset:13088
    v_cvt_pk_bf16_f32 v195, v166, v167
    v_smfmac_f32_16x16x64_bf16 a[220:223], a[228:231], v[184:191], v247
    s_waitcnt lgkmcnt(7)
    buffer_store_dwordx4 v[220:223], v244, s[16:19], s37 offen offset:1024 nt
    v_mfma_f32_16x16x32_bf16 v[100:103], v[184:187], a[148:151], v[100:103]
    v_exp_f32 v168, v168
    v_mfma_f32_16x16x32_bf16 v[100:103], v[188:191], a[180:183], v[100:103]
    v_exp_f32 v169, v169
    v_mfma_f32_16x16x32_bf16 v[104:107], v[184:187], a[152:155], v[104:107]
    s_waitcnt lgkmcnt(2)
    buffer_store_dwordx4 v[224:227], v244, s[16:19], s37 offen offset:2048 nt
    v_exp_f32 v170, v170
    v_mfma_f32_16x16x32_bf16 v[104:107], v[188:191], a[184:187], v[104:107]
    v_exp_f32 v171, v171
    v_mfma_f32_16x16x32_bf16 v[108:111], v[184:187], a[156:159], v[108:111]
    v_cvt_pk_bf16_f32 v196, v168, v169
    v_mfma_f32_16x16x32_bf16 v[108:111], v[188:191], a[188:191], v[108:111]
    s_waitcnt lgkmcnt(0)
    buffer_store_dwordx4 v[228:231], v244, s[16:19], s37 offen offset:3072 nt
    v_cvt_pk_bf16_f32 v197, v170, v171
    v_mfma_f32_16x16x32_bf16 v[112:115], v[184:187], a[160:163], v[112:115]
    v_exp_f32 v172, v172
    v_mfma_f32_16x16x32_bf16 v[112:115], v[188:191], a[192:195], v[112:115]
    v_exp_f32 v173, v173
    v_mfma_f32_16x16x32_bf16 v[116:119], v[184:187], a[164:167], v[116:119]
    v_exp_f32 v174, v174
    v_mfma_f32_16x16x32_bf16 v[116:119], v[188:191], a[196:199], v[116:119]
    v_exp_f32 v175, v175
    v_mfma_f32_16x16x32_bf16 v[120:123], v[184:187], a[168:171], v[120:123]
    v_cvt_pk_bf16_f32 v198, v172, v173
    v_accvgpr_read_b32 v248, a220
    v_mfma_f32_16x16x32_bf16 v[120:123], v[188:191], a[200:203], v[120:123]
    v_cvt_pk_bf16_f32 v199, v174, v175
    v_accvgpr_read_b32 v249, a221
    v_mfma_f32_16x16x32_bf16 v[124:127], v[184:187], a[172:175], v[124:127]
    v_add_f32 v248, v248, v249
    v_subrev_u32 v249, s42, v248
    v_mfma_f32_16x16x32_bf16 v[124:127], v[188:191], a[204:207], v[124:127]
    v_rcp_f32 v248, v248
    v_mfma_f32_16x16x32_bf16 v[128:131], v[192:195], a[144:147], v[128:131]
    v_cmp_le_u32 vcc, s43, v249
    v_mov_b32 v251, v248
    v_mfma_f32_16x16x32_bf16 v[128:131], v[196:199], a[176:179], v[128:131]
    v_mov_b32_dpp v251, v248 row_ror:12 row_mask:0x2 bank_mask:0xf
    v_mov_b32_dpp v251, v248 row_ror:8 row_mask:0x4 bank_mask:0xf
    v_smfmac_f32_16x16x64_bf16 a[224:227], a[228:231], v[192:199], v247
    s_or_b64 s[46:47], s[46:47], vcc
    v_mfma_f32_16x16x32_bf16 v[132:135], v[192:195], a[148:151], v[132:135]
    v_mov_b32_dpp v251, v248 row_ror:4 row_mask:0x8 bank_mask:0xf
    s_nop 1
    v_mov_b32_dpp v248, v251 row_newbcast:0 row_mask:0xf bank_mask:0xf
    v_mov_b32_dpp v249, v251 row_newbcast:1 row_mask:0xf bank_mask:0xf
    v_mov_b32_dpp v250, v251 row_newbcast:2 row_mask:0xf bank_mask:0xf
    v_mov_b32_dpp v251, v251 row_newbcast:3 row_mask:0xf bank_mask:0xf
    v_pk_mul_f32 v[96:97], v[96:97], v[248:249]
    v_pk_mul_f32 v[98:99], v[98:99], v[250:251]
    v_pk_mul_f32 v[100:101], v[100:101], v[248:249]
    v_pk_mul_f32 v[102:103], v[102:103], v[250:251]
    v_pk_mul_f32 v[104:105], v[104:105], v[248:249]
    v_pk_mul_f32 v[106:107], v[106:107], v[250:251]
    v_pk_mul_f32 v[108:109], v[108:109], v[248:249]
    v_pk_mul_f32 v[110:111], v[110:111], v[250:251]
    v_pk_mul_f32 v[112:113], v[112:113], v[248:249]
    v_pk_mul_f32 v[114:115], v[114:115], v[250:251]
    v_pk_mul_f32 v[116:117], v[116:117], v[248:249]
    v_pk_mul_f32 v[118:119], v[118:119], v[250:251]
    v_pk_mul_f32 v[120:121], v[120:121], v[248:249]
    v_pk_mul_f32 v[122:123], v[122:123], v[250:251]
    v_pk_mul_f32 v[124:125], v[124:125], v[248:249]
    v_pk_mul_f32 v[126:127], v[126:127], v[250:251]
    v_cvt_pk_bf16_f32 v96, v96, v100
    v_cvt_pk_bf16_f32 v100, v97, v101
    v_cvt_pk_bf16_f32 v97, v104, v108
    v_cvt_pk_bf16_f32 v101, v105, v109
    v_mfma_f32_16x16x32_bf16 v[132:135], v[196:199], a[180:183], v[132:135]
    ds_write_b64 v246, v[96:97] offset:5440
    v_cvt_pk_bf16_f32 v112, v112, v116
    v_cvt_pk_bf16_f32 v116, v113, v117
    v_mfma_f32_16x16x32_bf16 v[136:139], v[192:195], a[152:155], v[136:139]
    ds_write_b64 v246, v[100:101] offset:6528
    v_cvt_pk_bf16_f32 v113, v120, v124
    v_cvt_pk_bf16_f32 v117, v121, v125
    v_mfma_f32_16x16x32_bf16 v[136:139], v[196:199], a[184:187], v[136:139]
    ds_write_b64 v246, v[112:113] offset:5568
    v_cvt_pk_bf16_f32 v98, v98, v102
    v_cvt_pk_bf16_f32 v102, v99, v103
    v_mfma_f32_16x16x32_bf16 v[140:143], v[192:195], a[156:159], v[140:143]
    ds_write_b64 v246, v[116:117] offset:6656
    v_cvt_pk_bf16_f32 v99, v106, v110
    v_cvt_pk_bf16_f32 v103, v107, v111
    v_mfma_f32_16x16x32_bf16 v[140:143], v[196:199], a[188:191], v[140:143]
    ds_read_b64_tr_b16 v[200:201], v252 offset:5440
    ds_read_b64_tr_b16 v[202:203], v252 offset:5472
    v_cvt_pk_bf16_f32 v114, v114, v118
    v_cvt_pk_bf16_f32 v118, v115, v119
    v_mfma_f32_16x16x32_bf16 v[144:147], v[192:195], a[160:163], v[144:147]
    ds_read_b64_tr_b16 v[204:205], v252 offset:6528
    ds_read_b64_tr_b16 v[206:207], v252 offset:6560
    v_cvt_pk_bf16_f32 v115, v122, v126
    v_cvt_pk_bf16_f32 v119, v123, v127
    v_mfma_f32_16x16x32_bf16 v[144:147], v[196:199], a[192:195], v[144:147]
    ds_write_b64 v246, v[98:99] offset:7616
    v_mfma_f32_16x16x32_bf16 v[148:151], v[192:195], a[164:167], v[148:151]
    ds_write_b64 v246, v[102:103] offset:8704
    v_mfma_f32_16x16x32_bf16 v[148:151], v[196:199], a[196:199], v[148:151]
    ds_write_b64 v246, v[114:115] offset:7744
    v_mfma_f32_16x16x32_bf16 v[152:155], v[192:195], a[168:171], v[152:155]
    ds_write_b64 v246, v[118:119] offset:8832
    v_mfma_f32_16x16x32_bf16 v[152:155], v[196:199], a[200:203], v[152:155]
    s_waitcnt lgkmcnt(6)
    buffer_store_dwordx4 v[200:203], v244, s[16:19], s38 offen offset:0 nt
    v_accvgpr_read_b32 v248, a224
    v_accvgpr_read_b32 v249, a225
    v_add_f32 v248, v248, v249
    v_subrev_u32 v249, s42, v248
    v_rcp_f32 v248, v248
    v_cmp_le_u32 vcc, s43, v249
    v_mfma_f32_16x16x32_bf16 v[156:159], v[192:195], a[172:175], v[156:159]
    ds_read_b64_tr_b16 v[208:209], v252 offset:7616
    ds_read_b64_tr_b16 v[210:211], v252 offset:7648
    v_mov_b32 v251, v248
    v_mov_b32_dpp v251, v248 row_ror:12 row_mask:0x2 bank_mask:0xf
    v_mov_b32_dpp v251, v248 row_ror:8 row_mask:0x4 bank_mask:0xf
    v_mov_b32_dpp v251, v248 row_ror:4 row_mask:0x8 bank_mask:0xf
    v_mfma_f32_16x16x32_bf16 v[156:159], v[196:199], a[204:207], v[156:159]
    s_or_b64 s[46:47], s[46:47], vcc
    ds_read_b64_tr_b16 v[212:213], v252 offset:8704
    ds_read_b64_tr_b16 v[214:215], v252 offset:8736
    s_nop 0
    v_mov_b32_dpp v248, v251 row_newbcast:0 row_mask:0xf bank_mask:0xf
    v_mov_b32_dpp v249, v251 row_newbcast:1 row_mask:0xf bank_mask:0xf
    v_mov_b32_dpp v250, v251 row_newbcast:2 row_mask:0xf bank_mask:0xf
    v_mov_b32_dpp v251, v251 row_newbcast:3 row_mask:0xf bank_mask:0xf
    s_waitcnt lgkmcnt(8)
    buffer_store_dwordx4 v[204:207], v244, s[16:19], s38 offen offset:1024 nt
    s_nop 1
    v_pk_mul_f32 v[128:129], v[128:129], v[248:249]
    v_pk_mul_f32 v[132:133], v[132:133], v[248:249]
    v_pk_mul_f32 v[136:137], v[136:137], v[248:249]
    v_pk_mul_f32 v[140:141], v[140:141], v[248:249]
    v_pk_mul_f32 v[144:145], v[144:145], v[248:249]
    v_pk_mul_f32 v[148:149], v[148:149], v[248:249]
    v_pk_mul_f32 v[152:153], v[152:153], v[248:249]
    v_pk_mul_f32 v[156:157], v[156:157], v[248:249]
    v_cvt_pk_bf16_f32 v128, v128, v132
    v_cvt_pk_bf16_f32 v132, v129, v133
    v_cvt_pk_bf16_f32 v129, v136, v140
    v_cvt_pk_bf16_f32 v133, v137, v141
    v_cvt_pk_bf16_f32 v144, v144, v148
    v_cvt_pk_bf16_f32 v148, v145, v149
    v_cvt_pk_bf16_f32 v145, v152, v156
    v_cvt_pk_bf16_f32 v149, v153, v157
    s_waitcnt lgkmcnt(2)
    buffer_store_dwordx4 v[208:211], v244, s[16:19], s38 offen offset:2048 nt
    ds_write_b64 v246, v[128:129] offset:1088
    v_pk_mul_f32 v[130:131], v[130:131], v[250:251]
    v_pk_mul_f32 v[134:135], v[134:135], v[250:251]
    v_pk_mul_f32 v[138:139], v[138:139], v[250:251]
    v_pk_mul_f32 v[142:143], v[142:143], v[250:251]
    ds_write_b64 v246, v[144:145] offset:1216
    v_pk_mul_f32 v[146:147], v[146:147], v[250:251]
    v_pk_mul_f32 v[150:151], v[150:151], v[250:251]
    v_pk_mul_f32 v[154:155], v[154:155], v[250:251]
    v_pk_mul_f32 v[158:159], v[158:159], v[250:251]
    s_waitcnt lgkmcnt(2)
    buffer_store_dwordx4 v[212:215], v244, s[16:19], s38 offen offset:3072 nt
    ds_write_b64 v246, v[132:133] offset:2176
    v_cvt_pk_bf16_f32 v130, v130, v134
    v_cvt_pk_bf16_f32 v134, v131, v135
    v_cvt_pk_bf16_f32 v131, v138, v142
    v_cvt_pk_bf16_f32 v135, v139, v143
    ds_write_b64 v246, v[148:149] offset:2304
    v_cvt_pk_bf16_f32 v146, v146, v150
    v_cvt_pk_bf16_f32 v150, v147, v151
    v_cvt_pk_bf16_f32 v147, v154, v158
    v_cvt_pk_bf16_f32 v151, v155, v159
    ds_read_b64_tr_b16 v[216:217], v252 offset:1088
    ds_read_b64_tr_b16 v[218:219], v252 offset:1120
    ds_read_b64_tr_b16 v[220:221], v252 offset:2176
    ds_read_b64_tr_b16 v[222:223], v252 offset:2208
    ds_write_b64 v246, v[130:131] offset:3264
    ds_write_b64 v246, v[146:147] offset:3392
    ds_write_b64 v246, v[134:135] offset:4352
    ds_write_b64 v246, v[150:151] offset:4480
    ds_read_b64_tr_b16 v[224:225], v252 offset:3264
    ds_read_b64_tr_b16 v[226:227], v252 offset:3296
    ds_read_b64_tr_b16 v[228:229], v252 offset:4352
    ds_read_b64_tr_b16 v[230:231], v252 offset:4384
    s_waitcnt lgkmcnt(10)
    buffer_store_dwordx4 v[216:219], v244, s[16:19], s39 offen offset:0 nt
    s_waitcnt lgkmcnt(8)
    buffer_store_dwordx4 v[220:223], v244, s[16:19], s39 offen offset:1024 nt
    s_waitcnt lgkmcnt(2)
    buffer_store_dwordx4 v[224:227], v244, s[16:19], s39 offen offset:2048 nt
    s_waitcnt lgkmcnt(0)
    buffer_store_dwordx4 v[228:231], v244, s[16:19], s39 offen offset:3072 nt
L_rendr1:
    s_or_b64 s[60:61], s[44:45], s[46:47]
    s_cbranch_scc1 L_done
    s_endpgm
L_done:
    s_or_b64 s[60:61], s[44:45], s[46:47]
    s_cbranch_scc0 L_end
    s_waitcnt vmcnt(0) lgkmcnt(0)
    s_barrier
    s_mov_b32 s6, 39845888
    s_mov_b32 s7, 0x20000
    s_mov_b32 s10, 67108864
    s_mov_b32 s11, 0x20000
    s_mov_b32 s14, 67108864
    s_mov_b32 s15, 0x20000
    s_mul_i32 s58, s20, 8192
    v_lshrrev_b32 v128, 4, v244
    v_lshrrev_b32 v129, 2, v128
    v_lshlrev_b32 v129, 8, v129
    v_and_b32 v130, 3, v128
    v_lshl_add_u32 v129, v130, 3, v129
    v_add_u32 v129, s58, v129
    v_and_b32 v130, 15, v128
    v_lshlrev_b32 v131, 8, v130
    v_lshrrev_b32 v128, 4, v128
    v_lshl_add_u32 v130, v128, 4, v131
    v_lshl_add_u32 v131, v128, 3, v131
    s_mov_b32 s52, 0
L_fb_phase:
    s_cmp_eq_u32 s52, 0
    s_cselect_b64 s[60:61], s[44:45], s[46:47]
    s_cselect_b32 s54, s32, s37
    s_cselect_b32 s56, s30, s35
    s_cselect_b32 s55, s50, s51
    s_min_u32 s54, s54, s56
    s_cmp_eq_u64 s[60:61], 0
    s_cbranch_scc1 L_fb_next
    s_mov_b32 s53, 0
L_fb_tile:
    buffer_load_dwordx4 v[32:35], v130, s[4:7], s54 offen offset:0
    buffer_load_dwordx4 v[36:39], v130, s[4:7], s54 offen offset:64
    buffer_load_dwordx4 v[40:43], v130, s[4:7], s54 offen offset:128
    buffer_load_dwordx4 v[44:47], v130, s[4:7], s54 offen offset:192
    s_waitcnt vmcnt(0)
    v_lshlrev_b32 v80, 16, v32
    v_and_b32 v81, 0xffff0000, v32
    v_pk_mul_f32 v[80:81], v[80:81], s[40:41]
    v_cvt_pk_bf16_f32 v32, v80, v81
    v_lshlrev_b32 v80, 16, v33
    v_and_b32 v81, 0xffff0000, v33
    v_pk_mul_f32 v[80:81], v[80:81], s[40:41]
    v_cvt_pk_bf16_f32 v33, v80, v81
    v_lshlrev_b32 v80, 16, v34
    v_and_b32 v81, 0xffff0000, v34
    v_pk_mul_f32 v[80:81], v[80:81], s[40:41]
    v_cvt_pk_bf16_f32 v34, v80, v81
    v_lshlrev_b32 v80, 16, v35
    v_and_b32 v81, 0xffff0000, v35
    v_pk_mul_f32 v[80:81], v[80:81], s[40:41]
    v_cvt_pk_bf16_f32 v35, v80, v81
    v_lshlrev_b32 v80, 16, v36
    v_and_b32 v81, 0xffff0000, v36
    v_pk_mul_f32 v[80:81], v[80:81], s[40:41]
    v_cvt_pk_bf16_f32 v36, v80, v81
    v_lshlrev_b32 v80, 16, v37
    v_and_b32 v81, 0xffff0000, v37
    v_pk_mul_f32 v[80:81], v[80:81], s[40:41]
    v_cvt_pk_bf16_f32 v37, v80, v81
    v_lshlrev_b32 v80, 16, v38
    v_and_b32 v81, 0xffff0000, v38
    v_pk_mul_f32 v[80:81], v[80:81], s[40:41]
    v_cvt_pk_bf16_f32 v38, v80, v81
    v_lshlrev_b32 v80, 16, v39
    v_and_b32 v81, 0xffff0000, v39
    v_pk_mul_f32 v[80:81], v[80:81], s[40:41]
    v_cvt_pk_bf16_f32 v39, v80, v81
    v_lshlrev_b32 v80, 16, v40
    v_and_b32 v81, 0xffff0000, v40
    v_pk_mul_f32 v[80:81], v[80:81], s[40:41]
    v_cvt_pk_bf16_f32 v40, v80, v81
    v_lshlrev_b32 v80, 16, v41
    v_and_b32 v81, 0xffff0000, v41
    v_pk_mul_f32 v[80:81], v[80:81], s[40:41]
    v_cvt_pk_bf16_f32 v41, v80, v81
    v_lshlrev_b32 v80, 16, v42
    v_and_b32 v81, 0xffff0000, v42
    v_pk_mul_f32 v[80:81], v[80:81], s[40:41]
    v_cvt_pk_bf16_f32 v42, v80, v81
    v_lshlrev_b32 v80, 16, v43
    v_and_b32 v81, 0xffff0000, v43
    v_pk_mul_f32 v[80:81], v[80:81], s[40:41]
    v_cvt_pk_bf16_f32 v43, v80, v81
    v_lshlrev_b32 v80, 16, v44
    v_and_b32 v81, 0xffff0000, v44
    v_pk_mul_f32 v[80:81], v[80:81], s[40:41]
    v_cvt_pk_bf16_f32 v44, v80, v81
    v_lshlrev_b32 v80, 16, v45
    v_and_b32 v81, 0xffff0000, v45
    v_pk_mul_f32 v[80:81], v[80:81], s[40:41]
    v_cvt_pk_bf16_f32 v45, v80, v81
    v_lshlrev_b32 v80, 16, v46
    v_and_b32 v81, 0xffff0000, v46
    v_pk_mul_f32 v[80:81], v[80:81], s[40:41]
    v_cvt_pk_bf16_f32 v46, v80, v81
    v_lshlrev_b32 v80, 16, v47
    v_and_b32 v81, 0xffff0000, v47
    v_pk_mul_f32 v[80:81], v[80:81], s[40:41]
    v_cvt_pk_bf16_f32 v47, v80, v81
    v_mov_b32 v124, 0xff800000
    s_mov_b32 s57, s55
    s_mov_b32 s56, 32
L_fb_max:
    buffer_load_dwordx4 v[48:51], v130, s[8:11], s57 offen offset:0
    buffer_load_dwordx4 v[52:55], v130, s[8:11], s57 offen offset:64
    buffer_load_dwordx4 v[56:59], v130, s[8:11], s57 offen offset:128
    buffer_load_dwordx4 v[60:63], v130, s[8:11], s57 offen offset:192
    s_add_u32 s57, s57, 4096
    buffer_load_dwordx4 v[64:67], v130, s[8:11], s57 offen offset:0
    buffer_load_dwordx4 v[68:71], v130, s[8:11], s57 offen offset:64
    buffer_load_dwordx4 v[72:75], v130, s[8:11], s57 offen offset:128
    buffer_load_dwordx4 v[76:79], v130, s[8:11], s57 offen offset:192
    s_sub_u32 s57, s57, 4096
    s_waitcnt vmcnt(0)
    v_mfma_f32_16x16x32_bf16 v[80:83], v[48:51], v[32:35], 0
    v_mfma_f32_16x16x32_bf16 v[80:83], v[52:55], v[36:39], v[80:83]
    v_mfma_f32_16x16x32_bf16 v[80:83], v[56:59], v[40:43], v[80:83]
    v_mfma_f32_16x16x32_bf16 v[80:83], v[60:63], v[44:47], v[80:83]
    v_mfma_f32_16x16x32_bf16 v[84:87], v[64:67], v[32:35], 0
    v_mfma_f32_16x16x32_bf16 v[84:87], v[68:71], v[36:39], v[84:87]
    v_mfma_f32_16x16x32_bf16 v[84:87], v[72:75], v[40:43], v[84:87]
    v_mfma_f32_16x16x32_bf16 v[84:87], v[76:79], v[44:47], v[84:87]
    s_nop 7
    s_nop 1
    v_max3_f32 v124, v124, v80, v81
    v_max3_f32 v124, v124, v82, v83
    v_max3_f32 v124, v124, v84, v85
    v_max3_f32 v124, v124, v86, v87
    s_add_u32 s57, s57, 8192
    s_sub_u32 s56, s56, 1
    s_cmp_lg_u32 s56, 0
    s_cbranch_scc1 L_fb_max
    v_mov_b32 v128, v124
    s_nop 1
    v_permlane32_swap_b32 v128, v124
    s_nop 1
    v_max_f32 v124, v124, v128
    v_mov_b32 v128, v124
    s_nop 1
    v_permlane16_swap_b32 v128, v124
    s_nop 1
    v_max_f32 v124, v124, v128
    v_mov_b32 v0, 0
    v_mov_b32 v1, 0
    v_mov_b32 v2, 0
    v_mov_b32 v3, 0
    v_mov_b32 v4, 0
    v_mov_b32 v5, 0
    v_mov_b32 v6, 0
    v_mov_b32 v7, 0
    v_mov_b32 v8, 0
    v_mov_b32 v9, 0
    v_mov_b32 v10, 0
    v_mov_b32 v11, 0
    v_mov_b32 v12, 0
    v_mov_b32 v13, 0
    v_mov_b32 v14, 0
    v_mov_b32 v15, 0
    v_mov_b32 v16, 0
    v_mov_b32 v17, 0
    v_mov_b32 v18, 0
    v_mov_b32 v19, 0
    v_mov_b32 v20, 0
    v_mov_b32 v21, 0
    v_mov_b32 v22, 0
    v_mov_b32 v23, 0
    v_mov_b32 v24, 0
    v_mov_b32 v25, 0
    v_mov_b32 v26, 0
    v_mov_b32 v27, 0
    v_mov_b32 v28, 0
    v_mov_b32 v29, 0
    v_mov_b32 v30, 0
    v_mov_b32 v31, 0
    v_mov_b32 v126, 0
    s_mov_b32 s57, s55
    s_mov_b32 s56, 32
L_fb_acc:
    buffer_load_dwordx4 v[48:51], v130, s[8:11], s57 offen offset:0
    buffer_load_dwordx4 v[52:55], v130, s[8:11], s57 offen offset:64
    buffer_load_dwordx4 v[56:59], v130, s[8:11], s57 offen offset:128
    buffer_load_dwordx4 v[60:63], v130, s[8:11], s57 offen offset:192
    s_add_u32 s57, s57, 4096
    buffer_load_dwordx4 v[64:67], v130, s[8:11], s57 offen offset:0
    buffer_load_dwordx4 v[68:71], v130, s[8:11], s57 offen offset:64
    buffer_load_dwordx4 v[72:75], v130, s[8:11], s57 offen offset:128
    buffer_load_dwordx4 v[76:79], v130, s[8:11], s57 offen offset:192
    s_sub_u32 s57, s57, 4096
    s_add_u32 m0, s58, 0
    s_nop 0
    buffer_load_dwordx4 v244, s[12:15], s57 offen offset:0 lds
    s_add_u32 m0, s58, 0
    s_nop 0
    buffer_load_dwordx4 v244, s[12:15], s57 offen offset:1024 lds
    s_add_u32 m0, s58, 0
    s_nop 0
    buffer_load_dwordx4 v244, s[12:15], s57 offen offset:2048 lds
    s_add_u32 m0, s58, 0
    s_nop 0
    buffer_load_dwordx4 v244, s[12:15], s57 offen offset:3072 lds
    s_add_u32 s57, s57, 4096
    s_add_u32 m0, s58, 4096
    s_nop 0
    buffer_load_dwordx4 v244, s[12:15], s57 offen offset:0 lds
    s_add_u32 m0, s58, 4096
    s_nop 0
    buffer_load_dwordx4 v244, s[12:15], s57 offen offset:1024 lds
    s_add_u32 m0, s58, 4096
    s_nop 0
    buffer_load_dwordx4 v244, s[12:15], s57 offen offset:2048 lds
    s_add_u32 m0, s58, 4096
    s_nop 0
    buffer_load_dwordx4 v244, s[12:15], s57 offen offset:3072 lds
    s_waitcnt vmcnt(0)
    ds_read_b64_tr_b16 v[92:93], v129 offset:0
    ds_read_b64_tr_b16 v[94:95], v129 offset:4096
    ds_read_b64_tr_b16 v[96:97], v129 offset:32
    ds_read_b64_tr_b16 v[98:99], v129 offset:4128
    ds_read_b64_tr_b16 v[100:101], v129 offset:64
    ds_read_b64_tr_b16 v[102:103], v129 offset:4160
    ds_read_b64_tr_b16 v[104:105], v129 offset:96
    ds_read_b64_tr_b16 v[106:107], v129 offset:4192
    ds_read_b64_tr_b16 v[108:109], v129 offset:128
    ds_read_b64_tr_b16 v[110:111], v129 offset:4224
    ds_read_b64_tr_b16 v[112:113], v129 offset:160
    ds_read_b64_tr_b16 v[114:115], v129 offset:4256
    ds_read_b64_tr_b16 v[116:117], v129 offset:192
    ds_read_b64_tr_b16 v[118:119], v129 offset:4288
    ds_read_b64_tr_b16 v[120:121], v129 offset:224
    ds_read_b64_tr_b16 v[122:123], v129 offset:4320
    v_mfma_f32_16x16x32_bf16 v[80:83], v[48:51], v[32:35], 0
    v_mfma_f32_16x16x32_bf16 v[80:83], v[52:55], v[36:39], v[80:83]
    v_mfma_f32_16x16x32_bf16 v[80:83], v[56:59], v[40:43], v[80:83]
    v_mfma_f32_16x16x32_bf16 v[80:83], v[60:63], v[44:47], v[80:83]
    v_mfma_f32_16x16x32_bf16 v[84:87], v[64:67], v[32:35], 0
    v_mfma_f32_16x16x32_bf16 v[84:87], v[68:71], v[36:39], v[84:87]
    v_mfma_f32_16x16x32_bf16 v[84:87], v[72:75], v[40:43], v[84:87]
    v_mfma_f32_16x16x32_bf16 v[84:87], v[76:79], v[44:47], v[84:87]
    s_nop 7
    s_nop 1
    v_sub_f32 v80, v80, v124
    v_sub_f32 v81, v81, v124
    v_sub_f32 v82, v82, v124
    v_sub_f32 v83, v83, v124
    v_sub_f32 v84, v84, v124
    v_sub_f32 v85, v85, v124
    v_sub_f32 v86, v86, v124
    v_sub_f32 v87, v87, v124
    v_exp_f32 v80, v80
    v_exp_f32 v81, v81
    v_exp_f32 v82, v82
    v_exp_f32 v83, v83
    v_exp_f32 v84, v84
    v_exp_f32 v85, v85
    v_exp_f32 v86, v86
    v_exp_f32 v87, v87
    s_nop 0
    v_cvt_pk_bf16_f32 v88, v80, v81
    v_cvt_pk_bf16_f32 v89, v82, v83
    v_cvt_pk_bf16_f32 v90, v84, v85
    v_cvt_pk_bf16_f32 v91, v86, v87
    v_add_f32 v126, v126, v80
    v_add_f32 v126, v126, v81
    v_add_f32 v126, v126, v82
    v_add_f32 v126, v126, v83
    v_add_f32 v126, v126, v84
    v_add_f32 v126, v126, v85
    v_add_f32 v126, v126, v86
    v_add_f32 v126, v126, v87
    s_waitcnt lgkmcnt(0)
    v_mfma_f32_16x16x32_bf16 v[0:3], v[92:95], v[88:91], v[0:3]
    v_mfma_f32_16x16x32_bf16 v[4:7], v[96:99], v[88:91], v[4:7]
    v_mfma_f32_16x16x32_bf16 v[8:11], v[100:103], v[88:91], v[8:11]
    v_mfma_f32_16x16x32_bf16 v[12:15], v[104:107], v[88:91], v[12:15]
    v_mfma_f32_16x16x32_bf16 v[16:19], v[108:111], v[88:91], v[16:19]
    v_mfma_f32_16x16x32_bf16 v[20:23], v[112:115], v[88:91], v[20:23]
    v_mfma_f32_16x16x32_bf16 v[24:27], v[116:119], v[88:91], v[24:27]
    v_mfma_f32_16x16x32_bf16 v[28:31], v[120:123], v[88:91], v[28:31]
    s_add_u32 s57, s57, 4096
    s_sub_u32 s56, s56, 1
    s_cmp_lg_u32 s56, 0
    s_cbranch_scc1 L_fb_acc
    v_mov_b32 v128, v126
    s_nop 1
    v_permlane32_swap_b32 v128, v126
    s_nop 1
    v_add_f32 v126, v126, v128
    v_mov_b32 v128, v126
    s_nop 1
    v_permlane16_swap_b32 v128, v126
    s_nop 1
    v_add_f32 v126, v126, v128
    v_rcp_f32 v126, v126
    s_nop 7
    v_mul_f32 v0, v0, v126
    v_mul_f32 v1, v1, v126
    v_mul_f32 v2, v2, v126
    v_mul_f32 v3, v3, v126
    v_mul_f32 v4, v4, v126
    v_mul_f32 v5, v5, v126
    v_mul_f32 v6, v6, v126
    v_mul_f32 v7, v7, v126
    v_mul_f32 v8, v8, v126
    v_mul_f32 v9, v9, v126
    v_mul_f32 v10, v10, v126
    v_mul_f32 v11, v11, v126
    v_mul_f32 v12, v12, v126
    v_mul_f32 v13, v13, v126
    v_mul_f32 v14, v14, v126
    v_mul_f32 v15, v15, v126
    v_mul_f32 v16, v16, v126
    v_mul_f32 v17, v17, v126
    v_mul_f32 v18, v18, v126
    v_mul_f32 v19, v19, v126
    v_mul_f32 v20, v20, v126
    v_mul_f32 v21, v21, v126
    v_mul_f32 v22, v22, v126
    v_mul_f32 v23, v23, v126
    v_mul_f32 v24, v24, v126
    v_mul_f32 v25, v25, v126
    v_mul_f32 v26, v26, v126
    v_mul_f32 v27, v27, v126
    v_mul_f32 v28, v28, v126
    v_mul_f32 v29, v29, v126
    v_mul_f32 v30, v30, v126
    v_mul_f32 v31, v31, v126
    v_cvt_pk_bf16_f32 v0, v0, v1
    v_cvt_pk_bf16_f32 v1, v2, v3
    buffer_store_dwordx2 v[0:1], v131, s[16:19], s54 offen offset:0
    v_cvt_pk_bf16_f32 v4, v4, v5
    v_cvt_pk_bf16_f32 v5, v6, v7
    buffer_store_dwordx2 v[4:5], v131, s[16:19], s54 offen offset:32
    v_cvt_pk_bf16_f32 v8, v8, v9
    v_cvt_pk_bf16_f32 v9, v10, v11
    buffer_store_dwordx2 v[8:9], v131, s[16:19], s54 offen offset:64
    v_cvt_pk_bf16_f32 v12, v12, v13
    v_cvt_pk_bf16_f32 v13, v14, v15
    buffer_store_dwordx2 v[12:13], v131, s[16:19], s54 offen offset:96
    v_cvt_pk_bf16_f32 v16, v16, v17
    v_cvt_pk_bf16_f32 v17, v18, v19
    buffer_store_dwordx2 v[16:17], v131, s[16:19], s54 offen offset:128
    v_cvt_pk_bf16_f32 v20, v20, v21
    v_cvt_pk_bf16_f32 v21, v22, v23
    buffer_store_dwordx2 v[20:21], v131, s[16:19], s54 offen offset:160
    v_cvt_pk_bf16_f32 v24, v24, v25
    v_cvt_pk_bf16_f32 v25, v26, v27
    buffer_store_dwordx2 v[24:25], v131, s[16:19], s54 offen offset:192
    v_cvt_pk_bf16_f32 v28, v28, v29
    v_cvt_pk_bf16_f32 v29, v30, v31
    buffer_store_dwordx2 v[28:29], v131, s[16:19], s54 offen offset:224
    s_waitcnt vmcnt(0)
    s_add_u32 s54, s54, 4096
    s_add_u32 s53, s53, 1
    s_cmp_lt_u32 s53, 5
    s_cbranch_scc1 L_fb_tile
L_fb_next:
    s_add_u32 s52, s52, 1
    s_cmp_lt_u32 s52, 2
    s_cbranch_scc1 L_fb_phase
L_end:
    s_endpgm
.section .rodata,"a"
.p2align 6
.amdhsa_kernel standalone__mha_softmax__near_ridge_kernel
.amdhsa_next_free_vgpr 512
.amdhsa_next_free_sgpr 102
.amdhsa_accum_offset 256
.amdhsa_group_segment_fixed_size 0
.amdhsa_kernarg_size 48
.amdhsa_user_sgpr_count 2
.amdhsa_user_sgpr_kernarg_segment_ptr 1
.amdhsa_system_sgpr_workgroup_id_x 1
.end_amdhsa_kernel
```
